```python
import torch

def _softmax(x, axis=-1):
    return torch.softmax(x, dim=axis)
def _gelu(x):
    return torch.nn.functional.gelu(x, approximate="tanh")
def _silu(x):
    return torch.nn.functional.silu(x)
def _sigmoid(x):
    return torch.sigmoid(x)
def _layernorm(x, axis=-1, eps=1e-5):
    m = x.mean(dim=axis, keepdim=True)
    v = x.var(dim=axis, keepdim=True, unbiased=False)
    return (x - m) / torch.sqrt(v + eps)
def _scatter_add(tgt, idx, src, axis=0):
    return tgt.clone().index_add_(axis, idx, src)
def _segment_sum(src, seg, n):
    out = torch.zeros((n,) + src.shape[1:], dtype=src.dtype)
    return out.index_add_(0, seg, src)
def _pad(x, pw):
    flat = tuple(v for pair in reversed(pw) for v in pair)
    return torch.nn.functional.pad(x, flat)

kernel_name = 'interleave_layers__softmax_full_mha__dense_activation_squared_relu__prompt'

def setup_inputs():

    _w = (lambda a: (lambda t: t.to(torch.bfloat16) if t.is_floating_point() else t)(torch.as_tensor(a)))
    def _A_setup():
        B, S, D = 1, 2048, 448
        return {
            "x": _w((lambda *s: torch.randn(*s, dtype=torch.bfloat16) * 0.05)(B, S, D)),
            "wqkv": _w((lambda *s: torch.randn(*s, dtype=torch.bfloat16) * 0.05)(D, 3 * D)),
            "wo": _w((lambda *s: torch.randn(*s, dtype=torch.bfloat16) * 0.05)(D, D)),
        }
    _A_in = _A_setup()

    def _B_setup():
        B, S, D, F = 1, 2048, 448, 1792
        return {
            "x": _w((lambda *s: torch.randn(*s, dtype=torch.bfloat16) * 0.05)(B, S, D)),
            "w1": _w((lambda *s: torch.randn(*s, dtype=torch.bfloat16) * 0.05)(D, F)),
            "b1": _w((lambda *s: torch.randn(*s, dtype=torch.bfloat16) * 0.1)(F)),
            "w2": _w((lambda *s: torch.randn(*s, dtype=torch.bfloat16) * 0.05)(F, D)),
            "b2": _w((lambda *s: torch.randn(*s, dtype=torch.bfloat16) * 0.4)(D)),
        }
    _B_in = _B_setup()

    return {
        "A_x": _A_in["x"],
        "A_wqkv": _A_in["wqkv"],
        "A_wo": _A_in["wo"],
        "B_x": _B_in["x"],
        "B_w1": _B_in["w1"],
        "B_b1": _B_in["b1"],
        "B_w2": _B_in["w2"],
        "B_b2": _B_in["b2"],
    }

def reference(A_x, A_wqkv, A_wo, B_x, B_w1, B_b1, B_w2, B_b2):
    def _A_ref(x, wqkv, wo):
        B, S, D = x.shape
        H = 16; Dh = D // H
        qkv = (lambda x, *d: x.permute(*d))((x @ wqkv).reshape(B, S, 3, H, Dh), 2, 0, 3, 1, 4)
        q, k, v = qkv[0], qkv[1], qkv[2]
        scale = Dh ** -0.5
        scores = torch.einsum("bhqd,bhkd->bhqk", q, k) * scale
        p = _softmax(scores, axis=-1)
        o = torch.einsum("bhqk,bhkd->bhqd", p, v)
        return (lambda x, *d: x.permute(*d))(o, 0, 2, 1, 3).reshape(B, S, D) @ wo

    def _B_ref(x, w1, b1, w2, b2):
        h = torch.einsum("bsd,df->bsf", x, w1) + b1
        zero = torch.zeros_like(h)
        r = torch.where(h > zero, h, zero)
        h = r * r
        out = torch.einsum("bsf,fd->bsd", h, w2) + b2
        return out

    x = A_x
    x = x + _A_ref(_layernorm(x, axis=-1), A_wqkv, A_wo)
    x = x + _B_ref(_layernorm(x, axis=-1), B_w1, B_b1, B_w2, B_b2)
    x = x + _A_ref(_layernorm(x, axis=-1), A_wqkv, A_wo)
    x = x + _B_ref(_layernorm(x, axis=-1), B_w1, B_b1, B_w2, B_b2)
    return x
```

```asm
; @launch grid=(256,1,1) block=(256,1,1) lds=163840
.amdgcn_target "amdgcn-amd-amdhsa--gfx950"
.text
.globl interleave_layers__softmax_full_mha__dense_activation_squared_relu__prompt_kernel
.p2align 8
.type interleave_layers__softmax_full_mha__dense_activation_squared_relu__prompt_kernel,@function
interleave_layers__softmax_full_mha__dense_activation_squared_relu__prompt_kernel:
    s_cmp_ge_u32 s2, 256
    s_cbranch_scc1 M_END
    s_load_dwordx2 s[20:21], s[0:1], 80
    s_load_dwordx2 s[22:23], s[0:1], 64
    s_load_dwordx4 s[64:67], s[0:1], 0
    s_load_dwordx2 s[68:69], s[0:1], 16
    s_load_dwordx4 s[72:75], s[0:1], 32
    s_load_dwordx4 s[76:79], s[0:1], 48
    v_lshrrev_b32 v1, 6, v0
    s_nop 0
    v_readfirstlane_b32 s3, v1
    v_and_b32 v0, 63, v0
    v_lshlrev_b32 v1, 4, v0
    s_and_b32 s4, s2, 7
    s_lshr_b32 s5, s2, 3
    s_lshr_b32 s26, s5, 4
    s_and_b32 s27, s5, 15
    s_mul_i32 s33, s27, 89088
    s_lshl_b32 s28, s4, 1
    s_add_u32 s28, s28, s26
    s_lshl_b32 s36, s28, 2
    s_add_u32 s36, s36, s3
    s_mov_b32 s10, 268435456
    s_mov_b32 s11, 0x20000
    s_mov_b32 s18, 1835008
    s_mov_b32 s19, 0x20000
    s_mov_b32 s24, 0
    s_mov_b32 s25, -1
    s_mov_b32 s90, 0
    s_mov_b32 s91, 0x20000
    s_mov_b32 s94, 0
    s_mov_b32 s95, 0x20000
    s_waitcnt lgkmcnt(0)
    s_mov_b32 s8, s20
    s_mov_b32 s9, s21
    s_add_u32 s58, s20, 2031616
    s_addc_u32 s59, s21, 0
    s_load_dword s6, s[58:59], 0
    s_mov_b32 s96, s78
    s_mov_b32 s97, s79
    s_mov_b32 s98, 896
    s_mov_b32 s99, 0x20000
    s_mov_b32 s16, s22
    s_mov_b32 s17, s23
    s_mov_b32 s88, s20
    s_mov_b32 s89, s21
    s_mov_b32 s92, s20
    s_mov_b32 s93, s21
    s_mov_b32 s84, s64
    s_mov_b32 s85, s65
    s_mov_b32 s86, 1835008
    s_mov_b32 s87, 0x20000
    s_mov_b32 s80, s66
    s_mov_b32 s81, s67
    s_mov_b32 s82, 1204224
    s_mov_b32 s83, 0x20000
    v_lshrrev_b32 v225, 3, v0
    v_mul_u32_u24 v226, 144, v225
    v_mul_u32_u24 v225, 896, v225
    v_and_b32 v227, 7, v0
    v_lshl_add_u32 v225, v227, 4, v225
    v_lshl_add_u32 v226, v227, 4, v226
    v_lshrrev_b32 v224, 2, v0
    v_mul_u32_u24 v224, 2688, v224
    v_and_b32 v227, 3, v0
    v_lshl_add_u32 v224, v227, 4, v224
    s_mul_i32 s50, s36, 28672
    s_add_u32 s51, s50, 7168
    s_add_u32 s52, s50, 14336
    s_add_u32 s53, s50, 21504
    s_mul_i32 s70, s3, 43008
    s_mul_i32 s7, s27, 56
    s_and_b32 s7, s7, -16
    s_add_u32 s70, s70, s7
    s_mul_i32 s71, s3, 3072
    s_add_u32 s71, s71, 16384
    buffer_load_dwordx4 v[16:19], v225, s[84:87], s50 offen
    buffer_load_dwordx4 v[20:23], v225, s[84:87], s51 offen
    buffer_load_dwordx4 v[24:27], v225, s[84:87], s52 offen
    buffer_load_dwordx4 v[28:31], v225, s[84:87], s53 offen
    s_add_u32 m0, s71, 0
    s_add_u32 s67, s70, 0
    buffer_load_dwordx4 v224, s[80:83], s67 offen lds
    v_add_u32 v2, 49152, v1
    v_add_u32 v7, 114688, v1
    v_lshlrev_b32 v3, 3, v0
    v_lshlrev_b32 v4, 2, v0
    v_and_b32 v5, 0x7c, v4
    v_and_b32 v6, 15, v0
    v_min_u32 v6, 13, v6
    v_lshlrev_b32 v6, 2, v6
    s_xor_b32 s7, s3, 0
    s_lshl_b32 s7, s7, 12
    v_add_u32 v13, s7, v1
    s_xor_b32 s7, s3, 1
    s_lshl_b32 s7, s7, 12
    v_add_u32 v10, s7, v1
    s_add_u32 m0, s71, 1024
    s_add_u32 s67, s70, 896
    buffer_load_dwordx4 v224, s[80:83], s67 offen lds
    s_xor_b32 s7, s3, 2
    s_lshl_b32 s7, s7, 12
    v_add_u32 v11, s7, v1
    s_xor_b32 s7, s3, 3
    s_lshl_b32 s7, s7, 12
    v_add_u32 v12, s7, v1
    s_cmp_ge_u32 s5, 14
    s_cselect_b32 s7, 1, 0
    s_lshl_b32 s29, s4, 1
    s_add_u32 s29, s29, s7
    s_lshl_b32 s29, s29, 2
    s_add_u32 s29, s29, s3
    s_mul_i32 s7, s7, 14
    s_sub_u32 s30, s5, s7
    s_mul_i32 s7, s5, 37
    s_lshr_b32 s7, s7, 8
    s_mul_i32 s32, s7, 7
    s_sub_u32 s32, s5, s32
    s_min_u32 s7, s7, 3
    s_lshl_b32 s31, s4, 2
    s_add_u32 s31, s31, s7
    s_mul_i32 s34, s32, 229376
    s_mul_i32 s7, s3, 57344
    s_add_u32 s34, s34, s7
    s_add_u32 s34, s34, 10551296
    s_min_u32 s30, s30, 13
    s_mul_i32 s35, s30, 118784
    s_add_u32 s35, s35, 8388608
    s_lshl_b32 s46, s32, 16
    s_lshl_b32 s7, s3, 14
    s_add_u32 s46, s46, s7
    s_add_u32 s46, s46, 10092544
    s_lshr_b32 s7, s3, 1
    s_lshl_b32 s48, s31, 1
    s_add_u32 s48, s48, s7
    s_and_b32 s7, s3, 1
    s_lshl_b32 s49, s32, 1
    s_add_u32 s49, s49, s7
    s_lshl_b32 s13, s48, 15
    s_lshl_b32 s7, s49, 11
    s_add_u32 s12, s13, s7
    s_lshl_b32 s7, s49, 8
    s_add_u32 s13, s13, s7
    s_add_u32 s13, s13, 28672
    s_lshl_b32 s14, s48, 4
    s_add_u32 s14, s14, s49
    s_lshl_b32 s14, s14, 2
    s_mul_i32 s15, s29, 114688
    s_lshl_b32 s7, s30, 13
    s_add_u32 s15, s15, s7
    s_add_u32 s15, s15, 20971520
    v_and_b32 v4, 15, v0
    v_max_u32 v4, 1, v4
    v_xor_b32 v4, s28, v4
    s_lshl_b32 s7, s3, 7
    v_lshl_add_u32 v4, v4, 9, s7
    s_getreg_b32 s54, hwreg(HW_REG_XCC_ID, 0, 4)
    s_waitcnt lgkmcnt(0)
    s_add_u32 s6, s6, 1
    v_mov_b32 v8, s6
    s_add_u32 m0, s71, 2048
    s_add_u32 s67, s70, 1792
    buffer_load_dwordx4 v224, s[80:83], s67 offen lds
    s_lshl_b32 s54, s54, 28
    s_xor_b32 s54, s54, s6
    s_lshl_b32 s55, s4, 12
    s_add_u32 s55, s55, 1720320
    s_lshl_b32 s40, s27, 6
    s_add_u32 s40, s40, s36
    s_lshl_b32 s41, s40, 12
    s_add_u32 s41, s41, 12582912
    s_lshl_b32 s38, s3, 12
    s_add_u32 s38, s38, 2048
    s_mov_b32 s79, 0x20000
    s_mov_b32 s78, 0
    s_mov_b32 s43, 0
    s_mov_b32 s39, 32
    s_mov_b32 s37, 0
    s_mov_b32 s42, 0
    s_mov_b32 s47, 4
    s_mov_b32 s44, 0
    s_mov_b32 s45, 0
    s_and_b32 s22, s3, 1
    s_lshr_b32 s23, s3, 1
    s_cmp_ge_u32 s2, 128
    s_cbranch_scc1 P_JOB
    s_lshl_b32 s45, s4, 2
    s_add_u32 s45, s45, s3
    s_cmp_lt_u32 s45, 28
    s_cselect_b32 s47, 0, 4
    s_mul_i32 s45, s45, 3072
    s_add_u32 s44, s45, s33
    s_branch P_W
P_JOB:
    s_sub_u32 s20, s2, 128
    s_cmp_ge_u32 s20, 126
    s_cbranch_scc1 P_W
    s_cmp_ge_u32 s20, 112
    s_cbranch_scc1 P_SETWO
    s_cmp_ge_u32 s20, 56
    s_cbranch_scc1 P_SETW2
    s_mov_b32 s76, s72
    s_mov_b32 s77, s73
    s_mov_b32 s78, 1605632
    s_mov_b32 s42, 3584
    s_and_b32 s21, s20, 1
    s_lshr_b32 s20, s20, 1
    s_lshl_b32 s37, s20, 6
    s_mul_i32 s43, s21, 224
    s_lshr_b32 s7, s20, 1
    s_mul_i32 s44, s7, 118784
    s_add_u32 s44, s44, 8388608
    s_and_b32 s7, s20, 1
    s_lshl_b32 s7, s7, 1
    s_add_u32 s7, s7, s22
    s_lshl_b32 s7, s7, 10
    s_add_u32 s44, s44, s7
    s_lshl_b32 s21, s21, 1
    s_add_u32 s21, s21, s23
    s_lshl_b32 s7, s21, 8
    s_add_u32 s68, s44, s7
    s_add_u32 s68, s68, 114688
    s_mul_i32 s7, s21, 28672
    s_add_u32 s44, s44, s7
    s_mov_b32 s45, 4096
    s_mov_b32 s47, 1
    s_branch P_W
P_SETW2:
    s_mov_b32 s78, 1605632
    s_mov_b32 s42, 896
    s_sub_u32 s20, s20, 56
    s_and_b32 s21, s20, 7
    s_lshr_b32 s20, s20, 3
    s_lshl_b32 s37, s20, 6
    s_mul_i32 s43, s21, 224
    s_mul_i32 s44, s20, 229376
    s_add_u32 s44, s44, 10551296
    s_lshr_b32 s7, s21, 1
    s_xor_b32 s7, s7, s22
    s_and_b32 s7, s7, 1
    s_lshl_b32 s7, s7, 10
    s_add_u32 s44, s44, s7
    s_lshl_b32 s21, s21, 1
    s_add_u32 s21, s21, s23
    s_mul_i32 s7, s21, 14336
    s_add_u32 s44, s44, s7
    s_mov_b32 s45, 2048
    s_mov_b32 s47, 2
    s_branch P_W
P_SETWO:
    s_mov_b32 s76, s68
    s_mov_b32 s77, s69
    s_mov_b32 s78, 401408
    s_mov_b32 s42, 896
    s_sub_u32 s20, s20, 112
    s_and_b32 s21, s20, 1
    s_lshr_b32 s20, s20, 1
    s_lshl_b32 s37, s20, 6
    s_mul_i32 s43, s21, 224
    s_lshl_b32 s44, s20, 16
    s_add_u32 s44, s44, 10092544
    s_xor_b32 s7, s22, s23
    s_lshl_b32 s7, s7, 10
    s_add_u32 s44, s44, s7
    s_lshl_b32 s21, s21, 1
    s_add_u32 s21, s21, s23
    s_lshl_b32 s7, s21, 14
    s_add_u32 s44, s44, s7
    s_mov_b32 s45, 2048
    s_mov_b32 s47, 3
    s_mov_b32 s39, 28
P_W:
    s_mov_b32 s47, s47
    v_lshrrev_b32 v245, 3, v0
    v_mul_lo_u32 v245, v245, s42
    v_and_b32 v246, 7, v0
    v_lshl_add_u32 v245, v246, 4, v245
    s_lshl_b32 s7, s37, 1
    v_add_u32 v245, s7, v245
    v_mov_b32 v238, 0x80000000
    s_lshl_b32 s7, s22, 5
    s_add_u32 s37, s37, s7
    s_cmp_eq_u32 s47, 3
    s_cselect_b64 s[20:21], s[24:25], 0
    v_cndmask_b32 v246, v245, v238, s[20:21]
    s_cselect_b64 s[20:21], s[24:25], -1
    v_cndmask_b32 v247, v245, v238, s[20:21]
    s_cselect_b32 s7, 8, 7
    s_lshl_b32 s7, s7, 10
    s_mul_i32 s23, s3, s7
    s_add_u32 s23, s23, 102400
    s_lshl_b32 s7, s3, 10
    s_add_u32 s7, s7, 131072
    s_add_u32 s69, s23, 7168
    s_cmp_eq_u32 s47, 3
    s_cselect_b32 s69, s69, s7
    s_mul_i32 s22, s3, 56
    s_add_u32 s22, s22, s43
    s_mov_b32 s72, s74
    s_mov_b32 s73, s75
    s_mov_b32 s74, 3584
    s_mov_b32 s75, 0x20000
    v_and_b32 v244, 31, v0
    v_add_lshl_u32 v244, v244, s37, 1
    buffer_load_dwordx4 v[32:35], v225, s[84:87], s50 offen offset:128
    v_and_b32 v14, 31, v0
    v_mul_u32_u24 v227, 144, v14
    v_lshrrev_b32 v15, 5, v0
    v_lshl_add_u32 v227, v15, 4, v227
    s_mul_i32 s7, s3, 7168
    s_add_u32 s7, s7, 135168
    v_add_u32 v226, s7, v226
    v_add_u32 v227, s7, v227
    v_bfe_u32 v236, v0, 2, 2
    v_lshl_add_u32 v236, v15, 3, v236
    v_lshlrev_b32 v236, 6, v236
    buffer_load_dwordx4 v[36:39], v225, s[84:87], s51 offen offset:128
    v_bfe_u32 v237, v0, 4, 1
    v_lshl_add_u32 v236, v237, 5, v236
    v_and_b32 v237, 3, v0
    v_lshl_add_u32 v236, v237, 3, v236
    s_and_b32 s7, s27, 1
    s_lshl_b32 s7, s7, 3
    v_add_u32 v236, s7, v236
    v_add_u32 v238, s71, v236
    v_add_u32 v236, 16384, v236
    v_add_u32 v237, 49152, v236
    v_mov_b32 v240, 0x3f803f80
    v_mov_b32 v212, 0
    v_mov_b32 v241, 0x3f803f80
    buffer_load_dwordx4 v[40:43], v225, s[84:87], s52 offen offset:128
    v_mov_b32 v213, 0
    v_mov_b32 v242, 0x3f803f80
    v_mov_b32 v214, 0
    v_mov_b32 v243, 0x3f803f80
    v_mov_b32 v215, 0
    v_mov_b32 v235, 0x3f80
    s_mov_b32 s56, 0x10000000
    s_mov_b32 s57, 0x10000000
    v_cndmask_b32 v234, 0, v240, s[56:57]
    v_cndmask_b32 v218, 0, v235, s[56:57]
    s_mov_b32 s56, 0xf0000000
    s_mov_b32 s57, 0xf0000000
    buffer_load_dwordx4 v[44:47], v225, s[84:87], s53 offen offset:128
    s_add_u32 m0, s71, 12288
    s_add_u32 s67, s70, 172032
    buffer_load_dwordx4 v224, s[80:83], s67 offen lds
    s_waitcnt vmcnt(8)
    ds_write_b128 v226, v[16:19]
    ds_write_b128 v226, v[20:23] offset:1152
    ds_write_b128 v226, v[24:27] offset:2304
    ds_write_b128 v226, v[28:31] offset:3456
    ds_read_b128 v[16:19], v227
    ds_read_b128 v[20:23], v227 offset:32
    ds_read_b128 v[24:27], v227 offset:64
    ds_read_b128 v[28:31], v227 offset:96
    s_add_u32 m0, s71, 13312
    s_add_u32 s67, s70, 172928
    buffer_load_dwordx4 v224, s[80:83], s67 offen lds
    s_add_u32 m0, s71, 14336
    s_add_u32 s67, s70, 173824
    buffer_load_dwordx4 v224, s[80:83], s67 offen lds
    buffer_load_dwordx4 v[48:51], v225, s[84:87], s50 offen offset:256
    buffer_load_dwordx4 v[52:55], v225, s[84:87], s51 offen offset:256
    buffer_load_dwordx4 v[56:59], v225, s[84:87], s52 offen offset:256
    s_waitcnt vmcnt(10)
    s_barrier
    ds_read_b64_tr_b16 v[128:129], v236 offset:1024
    ds_read_b64_tr_b16 v[130:131], v236 offset:1280
    ds_read_b64_tr_b16 v[132:133], v236 offset:2048
    ds_read_b64_tr_b16 v[134:135], v236 offset:2304
    ds_read_b64_tr_b16 v[136:137], v236
    ds_read_b64_tr_b16 v[138:139], v236 offset:256
    ds_read_b64_tr_b16 v[140:141], v236 offset:4096
    ds_read_b64_tr_b16 v[142:143], v236 offset:4352
    ds_read_b64_tr_b16 v[144:145], v236 offset:5120
    ds_read_b64_tr_b16 v[146:147], v236 offset:5376
    ds_read_b64_tr_b16 v[148:149], v236 offset:3072
    ds_read_b64_tr_b16 v[150:151], v236 offset:3328
    s_waitcnt lgkmcnt(15)
    v_dot2c_f32_bf16 v212, v16, v240
    v_dot2c_f32_bf16 v213, v16, v16
    v_dot2c_f32_bf16 v214, v17, v240
    v_dot2c_f32_bf16 v215, v17, v17
    v_dot2c_f32_bf16 v212, v18, v240
    v_dot2c_f32_bf16 v213, v18, v18
    v_dot2c_f32_bf16 v214, v19, v240
    v_dot2c_f32_bf16 v215, v19, v19
    buffer_load_dwordx4 v[60:63], v225, s[84:87], s53 offen offset:256
    s_add_u32 m0, s71, 24576
    s_add_u32 s67, s70, 344064
    buffer_load_dwordx4 v224, s[80:83], s67 offen lds
    s_waitcnt lgkmcnt(14)
    v_dot2c_f32_bf16 v212, v20, v240
    v_dot2c_f32_bf16 v213, v20, v20
    v_dot2c_f32_bf16 v214, v21, v240
    v_dot2c_f32_bf16 v215, v21, v21
    v_dot2c_f32_bf16 v212, v22, v240
    v_dot2c_f32_bf16 v213, v22, v22
    v_dot2c_f32_bf16 v214, v23, v240
    v_dot2c_f32_bf16 v215, v23, v23
    s_waitcnt lgkmcnt(13)
    v_dot2c_f32_bf16 v212, v24, v240
    v_dot2c_f32_bf16 v213, v24, v24
    v_dot2c_f32_bf16 v214, v25, v240
    v_dot2c_f32_bf16 v215, v25, v25
    v_dot2c_f32_bf16 v212, v26, v240
    v_dot2c_f32_bf16 v213, v26, v26
    v_dot2c_f32_bf16 v214, v27, v240
    v_dot2c_f32_bf16 v215, v27, v27
    s_waitcnt lgkmcnt(12)
    v_dot2c_f32_bf16 v212, v28, v240
    v_dot2c_f32_bf16 v213, v28, v28
    v_dot2c_f32_bf16 v214, v29, v240
    v_dot2c_f32_bf16 v215, v29, v29
    v_dot2c_f32_bf16 v212, v30, v240
    v_dot2c_f32_bf16 v213, v30, v30
    v_dot2c_f32_bf16 v214, v31, v240
    v_dot2c_f32_bf16 v215, v31, v31
    s_waitcnt lgkmcnt(8)
    v_mfma_f32_32x32x16_bf16 v[180:195], v[128:131], v[16:19], 0
    ds_read_b64_tr_b16 v[152:153], v236 offset:7168
    ds_read_b64_tr_b16 v[154:155], v236 offset:7424
    v_mfma_f32_32x32x16_bf16 v[196:211], v[16:19], v[132:135], 0
    ds_read_b64_tr_b16 v[156:157], v236 offset:8192
    ds_read_b64_tr_b16 v[158:159], v236 offset:8448
    s_waitcnt lgkmcnt(8)
    v_mfma_f32_32x32x16_bf16 v[164:179], v[136:139], v[16:19], 0
    s_add_u32 m0, s71, 25600
    s_add_u32 s67, s70, 344960
    buffer_load_dwordx4 v224, s[80:83], s67 offen lds
    ds_read_b64_tr_b16 v[160:161], v236 offset:6144
    ds_read_b64_tr_b16 v[162:163], v236 offset:6400
    v_mfma_f32_32x32x16_bf16 v[180:195], v[140:143], v[20:23], v[180:195]
    ds_read_b64_tr_b16 v[128:129], v236 offset:10240
    ds_read_b64_tr_b16 v[130:131], v236 offset:10496
    s_waitcnt lgkmcnt(8)
    v_mfma_f32_32x32x16_bf16 v[196:211], v[20:23], v[144:147], v[196:211]
    ds_read_b64_tr_b16 v[132:133], v236 offset:11264
    ds_read_b64_tr_b16 v[134:135], v236 offset:11520
    s_waitcnt vmcnt(9)
    ds_write_b128 v226, v[32:35]
    v_mfma_f32_32x32x16_bf16 v[164:179], v[148:151], v[20:23], v[164:179]
    ds_read_b64_tr_b16 v[136:137], v236 offset:9216
    ds_read_b64_tr_b16 v[138:139], v236 offset:9472
    ds_write_b128 v226, v[36:39] offset:1152
    s_waitcnt lgkmcnt(10)
    v_mfma_f32_32x32x16_bf16 v[180:195], v[152:155], v[24:27], v[180:195]
    ds_read_b64_tr_b16 v[140:141], v238
    ds_read_b64_tr_b16 v[142:143], v238 offset:256
    ds_write_b128 v226, v[40:43] offset:2304
    v_mfma_f32_32x32x16_bf16 v[196:211], v[24:27], v[156:159], v[196:211]
    s_add_u32 m0, s71, 26624
    s_add_u32 s67, s70, 345856
    buffer_load_dwordx4 v224, s[80:83], s67 offen lds
    ds_read_b64_tr_b16 v[144:145], v238 offset:1024
    ds_read_b64_tr_b16 v[146:147], v238 offset:1280
    ds_write_b128 v226, v[44:47] offset:3456
    s_waitcnt lgkmcnt(12)
    v_mfma_f32_32x32x16_bf16 v[164:179], v[160:163], v[24:27], v[164:179]
    ds_read_b64_tr_b16 v[148:149], v238 offset:2048
    ds_read_b64_tr_b16 v[150:151], v238 offset:2304
    ds_read_b128 v[32:35], v227
    ds_read_b128 v[36:39], v227 offset:32
    v_mfma_f32_32x32x16_bf16 v[180:195], v[128:131], v[28:31], v[180:195]
    buffer_load_dwordx4 v[64:67], v225, s[84:87], s50 offen offset:384
    buffer_load_dwordx4 v[68:71], v225, s[84:87], s51 offen offset:384
    buffer_load_dwordx4 v[72:75], v225, s[84:87], s52 offen offset:384
    s_waitcnt vmcnt(10)
    s_barrier
    ds_read_b64_tr_b16 v[152:153], v236 offset:13312
    ds_read_b64_tr_b16 v[154:155], v236 offset:13568
    ds_read_b128 v[40:43], v227 offset:64
    ds_read_b128 v[44:47], v227 offset:96
    s_waitcnt lgkmcnt(15)
    v_mfma_f32_32x32x16_bf16 v[196:211], v[28:31], v[132:135], v[196:211]
    buffer_load_dwordx4 v[76:79], v225, s[84:87], s53 offen offset:384
    ds_read_b64_tr_b16 v[156:157], v236 offset:14336
    ds_read_b64_tr_b16 v[158:159], v236 offset:14592
    v_mfma_f32_32x32x16_bf16 v[164:179], v[136:139], v[28:31], v[164:179]
    buffer_load_dwordx4 v[80:83], v225, s[84:87], s50 offen offset:512
    ds_read_b64_tr_b16 v[160:161], v236 offset:12288
    ds_read_b64_tr_b16 v[162:163], v236 offset:12544
    s_waitcnt lgkmcnt(13)
    v_mfma_f32_32x32x16_bf16 a[0:15], v[240:243], v[140:143], 0
    buffer_load_dwordx4 v[84:87], v225, s[84:87], s51 offen offset:512
    ds_read_b64_tr_b16 v[128:129], v236 offset:16384
    ds_read_b64_tr_b16 v[130:131], v236 offset:16640
    v_mfma_f32_32x32x16_bf16 a[16:31], v[240:243], v[144:147], 0
    ds_read_b64_tr_b16 v[132:133], v236 offset:17408
    ds_read_b64_tr_b16 v[134:135], v236 offset:17664
    s_waitcnt lgkmcnt(10)
    v_mfma_f32_32x32x16_bf16 a[32:47], v[240:243], v[148:151], 0
    buffer_load_dwordx4 v[88:91], v225, s[84:87], s52 offen offset:512
    ds_read_b64_tr_b16 v[136:137], v236 offset:15360
    ds_read_b64_tr_b16 v[138:139], v236 offset:15616
    s_waitcnt lgkmcnt(15)
    v_dot2c_f32_bf16 v212, v32, v240
    v_dot2c_f32_bf16 v213, v32, v32
    v_dot2c_f32_bf16 v214, v33, v240
    v_dot2c_f32_bf16 v215, v33, v33
    v_dot2c_f32_bf16 v212, v34, v240
    v_dot2c_f32_bf16 v213, v34, v34
    v_dot2c_f32_bf16 v214, v35, v240
    v_dot2c_f32_bf16 v215, v35, v35
    buffer_load_dwordx4 v[92:95], v225, s[84:87], s53 offen offset:512
    s_waitcnt lgkmcnt(14)
    v_dot2c_f32_bf16 v212, v36, v240
    v_dot2c_f32_bf16 v213, v36, v36
    v_dot2c_f32_bf16 v214, v37, v240
    v_dot2c_f32_bf16 v215, v37, v37
    v_dot2c_f32_bf16 v212, v38, v240
    v_dot2c_f32_bf16 v213, v38, v38
    v_dot2c_f32_bf16 v214, v39, v240
    v_dot2c_f32_bf16 v215, v39, v39
    s_add_u32 m0, s71, 36864
    s_add_u32 s67, s70, 516096
    buffer_load_dwordx4 v224, s[80:83], s67 offen lds
    s_waitcnt lgkmcnt(11)
    v_dot2c_f32_bf16 v212, v40, v240
    v_dot2c_f32_bf16 v213, v40, v40
    v_dot2c_f32_bf16 v214, v41, v240
    v_dot2c_f32_bf16 v215, v41, v41
    v_dot2c_f32_bf16 v212, v42, v240
    v_dot2c_f32_bf16 v213, v42, v42
    v_dot2c_f32_bf16 v214, v43, v240
    v_dot2c_f32_bf16 v215, v43, v43
    s_waitcnt lgkmcnt(10)
    v_dot2c_f32_bf16 v212, v44, v240
    v_dot2c_f32_bf16 v213, v44, v44
    v_dot2c_f32_bf16 v214, v45, v240
    v_dot2c_f32_bf16 v215, v45, v45
    v_dot2c_f32_bf16 v212, v46, v240
    v_dot2c_f32_bf16 v213, v46, v46
    v_dot2c_f32_bf16 v214, v47, v240
    v_dot2c_f32_bf16 v215, v47, v47
    v_mfma_f32_32x32x16_bf16 v[180:195], v[152:155], v[32:35], v[180:195]
    ds_read_b64_tr_b16 v[140:141], v236 offset:19456
    ds_read_b64_tr_b16 v[142:143], v236 offset:19712
    s_waitcnt lgkmcnt(8)
    v_mfma_f32_32x32x16_bf16 v[196:211], v[32:35], v[156:159], v[196:211]
    ds_read_b64_tr_b16 v[144:145], v236 offset:20480
    ds_read_b64_tr_b16 v[146:147], v236 offset:20736
    v_mfma_f32_32x32x16_bf16 v[164:179], v[160:163], v[32:35], v[164:179]
    ds_read_b64_tr_b16 v[148:149], v236 offset:18432
    ds_read_b64_tr_b16 v[150:151], v236 offset:18688
    s_waitcnt lgkmcnt(8)
    v_mfma_f32_32x32x16_bf16 v[180:195], v[128:131], v[36:39], v[180:195]
    ds_read_b64_tr_b16 v[152:153], v236 offset:22528
    ds_read_b64_tr_b16 v[154:155], v236 offset:22784
    v_mfma_f32_32x32x16_bf16 v[196:211], v[36:39], v[132:135], v[196:211]
    s_add_u32 m0, s71, 37888
    s_add_u32 s67, s70, 516992
    buffer_load_dwordx4 v224, s[80:83], s67 offen lds
    ds_read_b64_tr_b16 v[156:157], v236 offset:23552
    ds_read_b64_tr_b16 v[158:159], v236 offset:23808
    s_waitcnt vmcnt(13)
    ds_write_b128 v226, v[48:51]
    s_waitcnt lgkmcnt(9)
    v_mfma_f32_32x32x16_bf16 v[164:179], v[136:139], v[36:39], v[164:179]
    ds_read_b64_tr_b16 v[160:161], v236 offset:21504
    ds_read_b64_tr_b16 v[162:163], v236 offset:21760
    ds_write_b128 v226, v[52:55] offset:1152
    v_mfma_f32_32x32x16_bf16 v[180:195], v[140:143], v[40:43], v[180:195]
    ds_read_b64_tr_b16 v[128:129], v238 offset:12288
    ds_read_b64_tr_b16 v[130:131], v238 offset:12544
    ds_write_b128 v226, v[56:59] offset:2304
    s_waitcnt lgkmcnt(11)
    v_mfma_f32_32x32x16_bf16 v[196:211], v[40:43], v[144:147], v[196:211]
    ds_read_b64_tr_b16 v[132:133], v238 offset:13312
    ds_read_b64_tr_b16 v[134:135], v238 offset:13568
    ds_write_b128 v226, v[60:63] offset:3456
    v_mfma_f32_32x32x16_bf16 v[164:179], v[148:151], v[40:43], v[164:179]
    s_add_u32 m0, s71, 38912
    s_add_u32 s67, s70, 517888
    buffer_load_dwordx4 v224, s[80:83], s67 offen lds
    ds_read_b64_tr_b16 v[136:137], v238 offset:14336
    ds_read_b64_tr_b16 v[138:139], v238 offset:14592
    ds_read_b128 v[48:51], v227
    ds_read_b128 v[52:55], v227 offset:32
    s_waitcnt lgkmcnt(14)
    v_mfma_f32_32x32x16_bf16 v[180:195], v[152:155], v[44:47], v[180:195]
    s_waitcnt vmcnt(11)
    s_barrier
    ds_read_b64_tr_b16 v[140:141], v236 offset:25600
    ds_read_b64_tr_b16 v[142:143], v236 offset:25856
    ds_read_b128 v[56:59], v227 offset:64
    ds_read_b128 v[60:63], v227 offset:96
    v_mfma_f32_32x32x16_bf16 v[196:211], v[44:47], v[156:159], v[196:211]
    ds_read_b64_tr_b16 v[144:145], v236 offset:26624
    ds_read_b64_tr_b16 v[146:147], v236 offset:26880
    s_waitcnt lgkmcnt(14)
    v_mfma_f32_32x32x16_bf16 v[164:179], v[160:163], v[44:47], v[164:179]
    buffer_load_dwordx4 v[96:99], v225, s[84:87], s50 offen offset:640
    ds_read_b64_tr_b16 v[148:149], v236 offset:24576
    ds_read_b64_tr_b16 v[150:151], v236 offset:24832
    v_mfma_f32_32x32x16_bf16 a[0:15], v[240:243], v[128:131], a[0:15]
    buffer_load_dwordx4 v[100:103], v225, s[84:87], s51 offen offset:640
    ds_read_b64_tr_b16 v[152:153], v236 offset:28672
    ds_read_b64_tr_b16 v[154:155], v236 offset:28928
    s_waitcnt lgkmcnt(12)
    v_mfma_f32_32x32x16_bf16 a[16:31], v[240:243], v[132:135], a[16:31]
    ds_read_b64_tr_b16 v[156:157], v236 offset:29696
    ds_read_b64_tr_b16 v[158:159], v236 offset:29952
    v_mfma_f32_32x32x16_bf16 a[32:47], v[240:243], v[136:139], a[32:47]
    buffer_load_dwordx4 v[104:107], v225, s[84:87], s52 offen offset:640
    ds_read_b64_tr_b16 v[160:161], v236 offset:27648
    ds_read_b64_tr_b16 v[162:163], v236 offset:27904
    s_waitcnt lgkmcnt(15)
    v_dot2c_f32_bf16 v212, v48, v240
    v_dot2c_f32_bf16 v213, v48, v48
    v_dot2c_f32_bf16 v214, v49, v240
    v_dot2c_f32_bf16 v215, v49, v49
    v_dot2c_f32_bf16 v212, v50, v240
    v_dot2c_f32_bf16 v213, v50, v50
    v_dot2c_f32_bf16 v214, v51, v240
    v_dot2c_f32_bf16 v215, v51, v51
    buffer_load_dwordx4 v[108:111], v225, s[84:87], s53 offen offset:640
    s_waitcnt lgkmcnt(14)
    v_dot2c_f32_bf16 v212, v52, v240
    v_dot2c_f32_bf16 v213, v52, v52
    v_dot2c_f32_bf16 v214, v53, v240
    v_dot2c_f32_bf16 v215, v53, v53
    v_dot2c_f32_bf16 v212, v54, v240
    v_dot2c_f32_bf16 v213, v54, v54
    v_dot2c_f32_bf16 v214, v55, v240
    v_dot2c_f32_bf16 v215, v55, v55
    buffer_load_dwordx4 v[112:115], v225, s[84:87], s50 offen offset:768
    s_waitcnt lgkmcnt(11)
    v_dot2c_f32_bf16 v212, v56, v240
    v_dot2c_f32_bf16 v213, v56, v56
    v_dot2c_f32_bf16 v214, v57, v240
    v_dot2c_f32_bf16 v215, v57, v57
    v_dot2c_f32_bf16 v212, v58, v240
    v_dot2c_f32_bf16 v213, v58, v58
    v_dot2c_f32_bf16 v214, v59, v240
    v_dot2c_f32_bf16 v215, v59, v59
    s_waitcnt lgkmcnt(10)
    v_dot2c_f32_bf16 v212, v60, v240
    v_dot2c_f32_bf16 v213, v60, v60
    v_dot2c_f32_bf16 v214, v61, v240
    v_dot2c_f32_bf16 v215, v61, v61
    v_dot2c_f32_bf16 v212, v62, v240
    v_dot2c_f32_bf16 v213, v62, v62
    v_dot2c_f32_bf16 v214, v63, v240
    v_dot2c_f32_bf16 v215, v63, v63
    buffer_load_dwordx4 v[116:119], v225, s[84:87], s51 offen offset:768
    s_waitcnt lgkmcnt(8)
    v_mfma_f32_32x32x16_bf16 v[180:195], v[140:143], v[48:51], v[180:195]
    ds_read_b64_tr_b16 v[128:129], v236 offset:31744
    ds_read_b64_tr_b16 v[130:131], v236 offset:32000
    v_mfma_f32_32x32x16_bf16 v[196:211], v[48:51], v[144:147], v[196:211]
    buffer_load_dwordx4 v[120:123], v225, s[84:87], s52 offen offset:768
    ds_read_b64_tr_b16 v[132:133], v236 offset:32768
    ds_read_b64_tr_b16 v[134:135], v236 offset:33024
    s_waitcnt vmcnt(14)
    ds_write_b128 v226, v[64:67]
    s_waitcnt lgkmcnt(9)
    v_mfma_f32_32x32x16_bf16 v[164:179], v[148:151], v[48:51], v[164:179]
    buffer_load_dwordx4 v[124:127], v225, s[84:87], s53 offen offset:768
    ds_read_b64_tr_b16 v[136:137], v236 offset:30720
    ds_read_b64_tr_b16 v[138:139], v236 offset:30976
    ds_write_b128 v226, v[68:71] offset:1152
    v_mfma_f32_32x32x16_bf16 v[180:195], v[152:155], v[52:55], v[180:195]
    s_add_u32 m0, s71, 49152
    s_add_u32 s67, s70, 688128
    buffer_load_dwordx4 v224, s[80:83], s67 offen lds
    ds_read_b64_tr_b16 v[140:141], v236 offset:34816
    ds_read_b64_tr_b16 v[142:143], v236 offset:35072
    ds_write_b128 v226, v[72:75] offset:2304
    s_waitcnt lgkmcnt(11)
    v_mfma_f32_32x32x16_bf16 v[196:211], v[52:55], v[156:159], v[196:211]
    ds_read_b64_tr_b16 v[144:145], v236 offset:35840
    ds_read_b64_tr_b16 v[146:147], v236 offset:36096
    ds_write_b128 v226, v[76:79] offset:3456
    v_mfma_f32_32x32x16_bf16 v[164:179], v[160:163], v[52:55], v[164:179]
    ds_read_b64_tr_b16 v[148:149], v236 offset:33792
    ds_read_b64_tr_b16 v[150:151], v236 offset:34048
    ds_read_b128 v[64:67], v227
    ds_read_b128 v[68:71], v227 offset:32
    s_waitcnt lgkmcnt(14)
    v_mfma_f32_32x32x16_bf16 v[180:195], v[128:131], v[56:59], v[180:195]
    ds_read_b64_tr_b16 v[152:153], v238 offset:24576
    ds_read_b64_tr_b16 v[154:155], v238 offset:24832
    ds_read_b128 v[72:75], v227 offset:64
    ds_read_b128 v[76:79], v227 offset:96
    v_mfma_f32_32x32x16_bf16 v[196:211], v[56:59], v[132:135], v[196:211]
    s_add_u32 m0, s71, 50176
    s_add_u32 s67, s70, 689024
    buffer_load_dwordx4 v224, s[80:83], s67 offen lds
    ds_read_b64_tr_b16 v[156:157], v238 offset:25600
    ds_read_b64_tr_b16 v[158:159], v238 offset:25856
    s_waitcnt vmcnt(13)
    ds_write_b128 v226, v[80:83]
    s_waitcnt lgkmcnt(15)
    v_mfma_f32_32x32x16_bf16 v[164:179], v[136:139], v[56:59], v[164:179]
    ds_read_b64_tr_b16 v[160:161], v238 offset:26624
    ds_read_b64_tr_b16 v[162:163], v238 offset:26880
    ds_write_b128 v226, v[84:87] offset:1152
    v_mfma_f32_32x32x16_bf16 v[180:195], v[140:143], v[60:63], v[180:195]
    s_add_u32 m0, s71, 51200
    s_add_u32 s67, s70, 689920
    buffer_load_dwordx4 v224, s[80:83], s67 offen lds
    s_waitcnt vmcnt(11)
    s_barrier
    ds_read_b64_tr_b16 v[128:129], v236 offset:37888
    ds_read_b64_tr_b16 v[130:131], v236 offset:38144
    ds_write_b128 v226, v[88:91] offset:2304
    s_waitcnt lgkmcnt(15)
    v_mfma_f32_32x32x16_bf16 v[196:211], v[60:63], v[144:147], v[196:211]
    ds_read_b64_tr_b16 v[132:133], v236 offset:38912
    ds_read_b64_tr_b16 v[134:135], v236 offset:39168
    ds_write_b128 v226, v[92:95] offset:3456
    v_mfma_f32_32x32x16_bf16 v[164:179], v[148:151], v[60:63], v[164:179]
    s_add_u32 m0, s71, 61440
    s_add_u32 s67, s70, 860160
    buffer_load_dwordx4 v224, s[80:83], s67 offen lds
    ds_read_b64_tr_b16 v[136:137], v236 offset:36864
    ds_read_b64_tr_b16 v[138:139], v236 offset:37120
    ds_read_b128 v[80:83], v227
    ds_read_b128 v[84:87], v227 offset:32
    s_waitcnt lgkmcnt(14)
    v_mfma_f32_32x32x16_bf16 a[0:15], v[240:243], v[152:155], a[0:15]
    ds_read_b64_tr_b16 v[140:141], v236 offset:40960
    ds_read_b64_tr_b16 v[142:143], v236 offset:41216
    ds_read_b128 v[88:91], v227 offset:64
    ds_read_b128 v[92:95], v227 offset:96
    v_mfma_f32_32x32x16_bf16 a[16:31], v[240:243], v[156:159], a[16:31]
    ds_read_b64_tr_b16 v[144:145], v236 offset:41984
    ds_read_b64_tr_b16 v[146:147], v236 offset:42240
    s_waitcnt lgkmcnt(14)
    v_mfma_f32_32x32x16_bf16 a[32:47], v[240:243], v[160:163], a[32:47]
    ds_read_b64_tr_b16 v[148:149], v236 offset:39936
    ds_read_b64_tr_b16 v[150:151], v236 offset:40192
    s_waitcnt lgkmcnt(15)
    v_dot2c_f32_bf16 v212, v64, v240
    v_dot2c_f32_bf16 v213, v64, v64
    v_dot2c_f32_bf16 v214, v65, v240
    v_dot2c_f32_bf16 v215, v65, v65
    v_dot2c_f32_bf16 v212, v66, v240
    v_dot2c_f32_bf16 v213, v66, v66
    v_dot2c_f32_bf16 v214, v67, v240
    v_dot2c_f32_bf16 v215, v67, v67
    s_add_u32 m0, s71, 62464
    s_add_u32 s67, s70, 861056
    buffer_load_dwordx4 v224, s[80:83], s67 offen lds
    s_waitcnt lgkmcnt(15)
    v_dot2c_f32_bf16 v212, v68, v240
    v_dot2c_f32_bf16 v213, v68, v68
    v_dot2c_f32_bf16 v214, v69, v240
    v_dot2c_f32_bf16 v215, v69, v69
    v_dot2c_f32_bf16 v212, v70, v240
    v_dot2c_f32_bf16 v213, v70, v70
    v_dot2c_f32_bf16 v214, v71, v240
    v_dot2c_f32_bf16 v215, v71, v71
    s_waitcnt lgkmcnt(15)
    v_dot2c_f32_bf16 v212, v72, v240
    v_dot2c_f32_bf16 v213, v72, v72
    v_dot2c_f32_bf16 v214, v73, v240
    v_dot2c_f32_bf16 v215, v73, v73
    v_dot2c_f32_bf16 v212, v74, v240
    v_dot2c_f32_bf16 v213, v74, v74
    v_dot2c_f32_bf16 v214, v75, v240
    v_dot2c_f32_bf16 v215, v75, v75
    s_waitcnt lgkmcnt(15)
    v_dot2c_f32_bf16 v212, v76, v240
    v_dot2c_f32_bf16 v213, v76, v76
    v_dot2c_f32_bf16 v214, v77, v240
    v_dot2c_f32_bf16 v215, v77, v77
    v_dot2c_f32_bf16 v212, v78, v240
    v_dot2c_f32_bf16 v213, v78, v78
    v_dot2c_f32_bf16 v214, v79, v240
    v_dot2c_f32_bf16 v215, v79, v79
    s_waitcnt lgkmcnt(9)
    v_dot2c_f32_bf16 v212, v80, v240
    v_dot2c_f32_bf16 v213, v80, v80
    v_dot2c_f32_bf16 v214, v81, v240
    v_dot2c_f32_bf16 v215, v81, v81
    v_dot2c_f32_bf16 v212, v82, v240
    v_dot2c_f32_bf16 v213, v82, v82
    v_dot2c_f32_bf16 v214, v83, v240
    v_dot2c_f32_bf16 v215, v83, v83
    s_waitcnt lgkmcnt(8)
    v_dot2c_f32_bf16 v212, v84, v240
    v_dot2c_f32_bf16 v213, v84, v84
    v_dot2c_f32_bf16 v214, v85, v240
    v_dot2c_f32_bf16 v215, v85, v85
    v_dot2c_f32_bf16 v212, v86, v240
    v_dot2c_f32_bf16 v213, v86, v86
    v_dot2c_f32_bf16 v214, v87, v240
    v_dot2c_f32_bf16 v215, v87, v87
    s_waitcnt lgkmcnt(5)
    v_dot2c_f32_bf16 v212, v88, v240
    v_dot2c_f32_bf16 v213, v88, v88
    v_dot2c_f32_bf16 v214, v89, v240
    v_dot2c_f32_bf16 v215, v89, v89
    v_dot2c_f32_bf16 v212, v90, v240
    v_dot2c_f32_bf16 v213, v90, v90
    v_dot2c_f32_bf16 v214, v91, v240
    v_dot2c_f32_bf16 v215, v91, v91
    s_waitcnt lgkmcnt(4)
    v_dot2c_f32_bf16 v212, v92, v240
    v_dot2c_f32_bf16 v213, v92, v92
    v_dot2c_f32_bf16 v214, v93, v240
    v_dot2c_f32_bf16 v215, v93, v93
    v_dot2c_f32_bf16 v212, v94, v240
    v_dot2c_f32_bf16 v213, v94, v94
    v_dot2c_f32_bf16 v214, v95, v240
    v_dot2c_f32_bf16 v215, v95, v95
    s_add_u32 m0, s71, 63488
    s_add_u32 s67, s70, 861952
    buffer_load_dwordx4 v224, s[80:83], s67 offen lds
    v_mfma_f32_32x32x16_bf16 v[180:195], v[128:131], v[64:67], v[180:195]
    ds_read_b64_tr_b16 v[152:153], v236 offset:44032
    ds_read_b64_tr_b16 v[154:155], v236 offset:44288
    s_waitcnt lgkmcnt(12)
    v_mfma_f32_32x32x16_bf16 v[196:211], v[64:67], v[132:135], v[196:211]
    ds_read_b64_tr_b16 v[156:157], v236 offset:45056
    ds_read_b64_tr_b16 v[158:159], v236 offset:45312
    s_waitcnt vmcnt(10)
    ds_write_b128 v226, v[96:99]
    v_mfma_f32_32x32x16_bf16 v[164:179], v[136:139], v[64:67], v[164:179]
    ds_read_b64_tr_b16 v[160:161], v236 offset:43008
    ds_read_b64_tr_b16 v[162:163], v236 offset:43264
    ds_write_b128 v226, v[100:103] offset:1152
    s_waitcnt lgkmcnt(10)
    v_mfma_f32_32x32x16_bf16 v[180:195], v[140:143], v[68:71], v[180:195]
    ds_read_b64_tr_b16 v[128:129], v236 offset:47104
    ds_read_b64_tr_b16 v[130:131], v236 offset:47360
    ds_write_b128 v226, v[104:107] offset:2304
    v_mfma_f32_32x32x16_bf16 v[196:211], v[68:71], v[144:147], v[196:211]
    s_add_u32 m0, s71, 73728
    s_add_u32 s67, s70, 1032192
    buffer_load_dwordx4 v224, s[80:83], s67 offen lds
    ds_read_b64_tr_b16 v[132:133], v236 offset:48128
    ds_read_b64_tr_b16 v[134:135], v236 offset:48384
    ds_write_b128 v226, v[108:111] offset:3456
    s_waitcnt lgkmcnt(12)
    v_mfma_f32_32x32x16_bf16 v[164:179], v[148:151], v[68:71], v[164:179]
    ds_read_b64_tr_b16 v[136:137], v236 offset:46080
    ds_read_b64_tr_b16 v[138:139], v236 offset:46336
    ds_read_b128 v[96:99], v227
    ds_read_b128 v[100:103], v227 offset:32
    v_mfma_f32_32x32x16_bf16 v[180:195], v[152:155], v[72:75], v[180:195]
    ds_read_b64_tr_b16 v[140:141], v238 offset:36864
    ds_read_b64_tr_b16 v[142:143], v238 offset:37120
    ds_read_b128 v[104:107], v227 offset:64
    ds_read_b128 v[108:111], v227 offset:96
    s_waitcnt lgkmcnt(15)
    v_mfma_f32_32x32x16_bf16 v[196:211], v[72:75], v[156:159], v[196:211]
    ds_read_b64_tr_b16 v[144:145], v238 offset:37888
    ds_read_b64_tr_b16 v[146:147], v238 offset:38144
    s_waitcnt vmcnt(7)
    ds_write_b128 v226, v[112:115]
    v_mfma_f32_32x32x16_bf16 v[164:179], v[160:163], v[72:75], v[164:179]
    s_add_u32 m0, s71, 74752
    s_add_u32 s67, s70, 1033088
    buffer_load_dwordx4 v224, s[80:83], s67 offen lds
    ds_read_b64_tr_b16 v[148:149], v238 offset:38912
    ds_read_b64_tr_b16 v[150:151], v238 offset:39168
    ds_write_b128 v226, v[116:119] offset:1152
    s_waitcnt lgkmcnt(15)
    v_mfma_f32_32x32x16_bf16 v[180:195], v[128:131], v[76:79], v[180:195]
    s_waitcnt vmcnt(5)
    s_barrier
    ds_read_b64_tr_b16 v[152:153], v237 offset:1024
    ds_read_b64_tr_b16 v[154:155], v237 offset:1280
    ds_write_b128 v226, v[120:123] offset:2304
    v_mfma_f32_32x32x16_bf16 v[196:211], v[76:79], v[132:135], v[196:211]
    ds_read_b64_tr_b16 v[156:157], v237 offset:2048
    ds_read_b64_tr_b16 v[158:159], v237 offset:2304
    ds_write_b128 v226, v[124:127] offset:3456
    s_waitcnt lgkmcnt(14)
    v_mfma_f32_32x32x16_bf16 v[164:179], v[136:139], v[76:79], v[164:179]
    s_add_u32 m0, s71, 75776
    s_add_u32 s67, s70, 1033984
    buffer_load_dwordx4 v224, s[80:83], s67 offen lds
    ds_read_b64_tr_b16 v[160:161], v237
    ds_read_b64_tr_b16 v[162:163], v237 offset:256
    ds_read_b128 v[112:115], v227
    ds_read_b128 v[116:119], v227 offset:32
    v_mfma_f32_32x32x16_bf16 a[0:15], v[240:243], v[140:143], a[0:15]
    ds_read_b64_tr_b16 v[128:129], v237 offset:4096
    ds_read_b64_tr_b16 v[130:131], v237 offset:4352
    ds_read_b128 v[120:123], v227 offset:64
    ds_read_b128 v[124:127], v227 offset:96
    s_waitcnt lgkmcnt(15)
    v_mfma_f32_32x32x16_bf16 a[16:31], v[240:243], v[144:147], a[16:31]
    ds_read_b64_tr_b16 v[132:133], v237 offset:5120
    ds_read_b64_tr_b16 v[134:135], v237 offset:5376
    v_mfma_f32_32x32x16_bf16 a[32:47], v[240:243], v[148:151], a[32:47]
    ds_read_b64_tr_b16 v[136:137], v237 offset:3072
    ds_read_b64_tr_b16 v[138:139], v237 offset:3328
    s_waitcnt lgkmcnt(15)
    v_dot2c_f32_bf16 v212, v96, v240
    v_dot2c_f32_bf16 v213, v96, v96
    v_dot2c_f32_bf16 v214, v97, v240
    v_dot2c_f32_bf16 v215, v97, v97
    v_dot2c_f32_bf16 v212, v98, v240
    v_dot2c_f32_bf16 v213, v98, v98
    v_dot2c_f32_bf16 v214, v99, v240
    v_dot2c_f32_bf16 v215, v99, v99
    s_mov_b64 exec, 1
    s_lshl_b32 s7, s2, 2
    s_add_u32 s7, s7, s3
    s_lshl_b32 s7, s7, 7
    s_add_u32 s7, s7, 1441792
    buffer_load_dword v9, off, s[8:11], s7 sc1
    s_lshl_b32 s7, s40, 7
    s_add_u32 s7, s7, 1572864
    buffer_load_dword v9, off, s[8:11], s7 sc1
    s_add_u32 s7, s7, 196608
    buffer_load_dword v9, off, s[8:11], s7 sc1
    buffer_load_dword v9, off, s[8:11], s41 sc1
    buffer_load_dword v9, off, s[8:11], s44 sc1
    s_mov_b64 exec, -1
    s_waitcnt lgkmcnt(15)
    v_dot2c_f32_bf16 v212, v100, v240
    v_dot2c_f32_bf16 v213, v100, v100
    v_dot2c_f32_bf16 v214, v101, v240
    v_dot2c_f32_bf16 v215, v101, v101
    v_dot2c_f32_bf16 v212, v102, v240
    v_dot2c_f32_bf16 v213, v102, v102
    v_dot2c_f32_bf16 v214, v103, v240
    v_dot2c_f32_bf16 v215, v103, v103
    s_add_u32 m0, s23, 0
    s_add_u32 s7, s22, 0
    s_mul_i32 s7, s7, s42
    buffer_load_dwordx4 v245, s[76:79], s7 offen lds
    s_add_u32 m0, s23, 1024
    s_add_u32 s7, s22, 8
    s_mul_i32 s7, s7, s42
    buffer_load_dwordx4 v245, s[76:79], s7 offen lds
    s_waitcnt lgkmcnt(15)
    v_dot2c_f32_bf16 v212, v104, v240
    v_dot2c_f32_bf16 v213, v104, v104
    v_dot2c_f32_bf16 v214, v105, v240
    v_dot2c_f32_bf16 v215, v105, v105
    v_dot2c_f32_bf16 v212, v106, v240
    v_dot2c_f32_bf16 v213, v106, v106
    v_dot2c_f32_bf16 v214, v107, v240
    v_dot2c_f32_bf16 v215, v107, v107
    s_add_u32 m0, s23, 2048
    s_add_u32 s7, s22, 16
    s_mul_i32 s7, s7, s42
    buffer_load_dwordx4 v245, s[76:79], s7 offen lds
    s_waitcnt lgkmcnt(15)
    v_dot2c_f32_bf16 v212, v108, v240
    v_dot2c_f32_bf16 v213, v108, v108
    v_dot2c_f32_bf16 v214, v109, v240
    v_dot2c_f32_bf16 v215, v109, v109
    v_dot2c_f32_bf16 v212, v110, v240
    v_dot2c_f32_bf16 v213, v110, v110
    v_dot2c_f32_bf16 v214, v111, v240
    v_dot2c_f32_bf16 v215, v111, v111
    s_add_u32 m0, s23, 3072
    s_add_u32 s7, s22, 24
    s_mul_i32 s7, s7, s42
    buffer_load_dwordx4 v246, s[76:79], s7 offen lds
    s_waitcnt lgkmcnt(9)
    v_dot2c_f32_bf16 v212, v112, v240
    v_dot2c_f32_bf16 v213, v112, v112
    v_dot2c_f32_bf16 v214, v113, v240
    v_dot2c_f32_bf16 v215, v113, v113
    v_dot2c_f32_bf16 v212, v114, v240
    v_dot2c_f32_bf16 v213, v114, v114
    v_dot2c_f32_bf16 v214, v115, v240
    v_dot2c_f32_bf16 v215, v115, v115
    s_add_u32 m0, s23, 4096
    s_add_u32 s22, s22, s39
    s_add_u32 s7, s22, 0
    s_mul_i32 s7, s7, s42
    buffer_load_dwordx4 v245, s[76:79], s7 offen lds
    s_waitcnt lgkmcnt(8)
    v_dot2c_f32_bf16 v212, v116, v240
    v_dot2c_f32_bf16 v213, v116, v116
    v_dot2c_f32_bf16 v214, v117, v240
    v_dot2c_f32_bf16 v215, v117, v117
    v_dot2c_f32_bf16 v212, v118, v240
    v_dot2c_f32_bf16 v213, v118, v118
    v_dot2c_f32_bf16 v214, v119, v240
    v_dot2c_f32_bf16 v215, v119, v119
    s_add_u32 m0, s23, 5120
    s_add_u32 s7, s22, 8
    s_mul_i32 s7, s7, s42
    buffer_load_dwordx4 v245, s[76:79], s7 offen lds
    s_waitcnt lgkmcnt(5)
    v_dot2c_f32_bf16 v212, v120, v240
    v_dot2c_f32_bf16 v213, v120, v120
    v_dot2c_f32_bf16 v214, v121, v240
    v_dot2c_f32_bf16 v215, v121, v121
    v_dot2c_f32_bf16 v212, v122, v240
    v_dot2c_f32_bf16 v213, v122, v122
    v_dot2c_f32_bf16 v214, v123, v240
    v_dot2c_f32_bf16 v215, v123, v123
    s_add_u32 m0, s23, 6144
    s_add_u32 s7, s22, 16
    s_mul_i32 s7, s7, s42
    buffer_load_dwordx4 v245, s[76:79], s7 offen lds
    s_waitcnt lgkmcnt(4)
    v_dot2c_f32_bf16 v212, v124, v240
    v_dot2c_f32_bf16 v213, v124, v124
    v_dot2c_f32_bf16 v214, v125, v240
    v_dot2c_f32_bf16 v215, v125, v125
    v_dot2c_f32_bf16 v212, v126, v240
    v_dot2c_f32_bf16 v213, v126, v126
    v_dot2c_f32_bf16 v214, v127, v240
    v_dot2c_f32_bf16 v215, v127, v127
    s_mov_b32 m0, s69
    s_add_u32 s7, s22, 24
    s_mul_i32 s7, s7, s42
    buffer_load_dwordx4 v247, s[76:79], s7 offen lds
    s_waitcnt lgkmcnt(13)
    v_mfma_f32_32x32x16_bf16 v[180:195], v[152:155], v[80:83], v[180:195]
    ds_read_b64_tr_b16 v[140:141], v237 offset:7168
    ds_read_b64_tr_b16 v[142:143], v237 offset:7424
    s_nop 2
    v_add_u32 v15, s38, v5
    v_mfma_f32_32x32x16_bf16 v[196:211], v[80:83], v[156:159], v[196:211]
    buffer_load_ushort v244, v244, s[72:75], 0 offen
    ds_read_b64_tr_b16 v[144:145], v237 offset:8192
    ds_read_b64_tr_b16 v[146:147], v237 offset:8448
    v_lshrrev_b32 v14, 5, v0
    v_lshl_add_u32 v14, v14, 4, s38
    s_waitcnt lgkmcnt(10)
    v_mfma_f32_32x32x16_bf16 v[164:179], v[160:163], v[80:83], v[164:179]
    ds_read_b64_tr_b16 v[148:149], v237 offset:6144
    ds_read_b64_tr_b16 v[150:151], v237 offset:6400
    v_add_f32 v212, v212, v214
    v_add_f32 v213, v213, v215
    v_mfma_f32_32x32x16_bf16 v[180:195], v[128:131], v[84:87], v[180:195]
    ds_read_b64_tr_b16 v[152:153], v237 offset:10240
    ds_read_b64_tr_b16 v[154:155], v237 offset:10496
    v_mov_b32 v214, v212
    v_mov_b32 v215, v213
    s_waitcnt lgkmcnt(8)
    v_mfma_f32_32x32x16_bf16 v[196:211], v[84:87], v[132:135], v[196:211]
    ds_read_b64_tr_b16 v[156:157], v237 offset:11264
    ds_read_b64_tr_b16 v[158:159], v237 offset:11520
    s_nop 0
    v_permlane32_swap_b32 v212, v214
    v_mfma_f32_32x32x16_bf16 v[164:179], v[136:139], v[84:87], v[164:179]
    ds_read_b64_tr_b16 v[160:161], v237 offset:9216
    ds_read_b64_tr_b16 v[162:163], v237 offset:9472
    v_permlane32_swap_b32 v213, v215
    v_add_f32 v212, v212, v214
    s_waitcnt lgkmcnt(8)
    v_mfma_f32_32x32x16_bf16 v[180:195], v[140:143], v[88:91], v[180:195]
    v_add_u32 v238, 49152, v238
    ds_read_b64_tr_b16 v[128:129], v238
    ds_read_b64_tr_b16 v[130:131], v238 offset:256
    v_add_f32 v213, v213, v215
    v_mul_f32 v214, 0xbb124925, v212
    v_mfma_f32_32x32x16_bf16 v[196:211], v[88:91], v[144:147], v[196:211]
    ds_read_b64_tr_b16 v[132:133], v238 offset:1024
    ds_read_b64_tr_b16 v[134:135], v238 offset:1280
    v_mul_f32 v215, 0x3b124925, v213
    v_fma_f32 v215, -v214, v214, v215
    s_waitcnt lgkmcnt(8)
    v_mfma_f32_32x32x16_bf16 v[164:179], v[148:151], v[88:91], v[164:179]
    ds_read_b64_tr_b16 v[136:137], v238 offset:2048
    ds_read_b64_tr_b16 v[138:139], v238 offset:2304
    v_max_f32 v215, 0, v215
    v_add_f32 v215, 0x3727c5ac, v215
    v_mfma_f32_32x32x16_bf16 v[180:195], v[152:155], v[92:95], v[180:195]
    s_waitcnt vmcnt(17)
    s_barrier
    ds_read_b64_tr_b16 v[140:141], v237 offset:13312
    ds_read_b64_tr_b16 v[142:143], v237 offset:13568
    v_rsq_f32 v232, v215
    v_cvt_pk_bf16_f32 v228, v214, v214
    s_waitcnt lgkmcnt(8)
    v_mfma_f32_32x32x16_bf16 v[196:211], v[92:95], v[156:159], v[196:211]
    ds_read_b64_tr_b16 v[144:145], v237 offset:14336
    ds_read_b64_tr_b16 v[146:147], v237 offset:14592
    v_mul_f32 v215, v215, v232
    v_and_b32 v216, 0xffff0000, v228
    v_mfma_f32_32x32x16_bf16 v[164:179], v[160:163], v[92:95], v[164:179]
    ds_read_b64_tr_b16 v[148:149], v237 offset:16384
    ds_read_b64_tr_b16 v[150:151], v237 offset:16640
    v_sub_f32 v216, v214, v216
    v_cvt_pk_bf16_f32 v229, v216, v215
    s_waitcnt lgkmcnt(8)
    v_mfma_f32_32x32x16_bf16 a[0:15], v[240:243], v[128:131], a[0:15]
    ds_read_b64_tr_b16 v[152:153], v237 offset:17408
    ds_read_b64_tr_b16 v[154:155], v237 offset:17664
    v_and_b32 v217, 0xffff0000, v229
    v_sub_f32 v217, v215, v217
    v_mfma_f32_32x32x16_bf16 a[16:31], v[240:243], v[132:135], a[16:31]
    ds_read_b64_tr_b16 v[156:157], v237 offset:19456
    ds_read_b64_tr_b16 v[158:159], v237 offset:19712
    v_mov_b32 v230, v228
    v_cvt_pk_bf16_f32 v231, v216, v217
    s_waitcnt lgkmcnt(8)
    v_mfma_f32_32x32x16_bf16 a[32:47], v[240:243], v[136:139], a[32:47]
    ds_read_b64_tr_b16 v[160:161], v237 offset:20480
    ds_read_b64_tr_b16 v[162:163], v237 offset:20736
    ds_write_b32 v15, v232
    ds_read_b128 v[16:19], v14
    v_mfma_f32_32x32x16_bf16 v[180:195], v[140:143], v[96:99], v[180:195]
    ds_read_b64_tr_b16 v[128:129], v237 offset:22528
    ds_read_b64_tr_b16 v[130:131], v237 offset:22784
    ds_read_b128 v[20:23], v14 offset:32
    ds_read_b128 v[24:27], v14 offset:64
    s_waitcnt lgkmcnt(12)
    v_mfma_f32_32x32x16_bf16 v[196:211], v[96:99], v[144:147], v[196:211]
    ds_read_b64_tr_b16 v[132:133], v237 offset:23552
    ds_read_b64_tr_b16 v[134:135], v237 offset:23808
    ds_read_b128 v[28:31], v14 offset:96
    v_mul_f32 v233, 0x3e8b97f6, v232
    v_mfma_f32_32x32x16_bf16 v[180:195], v[148:151], v[100:103], v[180:195]
    ds_read_b64_tr_b16 v[136:137], v238 offset:12288
    ds_read_b64_tr_b16 v[138:139], v238 offset:12544
    s_lshr_b32 s7, s3, 1
    s_lshl_b32 s7, s7, 9
    v_lshl_add_u32 v63, v5, 2, s7
    s_and_b32 s7, s3, 1
    s_lshl_b32 s7, s7, 3
    v_add_u32 v63, s7, v63
    s_waitcnt lgkmcnt(13)
    v_mfma_f32_32x32x16_bf16 v[196:211], v[100:103], v[152:155], v[196:211]
    ds_read_b64_tr_b16 v[140:141], v238 offset:13312
    ds_read_b64_tr_b16 v[142:143], v238 offset:13568
    v_add_u32 v63, 139776, v63
    v_and_b32 v60, 31, v0
    v_mfma_f32_32x32x16_bf16 v[180:195], v[156:159], v[104:107], v[180:195]
    ds_read_b64_tr_b16 v[144:145], v238 offset:14336
    ds_read_b64_tr_b16 v[146:147], v238 offset:14592
    v_subrev_u32 v60, 28, v60
    v_cmp_gt_u32 vcc, 3, v60
    s_waitcnt lgkmcnt(11)
    v_mfma_f32_32x32x16_bf16 v[196:211], v[104:107], v[160:163], v[196:211]
    s_waitcnt vmcnt(14)
    ds_read_b64_tr_b16 v[148:149], v238 offset:24576
    ds_read_b64_tr_b16 v[150:151], v238 offset:24832
    s_cmp_lt_u32 s3, 2
    s_cselect_b32 s7, 0x3f80, 0
    v_and_b32 v62, s7, v218
    v_mov_b32 v60, s7
    v_cndmask_b32 v61, 0, v60, vcc
    v_mfma_f32_32x32x16_bf16 v[180:195], v[128:131], v[108:111], v[180:195]
    ds_read_b64_tr_b16 v[152:153], v238 offset:25600
    ds_read_b64_tr_b16 v[154:155], v238 offset:25856
    v_mov_b32 v60, 0
    s_waitcnt lgkmcnt(8)
    v_mfma_f32_32x32x16_bf16 v[196:211], v[108:111], v[132:135], v[196:211]
    ds_read_b64_tr_b16 v[156:157], v238 offset:26624
    ds_read_b64_tr_b16 v[158:159], v238 offset:26880
    v_mfma_f32_32x32x16_bf16 a[0:15], v[240:243], v[136:139], a[0:15]
    s_barrier
    ds_read_b64_tr_b16 v[160:161], v237 offset:25600
    ds_read_b64_tr_b16 v[162:163], v237 offset:25856
    s_waitcnt lgkmcnt(8)
    v_mfma_f32_32x32x16_bf16 a[16:31], v[240:243], v[140:143], a[16:31]
    ds_read_b64_tr_b16 v[128:129], v237 offset:26624
    ds_read_b64_tr_b16 v[130:131], v237 offset:26880
    v_mfma_f32_32x32x16_bf16 a[32:47], v[240:243], v[144:147], a[32:47]
    ds_read_b64_tr_b16 v[132:133], v237 offset:28672
    ds_read_b64_tr_b16 v[134:135], v237 offset:28928
    s_waitcnt lgkmcnt(8)
    v_mfma_f32_32x32x16_bf16 a[0:15], v[240:243], v[148:151], a[0:15]
    ds_read_b64_tr_b16 v[136:137], v237 offset:29696
    ds_read_b64_tr_b16 v[138:139], v237 offset:29952
    v_mfma_f32_32x32x16_bf16 a[16:31], v[240:243], v[152:155], a[16:31]
    ds_read_b64_tr_b16 v[140:141], v237 offset:31744
    ds_read_b64_tr_b16 v[142:143], v237 offset:32000
    s_waitcnt lgkmcnt(8)
    v_mfma_f32_32x32x16_bf16 a[32:47], v[240:243], v[156:159], a[32:47]
    ds_read_b64_tr_b16 v[144:145], v237 offset:32768
    ds_read_b64_tr_b16 v[146:147], v237 offset:33024
    v_mfma_f32_32x32x16_bf16 v[180:195], v[160:163], v[112:115], v[180:195]
    ds_read_b64_tr_b16 v[148:149], v237 offset:34816
    ds_read_b64_tr_b16 v[150:151], v237 offset:35072
    s_waitcnt lgkmcnt(8)
    v_mfma_f32_32x32x16_bf16 v[196:211], v[112:115], v[128:131], v[196:211]
    ds_read_b64_tr_b16 v[152:153], v237 offset:35840
    ds_read_b64_tr_b16 v[154:155], v237 offset:36096
    v_mfma_f32_32x32x16_bf16 v[180:195], v[132:135], v[116:119], v[180:195]
    ds_read_b64_tr_b16 v[156:157], v237 offset:12288
    ds_read_b64_tr_b16 v[158:159], v237 offset:12544
    s_waitcnt lgkmcnt(8)
    v_mfma_f32_32x32x16_bf16 v[196:211], v[116:119], v[136:139], v[196:211]
    ds_read_b64_tr_b16 v[160:161], v237 offset:15360
    ds_read_b64_tr_b16 v[162:163], v237 offset:15616
    v_mfma_f32_32x32x16_bf16 v[180:195], v[140:143], v[120:123], v[180:195]
    ds_read_b64_tr_b16 v[128:129], v237 offset:18432
    ds_read_b64_tr_b16 v[130:131], v237 offset:18688
    v_accvgpr_read_b32 v34, a0
    v_cndmask_b32 v34, v34, 0, s[56:57]
    v_cvt_pk_bf16_f32 v33, v34, v34
    v_and_b32 v35, 0xffff0000, v33
    v_sub_f32 v34, v34, v35
    s_waitcnt lgkmcnt(8)
    v_mfma_f32_32x32x16_bf16 v[196:211], v[120:123], v[144:147], v[196:211]
    ds_read_b64_tr_b16 v[132:133], v237 offset:21504
    ds_read_b64_tr_b16 v[134:135], v237 offset:21760
    v_cvt_pk_bf16_f32 v32, v35, v34
    v_and_b32 v33, 0xffff, v33
    v_lshl_or_b32 v33, v60, 16, v33
    ds_write_b64 v63, v[32:33]
    v_accvgpr_read_b32 v38, a16
    v_mfma_f32_32x32x16_bf16 v[180:195], v[148:151], v[124:127], v[180:195]
    ds_read_b64_tr_b16 v[136:137], v237 offset:24576
    ds_read_b64_tr_b16 v[138:139], v237 offset:24832
    v_cndmask_b32 v38, v38, 0, s[56:57]
    v_cvt_pk_bf16_f32 v37, v38, v38
    v_and_b32 v39, 0xffff0000, v37
    v_sub_f32 v38, v38, v39
    v_cvt_pk_bf16_f32 v36, v39, v38
    s_waitcnt lgkmcnt(9)
    v_mfma_f32_32x32x16_bf16 v[196:211], v[124:127], v[152:155], v[196:211]
    ds_read_b64_tr_b16 v[140:141], v237 offset:27648
    ds_read_b64_tr_b16 v[142:143], v237 offset:27904
    v_and_b32 v37, 0xffff, v37
    v_lshl_or_b32 v37, v61, 16, v37
    ds_write_b64 v63, v[36:37] offset:7168
    v_accvgpr_read_b32 v42, a32
    v_cndmask_b32 v42, v42, 0, s[56:57]
    v_mfma_f32_32x32x16_bf16 v[164:179], v[156:159], v[96:99], v[164:179]
    ds_read_b64_tr_b16 v[144:145], v237 offset:30720
    ds_read_b64_tr_b16 v[146:147], v237 offset:30976
    v_cvt_pk_bf16_f32 v41, v42, v42
    v_and_b32 v43, 0xffff0000, v41
    v_sub_f32 v42, v42, v43
    v_cvt_pk_bf16_f32 v40, v43, v42
    v_and_b32 v41, 0xffff, v41
    s_waitcnt lgkmcnt(10)
    v_mfma_f32_32x32x16_bf16 v[164:179], v[160:163], v[100:103], v[164:179]
    ds_read_b64_tr_b16 v[148:149], v237 offset:33792
    ds_read_b64_tr_b16 v[150:151], v237 offset:34048
    v_lshl_or_b32 v41, v62, 16, v41
    ds_write_b64 v63, v[40:41] offset:14336
    s_waitcnt lgkmcnt(0)
    s_barrier
    ds_read_b128 a[240:243], v7 offset:25088
    ds_read_b128 a[244:247], v7 offset:32256
    v_mfma_f32_32x32x16_bf16 v[164:179], v[128:131], v[104:107], v[164:179]
    ds_read_b128 a[248:251], v7 offset:39424
    s_waitcnt lgkmcnt(11)
    v_mfma_f32_32x32x16_bf16 v[164:179], v[132:135], v[108:111], v[164:179]
    s_waitcnt lgkmcnt(0)
    v_mfma_f32_32x32x16_bf16 v[180:195], a[244:247], v[228:231], v[180:195]
    v_mfma_f32_32x32x16_bf16 v[196:211], v[228:231], a[248:251], v[196:211]
    v_mfma_f32_32x32x16_bf16 v[164:179], a[240:243], v[228:231], v[164:179]
    v_mfma_f32_32x32x16_bf16 v[164:179], v[136:139], v[112:115], v[164:179]
    s_nop 8
    v_mul_f32 v180, v180, v232
    v_mul_f32 v181, v181, v232
    v_mul_f32 v182, v182, v232
    v_mul_f32 v183, v183, v232
    v_mul_f32 v184, v184, v232
    s_waitcnt lgkmcnt(6)
    v_mfma_f32_32x32x16_bf16 v[164:179], v[140:143], v[116:119], v[164:179]
    v_mul_f32 v185, v185, v232
    v_mul_f32 v186, v186, v232
    v_mul_f32 v187, v187, v232
    v_cvt_pk_bf16_f32 v180, v180, v181
    v_cvt_pk_bf16_f32 v181, v182, v183
    v_mfma_f32_32x32x16_bf16 v[164:179], v[144:147], v[120:123], v[164:179]
    v_cvt_pk_bf16_f32 v182, v184, v185
    v_cvt_pk_bf16_f32 v183, v186, v187
    buffer_store_dwordx4 v[180:183], v1, s[8:11], s41 offen sc1
    v_mul_f32 v188, v188, v232
    v_mul_f32 v189, v189, v232
    s_waitcnt lgkmcnt(4)
    v_mfma_f32_32x32x16_bf16 v[164:179], v[148:151], v[124:127], v[164:179]
    v_mul_f32 v190, v190, v232
    v_mul_f32 v191, v191, v232
    v_mul_f32 v192, v192, v232
    v_mul_f32 v193, v193, v232
    v_mul_f32 v194, v194, v232
    v_mul_f32 v195, v195, v232
    v_cvt_pk_bf16_f32 v184, v188, v189
    v_cvt_pk_bf16_f32 v185, v190, v191
    v_cvt_pk_bf16_f32 v186, v192, v193
    v_cvt_pk_bf16_f32 v187, v194, v195
    v_cndmask_b32 v186, v186, v240, s[24:25]
    v_cndmask_b32 v187, v187, v235, s[24:25]
    buffer_store_dwordx4 v[184:187], v1, s[8:11], s41 offen offset:1024 sc1
    s_waitcnt lgkmcnt(15)
    v_mul_f32 v196, v196, v16
    v_mul_f32 v197, v197, v17
    v_mul_f32 v198, v198, v18
    v_mul_f32 v199, v199, v19
    v_mul_f32 v200, v200, v20
    v_mul_f32 v201, v201, v21
    v_mul_f32 v202, v202, v22
    v_mul_f32 v203, v203, v23
    v_cvt_pk_bf16_f32 v188, v196, v197
    v_cvt_pk_bf16_f32 v189, v198, v199
    v_cvt_pk_bf16_f32 v190, v200, v201
    v_cvt_pk_bf16_f32 v191, v202, v203
    v_cndmask_b32 v188, v188, v234, s[56:57]
    v_cndmask_b32 v189, v189, v234, s[56:57]
    v_cndmask_b32 v190, v190, v234, s[56:57]
    v_cndmask_b32 v191, v191, v234, s[56:57]
    buffer_store_dwordx4 v[188:191], v1, s[8:11], s41 offen offset:2048 sc1
    v_mul_f32 v204, v204, v24
    v_mul_f32 v205, v205, v25
    v_mul_f32 v206, v206, v26
    v_mul_f32 v207, v207, v27
    v_mul_f32 v208, v208, v28
    v_mul_f32 v209, v209, v29
    v_mul_f32 v210, v210, v30
    v_mul_f32 v211, v211, v31
    v_cvt_pk_bf16_f32 v192, v204, v205
    v_cvt_pk_bf16_f32 v193, v206, v207
    v_cvt_pk_bf16_f32 v194, v208, v209
    v_cvt_pk_bf16_f32 v195, v210, v211
    v_cndmask_b32 v192, v192, v234, s[56:57]
    v_cndmask_b32 v193, v193, v234, s[56:57]
    v_cndmask_b32 v194, v194, v234, s[56:57]
    v_cndmask_b32 v195, v195, v234, s[56:57]
    buffer_store_dwordx4 v[192:195], v1, s[8:11], s41 offen offset:3072 sc1
    v_mul_f32 v164, v164, v233
    v_mul_f32 v165, v165, v233
    v_mul_f32 v166, v166, v233
    v_mul_f32 v167, v167, v233
    v_mul_f32 v168, v168, v233
    v_mul_f32 v169, v169, v233
    v_mul_f32 v170, v170, v233
    v_mul_f32 v171, v171, v233
    v_cvt_pk_bf16_f32 v16, v164, v165
    v_cvt_pk_bf16_f32 v17, v166, v167
    v_cvt_pk_bf16_f32 v18, v168, v169
    v_cvt_pk_bf16_f32 v19, v170, v171
    ds_write_b128 v13, v[16:19]
    s_nop 0
    v_mfma_f32_32x32x16_bf16 v[112:127], v[180:183], v[16:19], 0
    v_mul_f32 v172, v172, v233
    v_mul_f32 v173, v173, v233
    v_mul_f32 v174, v174, v233
    v_mul_f32 v175, v175, v233
    v_mul_f32 v176, v176, v233
    v_mul_f32 v177, v177, v233
    v_mul_f32 v178, v178, v233
    v_mul_f32 v179, v179, v233
    v_cvt_pk_bf16_f32 v20, v172, v173
    v_cvt_pk_bf16_f32 v21, v174, v175
    v_cvt_pk_bf16_f32 v22, v176, v177
    v_cvt_pk_bf16_f32 v23, v178, v179
    v_cndmask_b32 v22, v22, 0, s[24:25]
    v_cndmask_b32 v23, v23, 0, s[24:25]
    s_lshl_b32 s22, s40, 7
    s_add_u32 s22, s22, 1572864
    s_lshl_b32 s39, s27, 13
    s_add_u32 s39, s39, 1572864
    v_mfma_f32_32x32x16_bf16 v[112:127], v[184:187], v[20:23], v[112:127]
    s_mul_i32 s51, s3, 28672
    s_add_u32 s50, s51, s35
    s_add_u32 s51, s51, 49152
    s_nop 8
    v_max_f32 v168, v112, v113
    v_max3_f32 v168, v114, v115, v168
    v_max3_f32 v168, v116, v117, v168
    v_max3_f32 v168, v118, v119, v168
    v_max3_f32 v168, v120, v121, v168
    v_max3_f32 v168, v122, v123, v168
    v_max3_f32 v168, v124, v125, v168
    v_max3_f32 v168, v126, v127, v168
    v_mov_b32 v128, v168
    s_nop 1
    v_permlane32_swap_b32 v168, v128
    v_max_f32 v168, v168, v128
    v_and_b32 v128, 0xffff0000, v168
    v_sub_f32 v132, v168, v128
    v_and_b32 v136, 0xffff0000, v132
    v_sub_f32 v132, v132, v136
    v_cvt_pk_bf16_f32 v128, -v128, -v136
    v_cvt_pk_bf16_f32 v132, -v132, 0
    v_cndmask_b32 v22, v22, v128, s[24:25]
    v_cndmask_b32 v23, v23, v132, s[24:25]
    ds_write_b128 v13, v[20:23] offset:1024
    v_mfma_f32_32x32x16_bf16 v[112:127], v[180:183], v[16:19], 0
    v_mfma_f32_32x32x16_bf16 v[112:127], v[184:187], v[20:23], v[112:127]
    s_waitcnt lgkmcnt(0) vmcnt(4)
    s_barrier
    ds_read_b128 v[24:27], v10
    ds_read_b128 v[28:31], v10 offset:1024
    ds_read_b128 v[32:35], v11
    ds_read_b128 v[36:39], v11 offset:1024
    ds_read_b128 v[40:43], v12
    ds_read_b128 v[44:47], v12 offset:1024
    s_mov_b64 exec, 1
    s_waitcnt vmcnt(0)
    buffer_store_dword v8, off, s[8:11], s22 sc1
    s_mov_b64 exec, -1
    s_cmp_eq_u32 s47, 4
    s_cbranch_scc1 J_DONE
    v_bfe_u32 v236, v0, 2, 2
    v_lshrrev_b32 v237, 5, v0
    v_lshl_add_u32 v236, v237, 2, v236
    s_cmp_eq_u32 s47, 0
    s_cselect_b32 s7, 6, 7
    v_lshlrev_b32 v236, s7, v236
    v_bfe_u32 v237, v0, 4, 1
    v_lshl_add_u32 v236, v237, 5, v236
    v_and_b32 v237, 3, v0
    v_lshl_add_u32 v236, v237, 3, v236
    s_cbranch_scc0 J_JOB
    s_and_b32 s53, s27, 1
    s_lshl_b32 s53, s53, 3
    s_add_u32 s7, s45, s53
    s_add_u32 s7, s7, 16384
    v_add_u32 v236, s7, v236
    ds_read_b64_tr_b16 v[196:197], v236
    ds_read_b64_tr_b16 v[198:199], v236 offset:512
    ds_read_b64_tr_b16 v[200:201], v236 offset:1024
    ds_read_b64_tr_b16 v[202:203], v236 offset:1536
    ds_read_b64_tr_b16 v[204:205], v236 offset:2048
    ds_read_b64_tr_b16 v[206:207], v236 offset:2560
    s_waitcnt lgkmcnt(0)
    s_mov_b32 exec_lo, 0xf0000000
    s_mov_b32 exec_hi, 0xf0000000
    v_mov_b64 v[196:197], 0
    v_mov_b64 v[198:199], 0
    v_mov_b64 v[200:201], 0
    v_mov_b64 v[202:203], 0
    v_mov_b64 v[204:205], 0
    v_mov_b64 v[206:207], 0
    s_mov_b64 exec, -1
    buffer_store_dwordx4 v[196:199], v1, s[8:11], s44 offen sc1
    buffer_store_dwordx4 v[200:203], v1, s[8:11], s44 offen offset:1024 sc1
    buffer_store_dwordx4 v[204:207], v1, s[8:11], s44 offen offset:2048 sc1
    s_branch J_DONE
J_JOB:
    s_cmp_eq_u32 s47, 3
    s_cselect_b32 s7, 8, 7
    s_lshl_b32 s7, s7, 11
    s_lshr_b32 s53, s3, 1
    s_mul_i32 s7, s7, s53
    s_and_b32 s53, s3, 1
    s_lshl_b32 s53, s53, 6
    s_add_u32 s7, s7, s53
    s_add_u32 s7, s7, 102400
    v_add_u32 v236, s7, v236
    ds_read_b64_tr_b16 v[196:197], v236
    ds_read_b64_tr_b16 v[198:199], v236 offset:1024
    ds_read_b64_tr_b16 v[200:201], v236 offset:2048
    ds_read_b64_tr_b16 v[202:203], v236 offset:3072
    ds_read_b64_tr_b16 v[204:205], v236 offset:4096
    ds_read_b64_tr_b16 v[206:207], v236 offset:5120
    ds_read_b64_tr_b16 v[208:209], v236 offset:6144
    ds_read_b64_tr_b16 v[210:211], v236 offset:7168
    ds_read_b64_tr_b16 v[212:213], v236 offset:8192
    ds_read_b64_tr_b16 v[214:215], v236 offset:9216
    ds_read_b64_tr_b16 v[216:217], v236 offset:10240
    ds_read_b64_tr_b16 v[218:219], v236 offset:11264
    ds_read_b64_tr_b16 v[220:221], v236 offset:12288
    ds_read_b64_tr_b16 v[222:223], v236 offset:13312
    ds_read_b64_tr_b16 v[224:225], v236 offset:14336
    ds_read_b64_tr_b16 v[226:227], v236 offset:15360
    s_waitcnt lgkmcnt(14)
    buffer_store_dwordx4 v[196:199], v1, s[8:11], s44 offen sc1
    s_add_u32 s44, s44, s45
    s_waitcnt lgkmcnt(12)
    buffer_store_dwordx4 v[200:203], v1, s[8:11], s44 offen sc1
    s_add_u32 s44, s44, s45
    s_waitcnt lgkmcnt(10)
    buffer_store_dwordx4 v[204:207], v1, s[8:11], s44 offen sc1
    s_add_u32 s44, s44, s45
    s_waitcnt lgkmcnt(8)
    buffer_store_dwordx4 v[208:211], v1, s[8:11], s44 offen sc1
    s_add_u32 s44, s44, s45
    s_waitcnt lgkmcnt(6)
    buffer_store_dwordx4 v[212:215], v1, s[8:11], s44 offen sc1
    s_add_u32 s44, s44, s45
    s_waitcnt lgkmcnt(4)
    buffer_store_dwordx4 v[216:219], v1, s[8:11], s44 offen sc1
    s_add_u32 s44, s44, s45
    s_waitcnt lgkmcnt(2)
    buffer_store_dwordx4 v[220:223], v1, s[8:11], s44 offen sc1
    s_add_u32 s44, s44, s45
    s_cmp_eq_u32 s47, 2
    s_cbranch_scc1 J_DONE
    s_cmp_eq_u32 s47, 1
    s_cbranch_scc1 J_W1
    s_waitcnt lgkmcnt(0)
    buffer_store_dwordx4 v[224:227], v1, s[8:11], s44 offen sc1
    s_branch J_DONE
J_W1:
    v_mfma_f32_32x32x16_bf16 v[128:143], v[240:243], v[196:199], 0
    v_mfma_f32_32x32x16_bf16 v[128:143], v[240:243], v[200:203], v[128:143]
    v_mfma_f32_32x32x16_bf16 v[128:143], v[240:243], v[204:207], v[128:143]
    v_mfma_f32_32x32x16_bf16 v[128:143], v[240:243], v[208:211], v[128:143]
    v_mfma_f32_32x32x16_bf16 v[128:143], v[240:243], v[212:215], v[128:143]
    v_mfma_f32_32x32x16_bf16 v[128:143], v[240:243], v[216:219], v[128:143]
    v_mfma_f32_32x32x16_bf16 v[128:143], v[240:243], v[220:223], v[128:143]
    s_cmp_eq_u32 s43, 0
    s_cselect_b32 s7, -1, 0
    v_and_b32 v244, s7, v244
    s_nop 8
    v_cvt_pk_bf16_f32 v239, v128, v128
    v_and_b32 v129, 0xffff0000, v239
    v_sub_f32 v128, v128, v129
    v_cvt_pk_bf16_f32 v238, v129, v128
    v_and_b32 v239, 0xffff, v239
    v_lshl_or_b32 v239, v244, 16, v239
    s_mov_b32 exec_hi, 0
    buffer_store_dwordx2 v[238:239], v3, s[8:11], s68 offen sc1
    s_mov_b32 exec_hi, -1
J_DONE:
    s_mov_b64 exec, 61440
    buffer_load_dword v173, v4, s[8:11], s39 offen sc1
    s_mov_b64 exec, -1
    s_waitcnt lgkmcnt(0)
    s_barrier
    v_lshrrev_b32 v232, 2, v0
    s_lshl_b32 s7, s30, 2
    v_add_u32 v233, s7, v232
    s_lshl_b32 s7, s32, 2
    s_add_u32 s7, s7, s3
    s_lshl_b32 s7, s7, 1
    s_add_u32 s7, s7, 52
    v_add_u32 v234, s7, v232
    v_cmp_lt_u32 vcc, 3, v232
    s_nop 1
    v_cndmask_b32 v233, v233, v234, vcc
    s_lshl_b32 s7, s32, 1
    s_lshr_b32 s45, s3, 1
    s_add_u32 s7, s7, s45
    s_add_u32 s7, s7, 112
    v_mov_b32 v234, s7
    v_cmp_lt_u32 vcc, 5, v232
    s_nop 1
    v_cndmask_b32 v233, v233, v234, vcc
    v_add_u32 v233, 0x80, v233
    v_cmp_lt_u32 vcc, 6, v232
    v_min_u32 v232, 13, v232
    s_lshl_b32 s7, s27, 3
    s_sub_u32 s7, s7, 7
    v_add_u32 v234, s7, v232
    v_cndmask_b32 v233, v233, v234, vcc
    v_and_b32 v234, 3, v0
    v_lshl_add_u32 v233, v233, 2, v234
    v_lshlrev_b32 v174, 7, v233
    s_mov_b32 s45, 1441792
    s_lshl_b32 s56, s2, 2
    s_add_u32 s56, s56, s3
    s_lshl_b32 s56, s56, 7
    s_add_u32 s56, s56, 1441792
    s_mov_b64 exec, 1
    s_waitcnt vmcnt(0)
    buffer_store_dword v8, off, s[8:11], s56 sc1
    s_mov_b64 exec, -1
    v_cmp_ne_u32 vcc, v8, v173
    s_nop 0
    s_and_b32 s7, vcc_lo, 61440
    s_cbranch_scc1 KSLOW0_1
KBACK0_1:
    v_lshrrev_b32 v176, 5, v0
    v_lshlrev_b32 v176, 9, v176
    v_lshl_add_u32 v176, v5, 1, v176
    s_add_u32 s47, s35, 114688
    v_and_b32 v177, 31, v0
    v_mul_u32_u24 v177, 896, v177
    v_lshrrev_b32 v178, 5, v0
    v_lshl_add_u32 v177, v178, 4, v177
    s_mul_i32 s44, s48, 28672
    s_lshl_b32 s7, s49, 6
    s_add_u32 s44, s44, s7
    s_xor_b32 s23, s41, 245760
    buffer_load_dwordx4 v[152:155], v1, s[8:11], s23 offen sc1
    buffer_load_dwordx4 v[156:159], v1, s[8:11], s23 offen offset:1024 sc1
    buffer_load_dwordx4 v[160:163], v1, s[8:11], s23 offen offset:2048 sc1
    buffer_load_dwordx4 v[164:167], v1, s[8:11], s23 offen offset:3072 sc1
    s_waitcnt lgkmcnt(0)
    s_lshl_b32 s38, s36, 4
    s_add_u32 s38, s38, s27
    s_lshl_b32 s20, s38, 11
    s_add_u32 s20, s20, 4194304
    s_lshl_b32 s22, s38, 2
    s_add_u32 s22, s22, 1703936
    v_mfma_f32_32x32x16_bf16 v[128:143], v[180:183], v[24:27], 0
    s_xor_b32 s23, s41, 229376
    buffer_load_dwordx4 v[196:199], v1, s[8:11], s23 offen sc1
    buffer_load_dwordx4 v[200:203], v1, s[8:11], s23 offen offset:1024 sc1
    buffer_load_dwordx4 v[204:207], v1, s[8:11], s23 offen offset:2048 sc1
    buffer_load_dwordx4 v[208:211], v1, s[8:11], s23 offen offset:3072 sc1
    v_exp_f32 v112, v112
    v_exp_f32 v113, v113
    v_exp_f32 v114, v114
    v_exp_f32 v115, v115
    v_mfma_f32_32x32x16_bf16 v[128:143], v[184:187], v[28:31], v[128:143]
    v_cvt_pk_bf16_f32 v144, v112, v113
    v_cvt_pk_bf16_f32 v145, v114, v115
    v_exp_f32 v116, v116
    v_exp_f32 v117, v117
    v_exp_f32 v118, v118
    v_exp_f32 v119, v119
    v_cvt_pk_bf16_f32 v146, v116, v117
    v_cvt_pk_bf16_f32 v147, v118, v119
    v_exp_f32 v120, v120
    v_exp_f32 v121, v121
    v_exp_f32 v122, v122
    v_exp_f32 v123, v123
    v_mfma_f32_32x32x16_bf16 v[48:63], v[188:191], v[144:147], 0
    v_cvt_pk_bf16_f32 v148, v120, v121
    v_cvt_pk_bf16_f32 v149, v122, v123
    v_exp_f32 v124, v124
    v_exp_f32 v125, v125
    v_exp_f32 v126, v126
    v_exp_f32 v127, v127
    v_cvt_pk_bf16_f32 v150, v124, v125
    v_cvt_pk_bf16_f32 v151, v126, v127
    v_mfma_f32_32x32x16_bf16 v[112:127], v[180:183], v[32:35], 0
    s_xor_b32 s23, s41, 212992
    buffer_load_dwordx4 v[212:215], v1, s[8:11], s23 offen sc1
    buffer_load_dwordx4 v[216:219], v1, s[8:11], s23 offen offset:1024 sc1
    buffer_load_dwordx4 v[220:223], v1, s[8:11], s23 offen offset:2048 sc1
    buffer_load_dwordx4 v[224:227], v1, s[8:11], s23 offen offset:3072 sc1
    v_exp_f32 v128, v128
    v_exp_f32 v129, v129
    v_exp_f32 v130, v130
    v_exp_f32 v131, v131
    v_mfma_f32_32x32x16_bf16 v[112:127], v[184:187], v[36:39], v[112:127]
    s_mov_b64 exec, 3840
    buffer_load_dword v173, v4, s[8:11], s39 offen sc1
    s_mov_b64 exec, -1
    v_cvt_pk_bf16_f32 v144, v128, v129
    v_cvt_pk_bf16_f32 v145, v130, v131
    v_exp_f32 v132, v132
    v_exp_f32 v133, v133
    v_exp_f32 v134, v134
    v_exp_f32 v135, v135
    v_mfma_f32_32x32x16_bf16 v[48:63], v[192:195], v[148:151], v[48:63]
    v_cvt_pk_bf16_f32 v146, v132, v133
    v_cvt_pk_bf16_f32 v147, v134, v135
    v_exp_f32 v136, v136
    v_exp_f32 v137, v137
    v_exp_f32 v138, v138
    v_exp_f32 v139, v139
    v_mfma_f32_32x32x16_bf16 v[64:79], v[188:191], v[144:147], 0
    v_cvt_pk_bf16_f32 v148, v136, v137
    v_cvt_pk_bf16_f32 v149, v138, v139
    v_exp_f32 v140, v140
    v_exp_f32 v141, v141
    v_exp_f32 v142, v142
    v_exp_f32 v143, v143
    v_cvt_pk_bf16_f32 v150, v140, v141
    v_cvt_pk_bf16_f32 v151, v142, v143
    v_mfma_f32_32x32x16_bf16 v[128:143], v[180:183], v[40:43], 0
    s_lshl_b32 s56, s5, 5
    s_add_u32 s56, s56, s3
    s_lshl_b32 s56, s56, 2
    s_add_u32 s56, s56, s55
    v_mov_b32 v9, s54
    s_mov_b64 exec, 1
    buffer_store_dword v9, off, s[8:11], s56 sc1
    s_mov_b64 exec, -1
    v_exp_f32 v112, v112
    v_exp_f32 v113, v113
    v_exp_f32 v114, v114
    v_exp_f32 v115, v115
    v_mfma_f32_32x32x16_bf16 v[128:143], v[184:187], v[44:47], v[128:143]
    v_cvt_pk_bf16_f32 v144, v112, v113
    v_cvt_pk_bf16_f32 v145, v114, v115
    v_exp_f32 v116, v116
    v_exp_f32 v117, v117
    v_exp_f32 v118, v118
    v_exp_f32 v119, v119
    v_mfma_f32_32x32x16_bf16 v[64:79], v[192:195], v[148:151], v[64:79]
    v_cvt_pk_bf16_f32 v146, v116, v117
    v_cvt_pk_bf16_f32 v147, v118, v119
    v_exp_f32 v120, v120
    v_exp_f32 v121, v121
    v_exp_f32 v122, v122
    v_exp_f32 v123, v123
    v_mfma_f32_32x32x16_bf16 v[80:95], v[188:191], v[144:147], 0
    v_cvt_pk_bf16_f32 v148, v120, v121
    v_cvt_pk_bf16_f32 v149, v122, v123
    v_exp_f32 v124, v124
    v_exp_f32 v125, v125
    v_exp_f32 v126, v126
    v_exp_f32 v127, v127
    v_cvt_pk_bf16_f32 v150, v124, v125
    v_cvt_pk_bf16_f32 v151, v126, v127
    s_waitcnt vmcnt(12)
    v_mfma_f32_32x32x16_bf16 v[112:127], v[152:155], v[16:19], 0
    v_exp_f32 v128, v128
    v_exp_f32 v129, v129
    v_exp_f32 v130, v130
    v_exp_f32 v131, v131
    v_mfma_f32_32x32x16_bf16 v[112:127], v[156:159], v[20:23], v[112:127]
    v_cvt_pk_bf16_f32 v144, v128, v129
    v_cvt_pk_bf16_f32 v145, v130, v131
    v_exp_f32 v132, v132
    v_exp_f32 v133, v133
    v_exp_f32 v134, v134
    v_exp_f32 v135, v135
    v_mfma_f32_32x32x16_bf16 v[80:95], v[192:195], v[148:151], v[80:95]
    v_cvt_pk_bf16_f32 v146, v132, v133
    v_cvt_pk_bf16_f32 v147, v134, v135
    v_exp_f32 v136, v136
    v_exp_f32 v137, v137
    v_exp_f32 v138, v138
    v_exp_f32 v139, v139
    v_mfma_f32_32x32x16_bf16 v[96:111], v[188:191], v[144:147], 0
    v_cvt_pk_bf16_f32 v148, v136, v137
    v_cvt_pk_bf16_f32 v149, v138, v139
    v_exp_f32 v140, v140
    v_exp_f32 v141, v141
    v_exp_f32 v142, v142
    v_exp_f32 v143, v143
    v_cvt_pk_bf16_f32 v150, v140, v141
    v_cvt_pk_bf16_f32 v151, v142, v143
    s_waitcnt vmcnt(10)
    v_mfma_f32_32x32x16_bf16 v[128:143], v[152:155], v[24:27], 0
    v_exp_f32 v112, v112
    v_exp_f32 v113, v113
    v_exp_f32 v114, v114
    v_exp_f32 v115, v115
    v_mfma_f32_32x32x16_bf16 v[128:143], v[156:159], v[28:31], v[128:143]
    s_xor_b32 s23, s41, 196608
    v_cvt_pk_bf16_f32 v144, v112, v113
    v_cvt_pk_bf16_f32 v145, v114, v115
    v_exp_f32 v116, v116
    v_exp_f32 v117, v117
    v_exp_f32 v118, v118
    v_exp_f32 v119, v119
    v_mfma_f32_32x32x16_bf16 v[96:111], v[192:195], v[148:151], v[96:111]
    buffer_load_dwordx4 v[180:183], v1, s[8:11], s23 offen sc1
    buffer_load_dwordx4 v[184:187], v1, s[8:11], s23 offen offset:1024 sc1
    buffer_load_dwordx4 v[188:191], v1, s[8:11], s23 offen offset:2048 sc1
    buffer_load_dwordx4 v[192:195], v1, s[8:11], s23 offen offset:3072 sc1
    v_cvt_pk_bf16_f32 v146, v116, v117
    v_cvt_pk_bf16_f32 v147, v118, v119
    v_exp_f32 v120, v120
    v_exp_f32 v121, v121
    v_exp_f32 v122, v122
    v_exp_f32 v123, v123
    v_mfma_f32_32x32x16_bf16 v[48:63], v[160:163], v[144:147], v[48:63]
    v_cvt_pk_bf16_f32 v148, v120, v121
    v_cvt_pk_bf16_f32 v149, v122, v123
    v_exp_f32 v124, v124
    v_exp_f32 v125, v125
    v_exp_f32 v126, v126
    v_exp_f32 v127, v127
    v_cvt_pk_bf16_f32 v150, v124, v125
    v_cvt_pk_bf16_f32 v151, v126, v127
    v_mfma_f32_32x32x16_bf16 v[112:127], v[152:155], v[32:35], 0
    buffer_load_dword v175, v174, s[8:11], s45 offen sc1
    v_exp_f32 v128, v128
    v_exp_f32 v129, v129
    v_exp_f32 v130, v130
    v_exp_f32 v131, v131
    v_mfma_f32_32x32x16_bf16 v[112:127], v[156:159], v[36:39], v[112:127]
    v_cvt_pk_bf16_f32 v144, v128, v129
    v_cvt_pk_bf16_f32 v145, v130, v131
    v_exp_f32 v132, v132
    v_exp_f32 v133, v133
    v_exp_f32 v134, v134
    v_exp_f32 v135, v135
    v_mfma_f32_32x32x16_bf16 v[48:63], v[164:167], v[148:151], v[48:63]
    v_cvt_pk_bf16_f32 v146, v132, v133
    v_cvt_pk_bf16_f32 v147, v134, v135
    v_exp_f32 v136, v136
    v_exp_f32 v137, v137
    v_exp_f32 v138, v138
    v_exp_f32 v139, v139
    v_mfma_f32_32x32x16_bf16 v[64:79], v[160:163], v[144:147], v[64:79]
    v_cvt_pk_bf16_f32 v148, v136, v137
    v_cvt_pk_bf16_f32 v149, v138, v139
    v_exp_f32 v140, v140
    v_exp_f32 v141, v141
    v_exp_f32 v142, v142
    v_exp_f32 v143, v143
    v_cvt_pk_bf16_f32 v150, v140, v141
    v_cvt_pk_bf16_f32 v151, v142, v143
    v_mfma_f32_32x32x16_bf16 v[128:143], v[152:155], v[40:43], 0
    buffer_load_dwordx4 v[248:251], v177, s[84:87], s44 offen
    buffer_load_dwordx4 v[252:255], v177, s[84:87], s44 offen offset:32
    v_exp_f32 v112, v112
    v_exp_f32 v113, v113
    v_exp_f32 v114, v114
    v_exp_f32 v115, v115
    v_mfma_f32_32x32x16_bf16 v[128:143], v[156:159], v[44:47], v[128:143]
    v_cvt_pk_bf16_f32 v144, v112, v113
    v_cvt_pk_bf16_f32 v145, v114, v115
    v_exp_f32 v116, v116
    v_exp_f32 v117, v117
    v_exp_f32 v118, v118
    v_exp_f32 v119, v119
    v_mfma_f32_32x32x16_bf16 v[64:79], v[164:167], v[148:151], v[64:79]
    v_cvt_pk_bf16_f32 v146, v116, v117
    v_cvt_pk_bf16_f32 v147, v118, v119
    v_exp_f32 v120, v120
    v_exp_f32 v121, v121
    v_exp_f32 v122, v122
    v_exp_f32 v123, v123
    v_mfma_f32_32x32x16_bf16 v[80:95], v[160:163], v[144:147], v[80:95]
    v_cvt_pk_bf16_f32 v148, v120, v121
    v_cvt_pk_bf16_f32 v149, v122, v123
    v_exp_f32 v124, v124
    v_exp_f32 v125, v125
    v_exp_f32 v126, v126
    v_exp_f32 v127, v127
    v_cvt_pk_bf16_f32 v150, v124, v125
    v_cvt_pk_bf16_f32 v151, v126, v127
    s_waitcnt vmcnt(13)
    v_mfma_f32_32x32x16_bf16 v[112:127], v[196:199], v[16:19], 0
    v_exp_f32 v128, v128
    v_exp_f32 v129, v129
    v_exp_f32 v130, v130
    v_exp_f32 v131, v131
    v_mfma_f32_32x32x16_bf16 v[112:127], v[200:203], v[20:23], v[112:127]
    s_waitcnt vmcnt(8)
    v_cmp_ne_u32 vcc, v8, v173
    s_nop 0
    s_and_b32 s7, vcc_lo, 3840
    s_cbranch_scc1 KSLOW0_5
KBACK0_5:
    v_cvt_pk_bf16_f32 v144, v128, v129
    v_cvt_pk_bf16_f32 v145, v130, v131
    v_exp_f32 v132, v132
    v_exp_f32 v133, v133
    v_exp_f32 v134, v134
    v_exp_f32 v135, v135
    v_mfma_f32_32x32x16_bf16 v[80:95], v[164:167], v[148:151], v[80:95]
    v_cvt_pk_bf16_f32 v146, v132, v133
    v_cvt_pk_bf16_f32 v147, v134, v135
    v_exp_f32 v136, v136
    v_exp_f32 v137, v137
    v_exp_f32 v138, v138
    v_exp_f32 v139, v139
    v_mfma_f32_32x32x16_bf16 v[96:111], v[160:163], v[144:147], v[96:111]
    v_cvt_pk_bf16_f32 v148, v136, v137
    v_cvt_pk_bf16_f32 v149, v138, v139
    v_exp_f32 v140, v140
    v_exp_f32 v141, v141
    v_exp_f32 v142, v142
    v_exp_f32 v143, v143
    v_cvt_pk_bf16_f32 v150, v140, v141
    v_cvt_pk_bf16_f32 v151, v142, v143
    v_mfma_f32_32x32x16_bf16 v[128:143], v[196:199], v[24:27], 0
    v_exp_f32 v112, v112
    v_exp_f32 v113, v113
    v_exp_f32 v114, v114
    v_exp_f32 v115, v115
    v_mfma_f32_32x32x16_bf16 v[128:143], v[200:203], v[28:31], v[128:143]
    s_xor_b32 s23, s41, 180224
    v_cvt_pk_bf16_f32 v144, v112, v113
    v_cvt_pk_bf16_f32 v145, v114, v115
    v_exp_f32 v116, v116
    v_exp_f32 v117, v117
    v_exp_f32 v118, v118
    v_exp_f32 v119, v119
    v_mfma_f32_32x32x16_bf16 v[96:111], v[164:167], v[148:151], v[96:111]
    buffer_load_dwordx4 v[152:155], v1, s[8:11], s23 offen sc1
    buffer_load_dwordx4 v[156:159], v1, s[8:11], s23 offen offset:1024 sc1
    buffer_load_dwordx4 v[160:163], v1, s[8:11], s23 offen offset:2048 sc1
    buffer_load_dwordx4 v[164:167], v1, s[8:11], s23 offen offset:3072 sc1
    v_cvt_pk_bf16_f32 v146, v116, v117
    v_cvt_pk_bf16_f32 v147, v118, v119
    v_exp_f32 v120, v120
    v_exp_f32 v121, v121
    v_exp_f32 v122, v122
    v_exp_f32 v123, v123
    v_mfma_f32_32x32x16_bf16 v[48:63], v[204:207], v[144:147], v[48:63]
    v_cvt_pk_bf16_f32 v148, v120, v121
    v_cvt_pk_bf16_f32 v149, v122, v123
    v_exp_f32 v124, v124
    v_exp_f32 v125, v125
    v_exp_f32 v126, v126
    v_exp_f32 v127, v127
    v_cvt_pk_bf16_f32 v150, v124, v125
    v_cvt_pk_bf16_f32 v151, v126, v127
    v_mfma_f32_32x32x16_bf16 v[112:127], v[196:199], v[32:35], 0
    v_exp_f32 v128, v128
    v_exp_f32 v129, v129
    v_exp_f32 v130, v130
    v_exp_f32 v131, v131
    v_mfma_f32_32x32x16_bf16 v[112:127], v[200:203], v[36:39], v[112:127]
    v_cvt_pk_bf16_f32 v144, v128, v129
    v_cvt_pk_bf16_f32 v145, v130, v131
    v_exp_f32 v132, v132
    v_exp_f32 v133, v133
    v_exp_f32 v134, v134
    v_exp_f32 v135, v135
    v_mfma_f32_32x32x16_bf16 v[48:63], v[208:211], v[148:151], v[48:63]
    v_cvt_pk_bf16_f32 v146, v132, v133
    v_cvt_pk_bf16_f32 v147, v134, v135
    v_exp_f32 v136, v136
    v_exp_f32 v137, v137
    v_exp_f32 v138, v138
    v_exp_f32 v139, v139
    v_mfma_f32_32x32x16_bf16 v[64:79], v[204:207], v[144:147], v[64:79]
    v_cvt_pk_bf16_f32 v148, v136, v137
    v_cvt_pk_bf16_f32 v149, v138, v139
    v_exp_f32 v140, v140
    v_exp_f32 v141, v141
    v_exp_f32 v142, v142
    v_exp_f32 v143, v143
    v_cvt_pk_bf16_f32 v150, v140, v141
    v_cvt_pk_bf16_f32 v151, v142, v143
    v_mfma_f32_32x32x16_bf16 v[128:143], v[196:199], v[40:43], 0
    v_exp_f32 v112, v112
    v_exp_f32 v113, v113
    v_exp_f32 v114, v114
    v_exp_f32 v115, v115
    v_mfma_f32_32x32x16_bf16 v[128:143], v[200:203], v[44:47], v[128:143]
    v_cvt_pk_bf16_f32 v144, v112, v113
    v_cvt_pk_bf16_f32 v145, v114, v115
    v_exp_f32 v116, v116
    v_exp_f32 v117, v117
    v_exp_f32 v118, v118
    v_exp_f32 v119, v119
    v_mfma_f32_32x32x16_bf16 v[64:79], v[208:211], v[148:151], v[64:79]
    v_cvt_pk_bf16_f32 v146, v116, v117
    v_cvt_pk_bf16_f32 v147, v118, v119
    v_exp_f32 v120, v120
    v_exp_f32 v121, v121
    v_exp_f32 v122, v122
    v_exp_f32 v123, v123
    v_mfma_f32_32x32x16_bf16 v[80:95], v[204:207], v[144:147], v[80:95]
    v_cvt_pk_bf16_f32 v148, v120, v121
    v_cvt_pk_bf16_f32 v149, v122, v123
    v_exp_f32 v124, v124
    v_exp_f32 v125, v125
    v_exp_f32 v126, v126
    v_exp_f32 v127, v127
    v_cvt_pk_bf16_f32 v150, v124, v125
    v_cvt_pk_bf16_f32 v151, v126, v127
    s_waitcnt vmcnt(13)
    v_mfma_f32_32x32x16_bf16 v[112:127], v[212:215], v[16:19], 0
    v_exp_f32 v128, v128
    v_exp_f32 v129, v129
    v_exp_f32 v130, v130
    v_exp_f32 v131, v131
    v_mfma_f32_32x32x16_bf16 v[112:127], v[216:219], v[20:23], v[112:127]
    v_cvt_pk_bf16_f32 v144, v128, v129
    v_cvt_pk_bf16_f32 v145, v130, v131
    v_exp_f32 v132, v132
    v_exp_f32 v133, v133
    v_exp_f32 v134, v134
    v_exp_f32 v135, v135
    v_mfma_f32_32x32x16_bf16 v[80:95], v[208:211], v[148:151], v[80:95]
    v_cvt_pk_bf16_f32 v146, v132, v133
    v_cvt_pk_bf16_f32 v147, v134, v135
    v_exp_f32 v136, v136
    v_exp_f32 v137, v137
    v_exp_f32 v138, v138
    v_exp_f32 v139, v139
    v_mfma_f32_32x32x16_bf16 v[96:111], v[204:207], v[144:147], v[96:111]
    s_waitcnt vmcnt(6)
    v_cmp_eq_u32 vcc, v8, v175
    s_nop 0
    s_cmp_eq_u64 vcc, -1
    s_cbranch_scc0 PSLOW
PBACK:
    v_cvt_pk_bf16_f32 v148, v136, v137
    v_cvt_pk_bf16_f32 v149, v138, v139
    v_exp_f32 v140, v140
    v_exp_f32 v141, v141
    v_exp_f32 v142, v142
    v_exp_f32 v143, v143
    v_cvt_pk_bf16_f32 v150, v140, v141
    v_cvt_pk_bf16_f32 v151, v142, v143
    v_mfma_f32_32x32x16_bf16 v[128:143], v[212:215], v[24:27], 0
    v_exp_f32 v112, v112
    v_exp_f32 v113, v113
    v_exp_f32 v114, v114
    v_exp_f32 v115, v115
    v_mfma_f32_32x32x16_bf16 v[128:143], v[216:219], v[28:31], v[128:143]
    s_xor_b32 s23, s41, 163840
    v_cvt_pk_bf16_f32 v144, v112, v113
    v_cvt_pk_bf16_f32 v145, v114, v115
    v_exp_f32 v116, v116
    v_exp_f32 v117, v117
    v_exp_f32 v118, v118
    v_exp_f32 v119, v119
    v_mfma_f32_32x32x16_bf16 v[96:111], v[208:211], v[148:151], v[96:111]
    buffer_load_dwordx4 v[196:199], v1, s[8:11], s23 offen sc1
    buffer_load_dwordx4 v[200:203], v1, s[8:11], s23 offen offset:1024 sc1
    buffer_load_dwordx4 v[204:207], v1, s[8:11], s23 offen offset:2048 sc1
    buffer_load_dwordx4 v[208:211], v1, s[8:11], s23 offen offset:3072 sc1
    s_mov_b32 s52, s50
    s_add_u32 m0, s51, 0
    s_nop 0
    buffer_load_dwordx4 v1, s[8:11], s52 offen sc1 lds
    buffer_load_dwordx4 v1, s[8:11], s52 offen offset:1024 sc1 lds
    buffer_load_dwordx4 v1, s[8:11], s52 offen offset:2048 sc1 lds
    v_cvt_pk_bf16_f32 v146, v116, v117
    v_cvt_pk_bf16_f32 v147, v118, v119
    v_exp_f32 v120, v120
    v_exp_f32 v121, v121
    v_exp_f32 v122, v122
    v_exp_f32 v123, v123
    v_mfma_f32_32x32x16_bf16 v[48:63], v[220:223], v[144:147], v[48:63]
    v_cvt_pk_bf16_f32 v148, v120, v121
    v_cvt_pk_bf16_f32 v149, v122, v123
    v_exp_f32 v124, v124
    v_exp_f32 v125, v125
    v_exp_f32 v126, v126
    v_exp_f32 v127, v127
    v_cvt_pk_bf16_f32 v150, v124, v125
    v_cvt_pk_bf16_f32 v151, v126, v127
    v_mfma_f32_32x32x16_bf16 v[112:127], v[212:215], v[32:35], 0
    v_exp_f32 v128, v128
    v_exp_f32 v129, v129
    v_exp_f32 v130, v130
    v_exp_f32 v131, v131
    v_mfma_f32_32x32x16_bf16 v[112:127], v[216:219], v[36:39], v[112:127]
    s_mov_b64 exec, 254
    buffer_load_dword v173, v4, s[8:11], s39 offen sc1
    s_mov_b64 exec, -1
    v_cvt_pk_bf16_f32 v144, v128, v129
    v_cvt_pk_bf16_f32 v145, v130, v131
    v_exp_f32 v132, v132
    v_exp_f32 v133, v133
    v_exp_f32 v134, v134
    v_exp_f32 v135, v135
    v_mfma_f32_32x32x16_bf16 v[48:63], v[224:227], v[148:151], v[48:63]
    v_cvt_pk_bf16_f32 v146, v132, v133
    v_cvt_pk_bf16_f32 v147, v134, v135
    v_exp_f32 v136, v136
    v_exp_f32 v137, v137
    v_exp_f32 v138, v138
    v_exp_f32 v139, v139
    v_mfma_f32_32x32x16_bf16 v[64:79], v[220:223], v[144:147], v[64:79]
    v_cvt_pk_bf16_f32 v148, v136, v137
    v_cvt_pk_bf16_f32 v149, v138, v139
    v_exp_f32 v140, v140
    v_exp_f32 v141, v141
    v_exp_f32 v142, v142
    v_exp_f32 v143, v143
    v_cvt_pk_bf16_f32 v150, v140, v141
    v_cvt_pk_bf16_f32 v151, v142, v143
    v_mfma_f32_32x32x16_bf16 v[128:143], v[212:215], v[40:43], 0
    v_exp_f32 v112, v112
    v_exp_f32 v113, v113
    v_exp_f32 v114, v114
    v_exp_f32 v115, v115
    v_mfma_f32_32x32x16_bf16 v[128:143], v[216:219], v[44:47], v[128:143]
    v_cvt_pk_bf16_f32 v144, v112, v113
    v_cvt_pk_bf16_f32 v145, v114, v115
    v_exp_f32 v116, v116
    v_exp_f32 v117, v117
    v_exp_f32 v118, v118
    v_exp_f32 v119, v119
    v_mfma_f32_32x32x16_bf16 v[64:79], v[224:227], v[148:151], v[64:79]
    buffer_load_dwordx2 a[224:225], v176, s[8:11], s47 offen sc1
    buffer_load_dwordx2 a[226:227], v176, s[8:11], s47 offen offset:256 sc1
    buffer_load_dwordx2 a[228:229], v176, s[8:11], s47 offen offset:1024 sc1
    buffer_load_dwordx2 a[230:231], v176, s[8:11], s47 offen offset:1280 sc1
    v_cvt_pk_bf16_f32 v146, v116, v117
    v_cvt_pk_bf16_f32 v147, v118, v119
    v_exp_f32 v120, v120
    v_exp_f32 v121, v121
    v_exp_f32 v122, v122
    v_exp_f32 v123, v123
    v_mfma_f32_32x32x16_bf16 v[80:95], v[220:223], v[144:147], v[80:95]
    v_cvt_pk_bf16_f32 v148, v120, v121
    v_cvt_pk_bf16_f32 v149, v122, v123
    v_exp_f32 v124, v124
    v_exp_f32 v125, v125
    v_exp_f32 v126, v126
    v_exp_f32 v127, v127
    v_cvt_pk_bf16_f32 v150, v124, v125
    v_cvt_pk_bf16_f32 v151, v126, v127
    s_waitcnt vmcnt(19)
    v_mfma_f32_32x32x16_bf16 v[112:127], v[180:183], v[16:19], 0
    v_exp_f32 v128, v128
    v_exp_f32 v129, v129
    v_exp_f32 v130, v130
    v_exp_f32 v131, v131
    v_mfma_f32_32x32x16_bf16 v[112:127], v[184:187], v[20:23], v[112:127]
    v_cvt_pk_bf16_f32 v144, v128, v129
    v_cvt_pk_bf16_f32 v145, v130, v131
    v_exp_f32 v132, v132
    v_exp_f32 v133, v133
    v_exp_f32 v134, v134
    v_exp_f32 v135, v135
    v_mfma_f32_32x32x16_bf16 v[80:95], v[224:227], v[148:151], v[80:95]
    v_cvt_pk_bf16_f32 v146, v132, v133
    v_cvt_pk_bf16_f32 v147, v134, v135
    v_exp_f32 v136, v136
    v_exp_f32 v137, v137
    v_exp_f32 v138, v138
    v_exp_f32 v139, v139
    v_mfma_f32_32x32x16_bf16 v[96:111], v[220:223], v[144:147], v[96:111]
    v_cvt_pk_bf16_f32 v148, v136, v137
    v_cvt_pk_bf16_f32 v149, v138, v139
    v_exp_f32 v140, v140
    v_exp_f32 v141, v141
    v_exp_f32 v142, v142
    v_exp_f32 v143, v143
    v_cvt_pk_bf16_f32 v150, v140, v141
    v_cvt_pk_bf16_f32 v151, v142, v143
    v_mfma_f32_32x32x16_bf16 v[128:143], v[180:183], v[24:27], 0
    v_exp_f32 v112, v112
    v_exp_f32 v113, v113
    v_exp_f32 v114, v114
    v_exp_f32 v115, v115
    v_mfma_f32_32x32x16_bf16 v[128:143], v[184:187], v[28:31], v[128:143]
    s_xor_b32 s23, s41, 147456
    v_cvt_pk_bf16_f32 v144, v112, v113
    v_cvt_pk_bf16_f32 v145, v114, v115
    v_exp_f32 v116, v116
    v_exp_f32 v117, v117
    v_exp_f32 v118, v118
    v_exp_f32 v119, v119
    v_mfma_f32_32x32x16_bf16 v[96:111], v[224:227], v[148:151], v[96:111]
    buffer_load_dwordx4 v[212:215], v1, s[8:11], s23 offen sc1
    buffer_load_dwordx4 v[216:219], v1, s[8:11], s23 offen offset:1024 sc1
    buffer_load_dwordx4 v[220:223], v1, s[8:11], s23 offen offset:2048 sc1
    buffer_load_dwordx4 v[224:227], v1, s[8:11], s23 offen offset:3072 sc1
    buffer_load_dwordx4 v1, s[8:11], s52 offen offset:3072 sc1 lds
    s_add_u32 s52, s50, 4096
    s_add_u32 m0, s51, 4096
    s_nop 0
    buffer_load_dwordx4 v1, s[8:11], s52 offen sc1 lds
    buffer_load_dwordx4 v1, s[8:11], s52 offen offset:1024 sc1 lds
    v_cvt_pk_bf16_f32 v146, v116, v117
    v_cvt_pk_bf16_f32 v147, v118, v119
    v_exp_f32 v120, v120
    v_exp_f32 v121, v121
    v_exp_f32 v122, v122
    v_exp_f32 v123, v123
    v_mfma_f32_32x32x16_bf16 v[48:63], v[188:191], v[144:147], v[48:63]
    v_cvt_pk_bf16_f32 v148, v120, v121
    v_cvt_pk_bf16_f32 v149, v122, v123
    v_exp_f32 v124, v124
    v_exp_f32 v125, v125
    v_exp_f32 v126, v126
    v_exp_f32 v127, v127
    v_cvt_pk_bf16_f32 v150, v124, v125
    v_cvt_pk_bf16_f32 v151, v126, v127
    v_mfma_f32_32x32x16_bf16 v[112:127], v[180:183], v[32:35], 0
    v_exp_f32 v128, v128
    v_exp_f32 v129, v129
    v_exp_f32 v130, v130
    v_exp_f32 v131, v131
    v_mfma_f32_32x32x16_bf16 v[112:127], v[184:187], v[36:39], v[112:127]
    v_cvt_pk_bf16_f32 v144, v128, v129
    v_cvt_pk_bf16_f32 v145, v130, v131
    v_exp_f32 v132, v132
    v_exp_f32 v133, v133
    v_exp_f32 v134, v134
    v_exp_f32 v135, v135
    v_mfma_f32_32x32x16_bf16 v[48:63], v[192:195], v[148:151], v[48:63]
    v_cvt_pk_bf16_f32 v146, v132, v133
    v_cvt_pk_bf16_f32 v147, v134, v135
    v_exp_f32 v136, v136
    v_exp_f32 v137, v137
    v_exp_f32 v138, v138
    v_exp_f32 v139, v139
    v_mfma_f32_32x32x16_bf16 v[64:79], v[188:191], v[144:147], v[64:79]
    v_cvt_pk_bf16_f32 v148, v136, v137
    v_cvt_pk_bf16_f32 v149, v138, v139
    v_exp_f32 v140, v140
    v_exp_f32 v141, v141
    v_exp_f32 v142, v142
    v_exp_f32 v143, v143
    v_cvt_pk_bf16_f32 v150, v140, v141
    v_cvt_pk_bf16_f32 v151, v142, v143
    v_mfma_f32_32x32x16_bf16 v[128:143], v[180:183], v[40:43], 0
    v_exp_f32 v112, v112
    v_exp_f32 v113, v113
    v_exp_f32 v114, v114
    v_exp_f32 v115, v115
    v_mfma_f32_32x32x16_bf16 v[128:143], v[184:187], v[44:47], v[128:143]
    v_cvt_pk_bf16_f32 v144, v112, v113
    v_cvt_pk_bf16_f32 v145, v114, v115
    v_exp_f32 v116, v116
    v_exp_f32 v117, v117
    v_exp_f32 v118, v118
    v_exp_f32 v119, v119
    v_mfma_f32_32x32x16_bf16 v[64:79], v[192:195], v[148:151], v[64:79]
    buffer_load_dwordx2 a[232:233], v176, s[8:11], s47 offen offset:2048 sc1
    buffer_load_dwordx2 a[234:235], v176, s[8:11], s47 offen offset:2304 sc1
    buffer_load_dwordx2 a[236:237], v176, s[8:11], s47 offen offset:3072 sc1
    buffer_load_dwordx2 a[238:239], v176, s[8:11], s47 offen offset:3328 sc1
    v_cvt_pk_bf16_f32 v146, v116, v117
    v_cvt_pk_bf16_f32 v147, v118, v119
    v_exp_f32 v120, v120
    v_exp_f32 v121, v121
    v_exp_f32 v122, v122
    v_exp_f32 v123, v123
    v_mfma_f32_32x32x16_bf16 v[80:95], v[188:191], v[144:147], v[80:95]
    v_cvt_pk_bf16_f32 v148, v120, v121
    v_cvt_pk_bf16_f32 v149, v122, v123
    v_exp_f32 v124, v124
    v_exp_f32 v125, v125
    v_exp_f32 v126, v126
    v_exp_f32 v127, v127
    v_cvt_pk_bf16_f32 v150, v124, v125
    v_cvt_pk_bf16_f32 v151, v126, v127
    s_waitcnt vmcnt(23)
    v_mfma_f32_32x32x16_bf16 v[112:127], v[152:155], v[16:19], 0
    v_exp_f32 v128, v128
    v_exp_f32 v129, v129
    v_exp_f32 v130, v130
    v_exp_f32 v131, v131
    v_mfma_f32_32x32x16_bf16 v[112:127], v[156:159], v[20:23], v[112:127]
    v_cvt_pk_bf16_f32 v144, v128, v129
    v_cvt_pk_bf16_f32 v145, v130, v131
    v_exp_f32 v132, v132
    v_exp_f32 v133, v133
    v_exp_f32 v134, v134
    v_exp_f32 v135, v135
    v_mfma_f32_32x32x16_bf16 v[80:95], v[192:195], v[148:151], v[80:95]
    v_cvt_pk_bf16_f32 v146, v132, v133
    v_cvt_pk_bf16_f32 v147, v134, v135
    v_exp_f32 v136, v136
    v_exp_f32 v137, v137
    v_exp_f32 v138, v138
    v_exp_f32 v139, v139
    v_mfma_f32_32x32x16_bf16 v[96:111], v[188:191], v[144:147], v[96:111]
    v_cvt_pk_bf16_f32 v148, v136, v137
    v_cvt_pk_bf16_f32 v149, v138, v139
    v_exp_f32 v140, v140
    v_exp_f32 v141, v141
    v_exp_f32 v142, v142
    v_exp_f32 v143, v143
    v_cvt_pk_bf16_f32 v150, v140, v141
    v_cvt_pk_bf16_f32 v151, v142, v143
    v_mfma_f32_32x32x16_bf16 v[128:143], v[152:155], v[24:27], 0
    v_exp_f32 v112, v112
    v_exp_f32 v113, v113
    v_exp_f32 v114, v114
    v_exp_f32 v115, v115
    v_mfma_f32_32x32x16_bf16 v[128:143], v[156:159], v[28:31], v[128:143]
    s_xor_b32 s23, s41, 131072
    v_cvt_pk_bf16_f32 v144, v112, v113
    v_cvt_pk_bf16_f32 v145, v114, v115
    v_exp_f32 v116, v116
    v_exp_f32 v117, v117
    v_exp_f32 v118, v118
    v_exp_f32 v119, v119
    v_mfma_f32_32x32x16_bf16 v[96:111], v[192:195], v[148:151], v[96:111]
    buffer_load_dwordx4 v[180:183], v1, s[8:11], s23 offen sc1
    buffer_load_dwordx4 v[184:187], v1, s[8:11], s23 offen offset:1024 sc1
    buffer_load_dwordx4 v[188:191], v1, s[8:11], s23 offen offset:2048 sc1
    buffer_load_dwordx4 v[192:195], v1, s[8:11], s23 offen offset:3072 sc1
    buffer_load_dwordx4 v1, s[8:11], s52 offen offset:2048 sc1 lds
    buffer_load_dwordx4 v1, s[8:11], s52 offen offset:3072 sc1 lds
    s_add_u32 s52, s50, 8192
    s_add_u32 m0, s51, 8192
    s_nop 0
    buffer_load_dwordx4 v1, s[8:11], s52 offen sc1 lds
    v_cvt_pk_bf16_f32 v146, v116, v117
    v_cvt_pk_bf16_f32 v147, v118, v119
    v_exp_f32 v120, v120
    v_exp_f32 v121, v121
    v_exp_f32 v122, v122
    v_exp_f32 v123, v123
    v_mfma_f32_32x32x16_bf16 v[48:63], v[160:163], v[144:147], v[48:63]
    v_cvt_pk_bf16_f32 v148, v120, v121
    v_cvt_pk_bf16_f32 v149, v122, v123
    v_exp_f32 v124, v124
    v_exp_f32 v125, v125
    v_exp_f32 v126, v126
    v_exp_f32 v127, v127
    v_cvt_pk_bf16_f32 v150, v124, v125
    v_cvt_pk_bf16_f32 v151, v126, v127
    v_mfma_f32_32x32x16_bf16 v[112:127], v[152:155], v[32:35], 0
    v_exp_f32 v128, v128
    v_exp_f32 v129, v129
    v_exp_f32 v130, v130
    v_exp_f32 v131, v131
    v_mfma_f32_32x32x16_bf16 v[112:127], v[156:159], v[36:39], v[112:127]
    v_cvt_pk_bf16_f32 v144, v128, v129
    v_cvt_pk_bf16_f32 v145, v130, v131
    v_exp_f32 v132, v132
    v_exp_f32 v133, v133
    v_exp_f32 v134, v134
    v_exp_f32 v135, v135
    v_mfma_f32_32x32x16_bf16 v[48:63], v[164:167], v[148:151], v[48:63]
    v_cvt_pk_bf16_f32 v146, v132, v133
    v_cvt_pk_bf16_f32 v147, v134, v135
    v_exp_f32 v136, v136
    v_exp_f32 v137, v137
    v_exp_f32 v138, v138
    v_exp_f32 v139, v139
    v_mfma_f32_32x32x16_bf16 v[64:79], v[160:163], v[144:147], v[64:79]
    v_cvt_pk_bf16_f32 v148, v136, v137
    v_cvt_pk_bf16_f32 v149, v138, v139
    v_exp_f32 v140, v140
    v_exp_f32 v141, v141
    v_exp_f32 v142, v142
    v_exp_f32 v143, v143
    v_cvt_pk_bf16_f32 v150, v140, v141
    v_cvt_pk_bf16_f32 v151, v142, v143
    v_mfma_f32_32x32x16_bf16 v[128:143], v[152:155], v[40:43], 0
    v_exp_f32 v112, v112
    v_exp_f32 v113, v113
    v_exp_f32 v114, v114
    v_exp_f32 v115, v115
    v_mfma_f32_32x32x16_bf16 v[128:143], v[156:159], v[44:47], v[128:143]
    v_cvt_pk_bf16_f32 v144, v112, v113
    v_cvt_pk_bf16_f32 v145, v114, v115
    v_exp_f32 v116, v116
    v_exp_f32 v117, v117
    v_exp_f32 v118, v118
    v_exp_f32 v119, v119
    v_mfma_f32_32x32x16_bf16 v[64:79], v[164:167], v[148:151], v[64:79]
    s_mov_b32 s57, s34
    buffer_load_dwordx4 a[0:3], v1, s[8:11], s57 offen sc1
    buffer_load_dwordx4 a[4:7], v1, s[8:11], s57 offen offset:1024 sc1
    v_cvt_pk_bf16_f32 v146, v116, v117
    v_cvt_pk_bf16_f32 v147, v118, v119
    v_exp_f32 v120, v120
    v_exp_f32 v121, v121
    v_exp_f32 v122, v122
    v_exp_f32 v123, v123
    v_mfma_f32_32x32x16_bf16 v[80:95], v[160:163], v[144:147], v[80:95]
    v_cvt_pk_bf16_f32 v148, v120, v121
    v_cvt_pk_bf16_f32 v149, v122, v123
    v_exp_f32 v124, v124
    v_exp_f32 v125, v125
    v_exp_f32 v126, v126
    v_exp_f32 v127, v127
    v_cvt_pk_bf16_f32 v150, v124, v125
    v_cvt_pk_bf16_f32 v151, v126, v127
    s_waitcnt vmcnt(28)
    v_mfma_f32_32x32x16_bf16 v[112:127], v[196:199], v[16:19], 0
    v_exp_f32 v128, v128
    v_exp_f32 v129, v129
    v_exp_f32 v130, v130
    v_exp_f32 v131, v131
    v_mfma_f32_32x32x16_bf16 v[112:127], v[200:203], v[20:23], v[112:127]
    s_waitcnt vmcnt(24)
    v_cmp_ne_u32 vcc, v8, v173
    s_nop 0
    s_and_b32 s7, vcc_lo, 254
    s_cbranch_scc1 KSLOW0_9
KBACK0_9:
    v_cvt_pk_bf16_f32 v144, v128, v129
    v_cvt_pk_bf16_f32 v145, v130, v131
    v_exp_f32 v132, v132
    v_exp_f32 v133, v133
    v_exp_f32 v134, v134
    v_exp_f32 v135, v135
    v_mfma_f32_32x32x16_bf16 v[80:95], v[164:167], v[148:151], v[80:95]
    v_cvt_pk_bf16_f32 v146, v132, v133
    v_cvt_pk_bf16_f32 v147, v134, v135
    v_exp_f32 v136, v136
    v_exp_f32 v137, v137
    v_exp_f32 v138, v138
    v_exp_f32 v139, v139
    v_mfma_f32_32x32x16_bf16 v[96:111], v[160:163], v[144:147], v[96:111]
    v_cvt_pk_bf16_f32 v148, v136, v137
    v_cvt_pk_bf16_f32 v149, v138, v139
    v_exp_f32 v140, v140
    v_exp_f32 v141, v141
    v_exp_f32 v142, v142
    v_exp_f32 v143, v143
    v_cvt_pk_bf16_f32 v150, v140, v141
    v_cvt_pk_bf16_f32 v151, v142, v143
    v_mfma_f32_32x32x16_bf16 v[128:143], v[196:199], v[24:27], 0
    v_exp_f32 v112, v112
    v_exp_f32 v113, v113
    v_exp_f32 v114, v114
    v_exp_f32 v115, v115
    v_mfma_f32_32x32x16_bf16 v[128:143], v[200:203], v[28:31], v[128:143]
    s_xor_b32 s23, s41, 114688
    v_cvt_pk_bf16_f32 v144, v112, v113
    v_cvt_pk_bf16_f32 v145, v114, v115
    v_exp_f32 v116, v116
    v_exp_f32 v117, v117
    v_exp_f32 v118, v118
    v_exp_f32 v119, v119
    v_mfma_f32_32x32x16_bf16 v[96:111], v[164:167], v[148:151], v[96:111]
    buffer_load_dwordx4 v[152:155], v1, s[8:11], s23 offen sc1
    buffer_load_dwordx4 v[156:159], v1, s[8:11], s23 offen offset:1024 sc1
    buffer_load_dwordx4 v[160:163], v1, s[8:11], s23 offen offset:2048 sc1
    buffer_load_dwordx4 v[164:167], v1, s[8:11], s23 offen offset:3072 sc1
    buffer_load_dwordx4 v1, s[8:11], s52 offen offset:1024 sc1 lds
    buffer_load_dwordx4 v1, s[8:11], s52 offen offset:2048 sc1 lds
    buffer_load_dwordx4 v1, s[8:11], s52 offen offset:3072 sc1 lds
    v_cvt_pk_bf16_f32 v146, v116, v117
    v_cvt_pk_bf16_f32 v147, v118, v119
    v_exp_f32 v120, v120
    v_exp_f32 v121, v121
    v_exp_f32 v122, v122
    v_exp_f32 v123, v123
    v_mfma_f32_32x32x16_bf16 v[48:63], v[204:207], v[144:147], v[48:63]
    v_cvt_pk_bf16_f32 v148, v120, v121
    v_cvt_pk_bf16_f32 v149, v122, v123
    v_exp_f32 v124, v124
    v_exp_f32 v125, v125
    v_exp_f32 v126, v126
    v_exp_f32 v127, v127
    v_cvt_pk_bf16_f32 v150, v124, v125
    v_cvt_pk_bf16_f32 v151, v126, v127
    v_mfma_f32_32x32x16_bf16 v[112:127], v[196:199], v[32:35], 0
    v_exp_f32 v128, v128
    v_exp_f32 v129, v129
    v_exp_f32 v130, v130
    v_exp_f32 v131, v131
    v_mfma_f32_32x32x16_bf16 v[112:127], v[200:203], v[36:39], v[112:127]
    v_cvt_pk_bf16_f32 v144, v128, v129
    v_cvt_pk_bf16_f32 v145, v130, v131
    v_exp_f32 v132, v132
    v_exp_f32 v133, v133
    v_exp_f32 v134, v134
    v_exp_f32 v135, v135
    v_mfma_f32_32x32x16_bf16 v[48:63], v[208:211], v[148:151], v[48:63]
    v_cvt_pk_bf16_f32 v146, v132, v133
    v_cvt_pk_bf16_f32 v147, v134, v135
    v_exp_f32 v136, v136
    v_exp_f32 v137, v137
    v_exp_f32 v138, v138
    v_exp_f32 v139, v139
    v_mfma_f32_32x32x16_bf16 v[64:79], v[204:207], v[144:147], v[64:79]
    v_cvt_pk_bf16_f32 v148, v136, v137
    v_cvt_pk_bf16_f32 v149, v138, v139
    v_exp_f32 v140, v140
    v_exp_f32 v141, v141
    v_exp_f32 v142, v142
    v_exp_f32 v143, v143
    v_cvt_pk_bf16_f32 v150, v140, v141
    v_cvt_pk_bf16_f32 v151, v142, v143
    v_mfma_f32_32x32x16_bf16 v[128:143], v[196:199], v[40:43], 0
    v_exp_f32 v112, v112
    v_exp_f32 v113, v113
    v_exp_f32 v114, v114
    v_exp_f32 v115, v115
    v_mfma_f32_32x32x16_bf16 v[128:143], v[200:203], v[44:47], v[128:143]
    v_cvt_pk_bf16_f32 v144, v112, v113
    v_cvt_pk_bf16_f32 v145, v114, v115
    v_exp_f32 v116, v116
    v_exp_f32 v117, v117
    v_exp_f32 v118, v118
    v_exp_f32 v119, v119
    v_mfma_f32_32x32x16_bf16 v[64:79], v[208:211], v[148:151], v[64:79]
    buffer_load_dwordx4 a[8:11], v1, s[8:11], s57 offen offset:2048 sc1
    buffer_load_dwordx4 a[12:15], v1, s[8:11], s57 offen offset:3072 sc1
    v_cvt_pk_bf16_f32 v146, v116, v117
    v_cvt_pk_bf16_f32 v147, v118, v119
    v_exp_f32 v120, v120
    v_exp_f32 v121, v121
    v_exp_f32 v122, v122
    v_exp_f32 v123, v123
    v_mfma_f32_32x32x16_bf16 v[80:95], v[204:207], v[144:147], v[80:95]
    v_cvt_pk_bf16_f32 v148, v120, v121
    v_cvt_pk_bf16_f32 v149, v122, v123
    v_exp_f32 v124, v124
    v_exp_f32 v125, v125
    v_exp_f32 v126, v126
    v_exp_f32 v127, v127
    v_cvt_pk_bf16_f32 v150, v124, v125
    v_cvt_pk_bf16_f32 v151, v126, v127
    s_waitcnt vmcnt(25)
    v_mfma_f32_32x32x16_bf16 v[112:127], v[212:215], v[16:19], 0
    v_exp_f32 v128, v128
    v_exp_f32 v129, v129
    v_exp_f32 v130, v130
    v_exp_f32 v131, v131
    v_mfma_f32_32x32x16_bf16 v[112:127], v[216:219], v[20:23], v[112:127]
    v_cvt_pk_bf16_f32 v144, v128, v129
    v_cvt_pk_bf16_f32 v145, v130, v131
    v_exp_f32 v132, v132
    v_exp_f32 v133, v133
    v_exp_f32 v134, v134
    v_exp_f32 v135, v135
    v_mfma_f32_32x32x16_bf16 v[80:95], v[208:211], v[148:151], v[80:95]
    v_cvt_pk_bf16_f32 v146, v132, v133
    v_cvt_pk_bf16_f32 v147, v134, v135
    v_exp_f32 v136, v136
    v_exp_f32 v137, v137
    v_exp_f32 v138, v138
    v_exp_f32 v139, v139
    v_mfma_f32_32x32x16_bf16 v[96:111], v[204:207], v[144:147], v[96:111]
    v_cvt_pk_bf16_f32 v148, v136, v137
    v_cvt_pk_bf16_f32 v149, v138, v139
    v_exp_f32 v140, v140
    v_exp_f32 v141, v141
    v_exp_f32 v142, v142
    v_exp_f32 v143, v143
    v_cvt_pk_bf16_f32 v150, v140, v141
    v_cvt_pk_bf16_f32 v151, v142, v143
    v_mfma_f32_32x32x16_bf16 v[128:143], v[212:215], v[24:27], 0
    v_exp_f32 v112, v112
    v_exp_f32 v113, v113
    v_exp_f32 v114, v114
    v_exp_f32 v115, v115
    v_mfma_f32_32x32x16_bf16 v[128:143], v[216:219], v[28:31], v[128:143]
    s_xor_b32 s23, s41, 98304
    v_cvt_pk_bf16_f32 v144, v112, v113
    v_cvt_pk_bf16_f32 v145, v114, v115
    v_exp_f32 v116, v116
    v_exp_f32 v117, v117
    v_exp_f32 v118, v118
    v_exp_f32 v119, v119
    v_mfma_f32_32x32x16_bf16 v[96:111], v[208:211], v[148:151], v[96:111]
    buffer_load_dwordx4 v[196:199], v1, s[8:11], s23 offen sc1
    buffer_load_dwordx4 v[200:203], v1, s[8:11], s23 offen offset:1024 sc1
    buffer_load_dwordx4 v[204:207], v1, s[8:11], s23 offen offset:2048 sc1
    buffer_load_dwordx4 v[208:211], v1, s[8:11], s23 offen offset:3072 sc1
    s_add_u32 s52, s50, 12288
    s_add_u32 m0, s51, 12288
    s_nop 0
    buffer_load_dwordx4 v1, s[8:11], s52 offen sc1 lds
    buffer_load_dwordx4 v1, s[8:11], s52 offen offset:1024 sc1 lds
    buffer_load_dwordx4 v1, s[8:11], s52 offen offset:2048 sc1 lds
    v_cvt_pk_bf16_f32 v146, v116, v117
    v_cvt_pk_bf16_f32 v147, v118, v119
    v_exp_f32 v120, v120
    v_exp_f32 v121, v121
    v_exp_f32 v122, v122
    v_exp_f32 v123, v123
    v_mfma_f32_32x32x16_bf16 v[48:63], v[220:223], v[144:147], v[48:63]
    v_cvt_pk_bf16_f32 v148, v120, v121
    v_cvt_pk_bf16_f32 v149, v122, v123
    v_exp_f32 v124, v124
    v_exp_f32 v125, v125
    v_exp_f32 v126, v126
    v_exp_f32 v127, v127
    v_cvt_pk_bf16_f32 v150, v124, v125
    v_cvt_pk_bf16_f32 v151, v126, v127
    v_mfma_f32_32x32x16_bf16 v[112:127], v[212:215], v[32:35], 0
    v_exp_f32 v128, v128
    v_exp_f32 v129, v129
    v_exp_f32 v130, v130
    v_exp_f32 v131, v131
    v_mfma_f32_32x32x16_bf16 v[112:127], v[216:219], v[36:39], v[112:127]
    v_cvt_pk_bf16_f32 v144, v128, v129
    v_cvt_pk_bf16_f32 v145, v130, v131
    v_exp_f32 v132, v132
    v_exp_f32 v133, v133
    v_exp_f32 v134, v134
    v_exp_f32 v135, v135
    v_mfma_f32_32x32x16_bf16 v[48:63], v[224:227], v[148:151], v[48:63]
    v_cvt_pk_bf16_f32 v146, v132, v133
    v_cvt_pk_bf16_f32 v147, v134, v135
    v_exp_f32 v136, v136
    v_exp_f32 v137, v137
    v_exp_f32 v138, v138
    v_exp_f32 v139, v139
    v_mfma_f32_32x32x16_bf16 v[64:79], v[220:223], v[144:147], v[64:79]
    v_cvt_pk_bf16_f32 v148, v136, v137
    v_cvt_pk_bf16_f32 v149, v138, v139
    v_exp_f32 v140, v140
    v_exp_f32 v141, v141
    v_exp_f32 v142, v142
    v_exp_f32 v143, v143
    v_cvt_pk_bf16_f32 v150, v140, v141
    v_cvt_pk_bf16_f32 v151, v142, v143
    v_mfma_f32_32x32x16_bf16 v[128:143], v[212:215], v[40:43], 0
    v_exp_f32 v112, v112
    v_exp_f32 v113, v113
    v_exp_f32 v114, v114
    v_exp_f32 v115, v115
    v_mfma_f32_32x32x16_bf16 v[128:143], v[216:219], v[44:47], v[128:143]
    v_cvt_pk_bf16_f32 v144, v112, v113
    v_cvt_pk_bf16_f32 v145, v114, v115
    v_exp_f32 v116, v116
    v_exp_f32 v117, v117
    v_exp_f32 v118, v118
    v_exp_f32 v119, v119
    v_mfma_f32_32x32x16_bf16 v[64:79], v[224:227], v[148:151], v[64:79]
    s_add_u32 s57, s34, 4096
    buffer_load_dwordx4 a[16:19], v1, s[8:11], s57 offen sc1
    buffer_load_dwordx4 a[20:23], v1, s[8:11], s57 offen offset:1024 sc1
    v_cvt_pk_bf16_f32 v146, v116, v117
    v_cvt_pk_bf16_f32 v147, v118, v119
    v_exp_f32 v120, v120
    v_exp_f32 v121, v121
    v_exp_f32 v122, v122
    v_exp_f32 v123, v123
    v_mfma_f32_32x32x16_bf16 v[80:95], v[220:223], v[144:147], v[80:95]
    v_cvt_pk_bf16_f32 v148, v120, v121
    v_cvt_pk_bf16_f32 v149, v122, v123
    v_exp_f32 v124, v124
    v_exp_f32 v125, v125
    v_exp_f32 v126, v126
    v_exp_f32 v127, v127
    v_cvt_pk_bf16_f32 v150, v124, v125
    v_cvt_pk_bf16_f32 v151, v126, v127
    s_waitcnt vmcnt(23)
    v_mfma_f32_32x32x16_bf16 v[112:127], v[180:183], v[16:19], 0
    v_exp_f32 v128, v128
    v_exp_f32 v129, v129
    v_exp_f32 v130, v130
    v_exp_f32 v131, v131
    v_mfma_f32_32x32x16_bf16 v[112:127], v[184:187], v[20:23], v[112:127]
    v_cvt_pk_bf16_f32 v144, v128, v129
    v_cvt_pk_bf16_f32 v145, v130, v131
    v_exp_f32 v132, v132
    v_exp_f32 v133, v133
    v_exp_f32 v134, v134
    v_exp_f32 v135, v135
    v_mfma_f32_32x32x16_bf16 v[80:95], v[224:227], v[148:151], v[80:95]
    v_cvt_pk_bf16_f32 v146, v132, v133
    v_cvt_pk_bf16_f32 v147, v134, v135
    v_exp_f32 v136, v136
    v_exp_f32 v137, v137
    v_exp_f32 v138, v138
    v_exp_f32 v139, v139
    v_mfma_f32_32x32x16_bf16 v[96:111], v[220:223], v[144:147], v[96:111]
    v_cvt_pk_bf16_f32 v148, v136, v137
    v_cvt_pk_bf16_f32 v149, v138, v139
    v_exp_f32 v140, v140
    v_exp_f32 v141, v141
    v_exp_f32 v142, v142
    v_exp_f32 v143, v143
    v_cvt_pk_bf16_f32 v150, v140, v141
    v_cvt_pk_bf16_f32 v151, v142, v143
    v_mfma_f32_32x32x16_bf16 v[128:143], v[180:183], v[24:27], 0
    v_exp_f32 v112, v112
    v_exp_f32 v113, v113
    v_exp_f32 v114, v114
    v_exp_f32 v115, v115
    v_mfma_f32_32x32x16_bf16 v[128:143], v[184:187], v[28:31], v[128:143]
    s_xor_b32 s23, s41, 81920
    v_cvt_pk_bf16_f32 v144, v112, v113
    v_cvt_pk_bf16_f32 v145, v114, v115
    v_exp_f32 v116, v116
    v_exp_f32 v117, v117
    v_exp_f32 v118, v118
    v_exp_f32 v119, v119
    v_mfma_f32_32x32x16_bf16 v[96:111], v[224:227], v[148:151], v[96:111]
    buffer_load_dwordx4 v[212:215], v1, s[8:11], s23 offen sc1
    buffer_load_dwordx4 v[216:219], v1, s[8:11], s23 offen offset:1024 sc1
    buffer_load_dwordx4 v[220:223], v1, s[8:11], s23 offen offset:2048 sc1
    buffer_load_dwordx4 v[224:227], v1, s[8:11], s23 offen offset:3072 sc1
    buffer_load_dwordx4 v1, s[8:11], s52 offen offset:3072 sc1 lds
    s_add_u32 s52, s50, 16384
    s_add_u32 m0, s51, 16384
    s_nop 0
    buffer_load_dwordx4 v1, s[8:11], s52 offen sc1 lds
    buffer_load_dwordx4 v1, s[8:11], s52 offen offset:1024 sc1 lds
    v_cvt_pk_bf16_f32 v146, v116, v117
    v_cvt_pk_bf16_f32 v147, v118, v119
    v_exp_f32 v120, v120
    v_exp_f32 v121, v121
    v_exp_f32 v122, v122
    v_exp_f32 v123, v123
    v_mfma_f32_32x32x16_bf16 v[48:63], v[188:191], v[144:147], v[48:63]
    v_cvt_pk_bf16_f32 v148, v120, v121
    v_cvt_pk_bf16_f32 v149, v122, v123
    v_exp_f32 v124, v124
    v_exp_f32 v125, v125
    v_exp_f32 v126, v126
    v_exp_f32 v127, v127
    v_cvt_pk_bf16_f32 v150, v124, v125
    v_cvt_pk_bf16_f32 v151, v126, v127
    v_mfma_f32_32x32x16_bf16 v[112:127], v[180:183], v[32:35], 0
    v_exp_f32 v128, v128
    v_exp_f32 v129, v129
    v_exp_f32 v130, v130
    v_exp_f32 v131, v131
    v_mfma_f32_32x32x16_bf16 v[112:127], v[184:187], v[36:39], v[112:127]
    v_cvt_pk_bf16_f32 v144, v128, v129
    v_cvt_pk_bf16_f32 v145, v130, v131
    v_exp_f32 v132, v132
    v_exp_f32 v133, v133
    v_exp_f32 v134, v134
    v_exp_f32 v135, v135
    v_mfma_f32_32x32x16_bf16 v[48:63], v[192:195], v[148:151], v[48:63]
    v_cvt_pk_bf16_f32 v146, v132, v133
    v_cvt_pk_bf16_f32 v147, v134, v135
    v_exp_f32 v136, v136
    v_exp_f32 v137, v137
    v_exp_f32 v138, v138
    v_exp_f32 v139, v139
    v_mfma_f32_32x32x16_bf16 v[64:79], v[188:191], v[144:147], v[64:79]
    v_cvt_pk_bf16_f32 v148, v136, v137
    v_cvt_pk_bf16_f32 v149, v138, v139
    v_exp_f32 v140, v140
    v_exp_f32 v141, v141
    v_exp_f32 v142, v142
    v_exp_f32 v143, v143
    v_cvt_pk_bf16_f32 v150, v140, v141
    v_cvt_pk_bf16_f32 v151, v142, v143
    v_mfma_f32_32x32x16_bf16 v[128:143], v[180:183], v[40:43], 0
    v_exp_f32 v112, v112
    v_exp_f32 v113, v113
    v_exp_f32 v114, v114
    v_exp_f32 v115, v115
    v_mfma_f32_32x32x16_bf16 v[128:143], v[184:187], v[44:47], v[128:143]
    v_cvt_pk_bf16_f32 v144, v112, v113
    v_cvt_pk_bf16_f32 v145, v114, v115
    v_exp_f32 v116, v116
    v_exp_f32 v117, v117
    v_exp_f32 v118, v118
    v_exp_f32 v119, v119
    v_mfma_f32_32x32x16_bf16 v[64:79], v[192:195], v[148:151], v[64:79]
    buffer_load_dwordx4 a[24:27], v1, s[8:11], s57 offen offset:2048 sc1
    buffer_load_dwordx4 a[28:31], v1, s[8:11], s57 offen offset:3072 sc1
    v_cvt_pk_bf16_f32 v146, v116, v117
    v_cvt_pk_bf16_f32 v147, v118, v119
    v_exp_f32 v120, v120
    v_exp_f32 v121, v121
    v_exp_f32 v122, v122
    v_exp_f32 v123, v123
    v_mfma_f32_32x32x16_bf16 v[80:95], v[188:191], v[144:147], v[80:95]
    v_cvt_pk_bf16_f32 v148, v120, v121
    v_cvt_pk_bf16_f32 v149, v122, v123
    v_exp_f32 v124, v124
    v_exp_f32 v125, v125
    v_exp_f32 v126, v126
    v_exp_f32 v127, v127
    v_cvt_pk_bf16_f32 v150, v124, v125
    v_cvt_pk_bf16_f32 v151, v126, v127
    s_waitcnt vmcnt(23)
    v_mfma_f32_32x32x16_bf16 v[112:127], v[152:155], v[16:19], 0
    v_exp_f32 v128, v128
    v_exp_f32 v129, v129
    v_exp_f32 v130, v130
    v_exp_f32 v131, v131
    v_mfma_f32_32x32x16_bf16 v[112:127], v[156:159], v[20:23], v[112:127]
    v_cvt_pk_bf16_f32 v144, v128, v129
    v_cvt_pk_bf16_f32 v145, v130, v131
    v_exp_f32 v132, v132
    v_exp_f32 v133, v133
    v_exp_f32 v134, v134
    v_exp_f32 v135, v135
    v_mfma_f32_32x32x16_bf16 v[80:95], v[192:195], v[148:151], v[80:95]
    v_cvt_pk_bf16_f32 v146, v132, v133
    v_cvt_pk_bf16_f32 v147, v134, v135
    v_exp_f32 v136, v136
    v_exp_f32 v137, v137
    v_exp_f32 v138, v138
    v_exp_f32 v139, v139
    v_mfma_f32_32x32x16_bf16 v[96:111], v[188:191], v[144:147], v[96:111]
    v_cvt_pk_bf16_f32 v148, v136, v137
    v_cvt_pk_bf16_f32 v149, v138, v139
    v_exp_f32 v140, v140
    v_exp_f32 v141, v141
    v_exp_f32 v142, v142
    v_exp_f32 v143, v143
    v_cvt_pk_bf16_f32 v150, v140, v141
    v_cvt_pk_bf16_f32 v151, v142, v143
    v_mfma_f32_32x32x16_bf16 v[128:143], v[152:155], v[24:27], 0
    v_exp_f32 v112, v112
    v_exp_f32 v113, v113
    v_exp_f32 v114, v114
    v_exp_f32 v115, v115
    v_mfma_f32_32x32x16_bf16 v[128:143], v[156:159], v[28:31], v[128:143]
    s_xor_b32 s23, s41, 65536
    v_cvt_pk_bf16_f32 v144, v112, v113
    v_cvt_pk_bf16_f32 v145, v114, v115
    v_exp_f32 v116, v116
    v_exp_f32 v117, v117
    v_exp_f32 v118, v118
    v_exp_f32 v119, v119
    v_mfma_f32_32x32x16_bf16 v[96:111], v[192:195], v[148:151], v[96:111]
    buffer_load_dwordx4 v[180:183], v1, s[8:11], s23 offen sc1
    buffer_load_dwordx4 v[184:187], v1, s[8:11], s23 offen offset:1024 sc1
    buffer_load_dwordx4 v[188:191], v1, s[8:11], s23 offen offset:2048 sc1
    buffer_load_dwordx4 v[192:195], v1, s[8:11], s23 offen offset:3072 sc1
    buffer_load_dwordx4 v1, s[8:11], s52 offen offset:2048 sc1 lds
    buffer_load_dwordx4 v1, s[8:11], s52 offen offset:3072 sc1 lds
    s_add_u32 s52, s50, 20480
    s_add_u32 m0, s51, 20480
    s_nop 0
    buffer_load_dwordx4 v1, s[8:11], s52 offen sc1 lds
    v_cvt_pk_bf16_f32 v146, v116, v117
    v_cvt_pk_bf16_f32 v147, v118, v119
    v_exp_f32 v120, v120
    v_exp_f32 v121, v121
    v_exp_f32 v122, v122
    v_exp_f32 v123, v123
    v_mfma_f32_32x32x16_bf16 v[48:63], v[160:163], v[144:147], v[48:63]
    v_cvt_pk_bf16_f32 v148, v120, v121
    v_cvt_pk_bf16_f32 v149, v122, v123
    v_exp_f32 v124, v124
    v_exp_f32 v125, v125
    v_exp_f32 v126, v126
    v_exp_f32 v127, v127
    v_cvt_pk_bf16_f32 v150, v124, v125
    v_cvt_pk_bf16_f32 v151, v126, v127
    v_mfma_f32_32x32x16_bf16 v[112:127], v[152:155], v[32:35], 0
    v_lshlrev_b32 v172, 5, v5
    buffer_load_dword v172, v172, s[8:11], s55 offen sc1
    v_exp_f32 v128, v128
    v_exp_f32 v129, v129
    v_exp_f32 v130, v130
    v_exp_f32 v131, v131
    v_mfma_f32_32x32x16_bf16 v[112:127], v[156:159], v[36:39], v[112:127]
    s_add_u32 s53, s46, 12288
    buffer_load_dwordx4 v[228:231], v1, s[8:11], s53 offen offset:2048 sc1
    buffer_load_dwordx4 v[232:235], v1, s[8:11], s53 offen offset:3072 sc1
    v_cvt_pk_bf16_f32 v144, v128, v129
    v_cvt_pk_bf16_f32 v145, v130, v131
    v_exp_f32 v132, v132
    v_exp_f32 v133, v133
    v_exp_f32 v134, v134
    v_exp_f32 v135, v135
    v_mfma_f32_32x32x16_bf16 v[48:63], v[164:167], v[148:151], v[48:63]
    v_cvt_pk_bf16_f32 v146, v132, v133
    v_cvt_pk_bf16_f32 v147, v134, v135
    v_exp_f32 v136, v136
    v_exp_f32 v137, v137
    v_exp_f32 v138, v138
    v_exp_f32 v139, v139
    v_mfma_f32_32x32x16_bf16 v[64:79], v[160:163], v[144:147], v[64:79]
    v_cvt_pk_bf16_f32 v148, v136, v137
    v_cvt_pk_bf16_f32 v149, v138, v139
    v_exp_f32 v140, v140
    v_exp_f32 v141, v141
    v_exp_f32 v142, v142
    v_exp_f32 v143, v143
    v_cvt_pk_bf16_f32 v150, v140, v141
    v_cvt_pk_bf16_f32 v151, v142, v143
    v_mfma_f32_32x32x16_bf16 v[128:143], v[152:155], v[40:43], 0
    v_exp_f32 v112, v112
    v_exp_f32 v113, v113
    v_exp_f32 v114, v114
    v_exp_f32 v115, v115
    v_mfma_f32_32x32x16_bf16 v[128:143], v[156:159], v[44:47], v[128:143]
    v_cvt_pk_bf16_f32 v144, v112, v113
    v_cvt_pk_bf16_f32 v145, v114, v115
    v_exp_f32 v116, v116
    v_exp_f32 v117, v117
    v_exp_f32 v118, v118
    v_exp_f32 v119, v119
    v_mfma_f32_32x32x16_bf16 v[64:79], v[164:167], v[148:151], v[64:79]
    s_add_u32 s57, s34, 8192
    buffer_load_dwordx4 a[32:35], v1, s[8:11], s57 offen sc1
    buffer_load_dwordx4 a[36:39], v1, s[8:11], s57 offen offset:1024 sc1
    v_cvt_pk_bf16_f32 v146, v116, v117
    v_cvt_pk_bf16_f32 v147, v118, v119
    v_exp_f32 v120, v120
    v_exp_f32 v121, v121
    v_exp_f32 v122, v122
    v_exp_f32 v123, v123
    v_mfma_f32_32x32x16_bf16 v[80:95], v[160:163], v[144:147], v[80:95]
    v_cvt_pk_bf16_f32 v148, v120, v121
    v_cvt_pk_bf16_f32 v149, v122, v123
    v_exp_f32 v124, v124
    v_exp_f32 v125, v125
    v_exp_f32 v126, v126
    v_exp_f32 v127, v127
    v_cvt_pk_bf16_f32 v150, v124, v125
    v_cvt_pk_bf16_f32 v151, v126, v127
    s_waitcnt vmcnt(26)
    v_mfma_f32_32x32x16_bf16 v[112:127], v[196:199], v[16:19], 0
    v_exp_f32 v128, v128
    v_exp_f32 v129, v129
    v_exp_f32 v130, v130
    v_exp_f32 v131, v131
    v_mfma_f32_32x32x16_bf16 v[112:127], v[200:203], v[20:23], v[112:127]
    v_cvt_pk_bf16_f32 v144, v128, v129
    v_cvt_pk_bf16_f32 v145, v130, v131
    v_exp_f32 v132, v132
    v_exp_f32 v133, v133
    v_exp_f32 v134, v134
    v_exp_f32 v135, v135
    v_mfma_f32_32x32x16_bf16 v[80:95], v[164:167], v[148:151], v[80:95]
    v_cvt_pk_bf16_f32 v146, v132, v133
    v_cvt_pk_bf16_f32 v147, v134, v135
    v_exp_f32 v136, v136
    v_exp_f32 v137, v137
    v_exp_f32 v138, v138
    v_exp_f32 v139, v139
    v_mfma_f32_32x32x16_bf16 v[96:111], v[160:163], v[144:147], v[96:111]
    v_cvt_pk_bf16_f32 v148, v136, v137
    v_cvt_pk_bf16_f32 v149, v138, v139
    v_exp_f32 v140, v140
    v_exp_f32 v141, v141
    v_exp_f32 v142, v142
    v_exp_f32 v143, v143
    v_cvt_pk_bf16_f32 v150, v140, v141
    v_cvt_pk_bf16_f32 v151, v142, v143
    v_mfma_f32_32x32x16_bf16 v[128:143], v[196:199], v[24:27], 0
    v_exp_f32 v112, v112
    v_exp_f32 v113, v113
    v_exp_f32 v114, v114
    v_exp_f32 v115, v115
    v_mfma_f32_32x32x16_bf16 v[128:143], v[200:203], v[28:31], v[128:143]
    s_xor_b32 s23, s41, 49152
    v_cvt_pk_bf16_f32 v144, v112, v113
    v_cvt_pk_bf16_f32 v145, v114, v115
    v_exp_f32 v116, v116
    v_exp_f32 v117, v117
    v_exp_f32 v118, v118
    v_exp_f32 v119, v119
    v_mfma_f32_32x32x16_bf16 v[96:111], v[164:167], v[148:151], v[96:111]
    buffer_load_dwordx4 v[152:155], v1, s[8:11], s23 offen sc1
    buffer_load_dwordx4 v[156:159], v1, s[8:11], s23 offen offset:1024 sc1
    buffer_load_dwordx4 v[160:163], v1, s[8:11], s23 offen offset:2048 sc1
    buffer_load_dwordx4 v[164:167], v1, s[8:11], s23 offen offset:3072 sc1
    buffer_load_dwordx4 v1, s[8:11], s52 offen offset:1024 sc1 lds
    buffer_load_dwordx4 v1, s[8:11], s52 offen offset:2048 sc1 lds
    buffer_load_dwordx4 v1, s[8:11], s52 offen offset:3072 sc1 lds
    v_cvt_pk_bf16_f32 v146, v116, v117
    v_cvt_pk_bf16_f32 v147, v118, v119
    v_exp_f32 v120, v120
    v_exp_f32 v121, v121
    v_exp_f32 v122, v122
    v_exp_f32 v123, v123
    v_mfma_f32_32x32x16_bf16 v[48:63], v[204:207], v[144:147], v[48:63]
    v_cvt_pk_bf16_f32 v148, v120, v121
    v_cvt_pk_bf16_f32 v149, v122, v123
    v_exp_f32 v124, v124
    v_exp_f32 v125, v125
    v_exp_f32 v126, v126
    v_exp_f32 v127, v127
    v_cvt_pk_bf16_f32 v150, v124, v125
    v_cvt_pk_bf16_f32 v151, v126, v127
    v_mfma_f32_32x32x16_bf16 v[112:127], v[196:199], v[32:35], 0
    v_exp_f32 v128, v128
    v_exp_f32 v129, v129
    v_exp_f32 v130, v130
    v_exp_f32 v131, v131
    v_mfma_f32_32x32x16_bf16 v[112:127], v[200:203], v[36:39], v[112:127]
    v_cvt_pk_bf16_f32 v144, v128, v129
    v_cvt_pk_bf16_f32 v145, v130, v131
    v_exp_f32 v132, v132
    v_exp_f32 v133, v133
    v_exp_f32 v134, v134
    v_exp_f32 v135, v135
    v_mfma_f32_32x32x16_bf16 v[48:63], v[208:211], v[148:151], v[48:63]
    v_cvt_pk_bf16_f32 v146, v132, v133
    v_cvt_pk_bf16_f32 v147, v134, v135
    v_exp_f32 v136, v136
    v_exp_f32 v137, v137
    v_exp_f32 v138, v138
    v_exp_f32 v139, v139
    v_mfma_f32_32x32x16_bf16 v[64:79], v[204:207], v[144:147], v[64:79]
    v_cvt_pk_bf16_f32 v148, v136, v137
    v_cvt_pk_bf16_f32 v149, v138, v139
    v_exp_f32 v140, v140
    v_exp_f32 v141, v141
    v_exp_f32 v142, v142
    v_exp_f32 v143, v143
    v_cvt_pk_bf16_f32 v150, v140, v141
    v_cvt_pk_bf16_f32 v151, v142, v143
    v_mfma_f32_32x32x16_bf16 v[128:143], v[196:199], v[40:43], 0
    v_exp_f32 v112, v112
    v_exp_f32 v113, v113
    v_exp_f32 v114, v114
    v_exp_f32 v115, v115
    v_mfma_f32_32x32x16_bf16 v[128:143], v[200:203], v[44:47], v[128:143]
    v_cvt_pk_bf16_f32 v144, v112, v113
    v_cvt_pk_bf16_f32 v145, v114, v115
    v_exp_f32 v116, v116
    v_exp_f32 v117, v117
    v_exp_f32 v118, v118
    v_exp_f32 v119, v119
    v_mfma_f32_32x32x16_bf16 v[64:79], v[208:211], v[148:151], v[64:79]
    buffer_load_dwordx4 a[40:43], v1, s[8:11], s57 offen offset:2048 sc1
    buffer_load_dwordx4 a[44:47], v1, s[8:11], s57 offen offset:3072 sc1
    v_cvt_pk_bf16_f32 v146, v116, v117
    v_cvt_pk_bf16_f32 v147, v118, v119
    v_exp_f32 v120, v120
    v_exp_f32 v121, v121
    v_exp_f32 v122, v122
    v_exp_f32 v123, v123
    v_mfma_f32_32x32x16_bf16 v[80:95], v[204:207], v[144:147], v[80:95]
    v_cvt_pk_bf16_f32 v148, v120, v121
    v_cvt_pk_bf16_f32 v149, v122, v123
    v_exp_f32 v124, v124
    v_exp_f32 v125, v125
    v_exp_f32 v126, v126
    v_exp_f32 v127, v127
    v_cvt_pk_bf16_f32 v150, v124, v125
    v_cvt_pk_bf16_f32 v151, v126, v127
    s_waitcnt vmcnt(26)
    v_mfma_f32_32x32x16_bf16 v[112:127], v[212:215], v[16:19], 0
    v_exp_f32 v128, v128
    v_exp_f32 v129, v129
    v_exp_f32 v130, v130
    v_exp_f32 v131, v131
    v_mfma_f32_32x32x16_bf16 v[112:127], v[216:219], v[20:23], v[112:127]
    v_cvt_pk_bf16_f32 v144, v128, v129
    v_cvt_pk_bf16_f32 v145, v130, v131
    v_exp_f32 v132, v132
    v_exp_f32 v133, v133
    v_exp_f32 v134, v134
    v_exp_f32 v135, v135
    v_mfma_f32_32x32x16_bf16 v[80:95], v[208:211], v[148:151], v[80:95]
    v_cvt_pk_bf16_f32 v146, v132, v133
    v_cvt_pk_bf16_f32 v147, v134, v135
    v_exp_f32 v136, v136
    v_exp_f32 v137, v137
    v_exp_f32 v138, v138
    v_exp_f32 v139, v139
    v_mfma_f32_32x32x16_bf16 v[96:111], v[204:207], v[144:147], v[96:111]
    v_cvt_pk_bf16_f32 v148, v136, v137
    v_cvt_pk_bf16_f32 v149, v138, v139
    v_exp_f32 v140, v140
    v_exp_f32 v141, v141
    v_exp_f32 v142, v142
    v_exp_f32 v143, v143
    v_cvt_pk_bf16_f32 v150, v140, v141
    v_cvt_pk_bf16_f32 v151, v142, v143
    v_mfma_f32_32x32x16_bf16 v[128:143], v[212:215], v[24:27], 0
    v_exp_f32 v112, v112
    v_exp_f32 v113, v113
    v_exp_f32 v114, v114
    v_exp_f32 v115, v115
    v_mfma_f32_32x32x16_bf16 v[128:143], v[216:219], v[28:31], v[128:143]
    s_xor_b32 s23, s41, 32768
    v_cvt_pk_bf16_f32 v144, v112, v113
    v_cvt_pk_bf16_f32 v145, v114, v115
    v_exp_f32 v116, v116
    v_exp_f32 v117, v117
    v_exp_f32 v118, v118
    v_exp_f32 v119, v119
    v_mfma_f32_32x32x16_bf16 v[96:111], v[208:211], v[148:151], v[96:111]
    buffer_load_dwordx4 v[196:199], v1, s[8:11], s23 offen sc1
    buffer_load_dwordx4 v[200:203], v1, s[8:11], s23 offen offset:1024 sc1
    buffer_load_dwordx4 v[204:207], v1, s[8:11], s23 offen offset:2048 sc1
    buffer_load_dwordx4 v[208:211], v1, s[8:11], s23 offen offset:3072 sc1
    s_add_u32 s52, s50, 24576
    s_add_u32 m0, s51, 24576
    s_nop 0
    buffer_load_dwordx4 v1, s[8:11], s52 offen sc1 lds
    buffer_load_dwordx4 v1, s[8:11], s52 offen offset:1024 sc1 lds
    buffer_load_dwordx4 v1, s[8:11], s52 offen offset:2048 sc1 lds
    v_cvt_pk_bf16_f32 v146, v116, v117
    v_cvt_pk_bf16_f32 v147, v118, v119
    v_exp_f32 v120, v120
    v_exp_f32 v121, v121
    v_exp_f32 v122, v122
    v_exp_f32 v123, v123
    v_mfma_f32_32x32x16_bf16 v[48:63], v[220:223], v[144:147], v[48:63]
    v_cvt_pk_bf16_f32 v148, v120, v121
    v_cvt_pk_bf16_f32 v149, v122, v123
    v_exp_f32 v124, v124
    v_exp_f32 v125, v125
    v_exp_f32 v126, v126
    v_exp_f32 v127, v127
    v_cvt_pk_bf16_f32 v150, v124, v125
    v_cvt_pk_bf16_f32 v151, v126, v127
    v_mfma_f32_32x32x16_bf16 v[112:127], v[212:215], v[32:35], 0
    v_exp_f32 v128, v128
    v_exp_f32 v129, v129
    v_exp_f32 v130, v130
    v_exp_f32 v131, v131
    v_mfma_f32_32x32x16_bf16 v[112:127], v[216:219], v[36:39], v[112:127]
    v_cvt_pk_bf16_f32 v144, v128, v129
    v_cvt_pk_bf16_f32 v145, v130, v131
    v_exp_f32 v132, v132
    v_exp_f32 v133, v133
    v_exp_f32 v134, v134
    v_exp_f32 v135, v135
    v_mfma_f32_32x32x16_bf16 v[48:63], v[224:227], v[148:151], v[48:63]
    v_cvt_pk_bf16_f32 v146, v132, v133
    v_cvt_pk_bf16_f32 v147, v134, v135
    v_exp_f32 v136, v136
    v_exp_f32 v137, v137
    v_exp_f32 v138, v138
    v_exp_f32 v139, v139
    v_mfma_f32_32x32x16_bf16 v[64:79], v[220:223], v[144:147], v[64:79]
    v_cvt_pk_bf16_f32 v148, v136, v137
    v_cvt_pk_bf16_f32 v149, v138, v139
    v_exp_f32 v140, v140
    v_exp_f32 v141, v141
    v_exp_f32 v142, v142
    v_exp_f32 v143, v143
    v_cvt_pk_bf16_f32 v150, v140, v141
    v_cvt_pk_bf16_f32 v151, v142, v143
    v_mfma_f32_32x32x16_bf16 v[128:143], v[212:215], v[40:43], 0
    v_exp_f32 v112, v112
    v_exp_f32 v113, v113
    v_exp_f32 v114, v114
    v_exp_f32 v115, v115
    v_mfma_f32_32x32x16_bf16 v[128:143], v[216:219], v[44:47], v[128:143]
    v_cvt_pk_bf16_f32 v144, v112, v113
    v_cvt_pk_bf16_f32 v145, v114, v115
    v_exp_f32 v116, v116
    v_exp_f32 v117, v117
    v_exp_f32 v118, v118
    v_exp_f32 v119, v119
    v_mfma_f32_32x32x16_bf16 v[64:79], v[224:227], v[148:151], v[64:79]
    s_add_u32 s57, s34, 12288
    buffer_load_dwordx4 a[48:51], v1, s[8:11], s57 offen sc1
    buffer_load_dwordx4 a[52:55], v1, s[8:11], s57 offen offset:1024 sc1
    v_cvt_pk_bf16_f32 v146, v116, v117
    v_cvt_pk_bf16_f32 v147, v118, v119
    v_exp_f32 v120, v120
    v_exp_f32 v121, v121
    v_exp_f32 v122, v122
    v_exp_f32 v123, v123
    v_mfma_f32_32x32x16_bf16 v[80:95], v[220:223], v[144:147], v[80:95]
    v_cvt_pk_bf16_f32 v148, v120, v121
    v_cvt_pk_bf16_f32 v149, v122, v123
    v_exp_f32 v124, v124
    v_exp_f32 v125, v125
    v_exp_f32 v126, v126
    v_exp_f32 v127, v127
    v_cvt_pk_bf16_f32 v150, v124, v125
    v_cvt_pk_bf16_f32 v151, v126, v127
    s_waitcnt vmcnt(26)
    v_mfma_f32_32x32x16_bf16 v[112:127], v[180:183], v[16:19], 0
    v_exp_f32 v128, v128
    v_exp_f32 v129, v129
    v_exp_f32 v130, v130
    v_exp_f32 v131, v131
    v_mfma_f32_32x32x16_bf16 v[112:127], v[184:187], v[20:23], v[112:127]
    v_cvt_pk_bf16_f32 v144, v128, v129
    v_cvt_pk_bf16_f32 v145, v130, v131
    v_exp_f32 v132, v132
    v_exp_f32 v133, v133
    v_exp_f32 v134, v134
    v_exp_f32 v135, v135
    v_mfma_f32_32x32x16_bf16 v[80:95], v[224:227], v[148:151], v[80:95]
    v_cvt_pk_bf16_f32 v146, v132, v133
    v_cvt_pk_bf16_f32 v147, v134, v135
    v_exp_f32 v136, v136
    v_exp_f32 v137, v137
    v_exp_f32 v138, v138
    v_exp_f32 v139, v139
    v_mfma_f32_32x32x16_bf16 v[96:111], v[220:223], v[144:147], v[96:111]
    v_cvt_pk_bf16_f32 v148, v136, v137
    v_cvt_pk_bf16_f32 v149, v138, v139
    v_exp_f32 v140, v140
    v_exp_f32 v141, v141
    v_exp_f32 v142, v142
    v_exp_f32 v143, v143
    v_cvt_pk_bf16_f32 v150, v140, v141
    v_cvt_pk_bf16_f32 v151, v142, v143
    v_mfma_f32_32x32x16_bf16 v[128:143], v[180:183], v[24:27], 0
    v_exp_f32 v112, v112
    v_exp_f32 v113, v113
    v_exp_f32 v114, v114
    v_exp_f32 v115, v115
    v_mfma_f32_32x32x16_bf16 v[128:143], v[184:187], v[28:31], v[128:143]
    s_xor_b32 s23, s41, 16384
    v_cvt_pk_bf16_f32 v144, v112, v113
    v_cvt_pk_bf16_f32 v145, v114, v115
    v_exp_f32 v116, v116
    v_exp_f32 v117, v117
    v_exp_f32 v118, v118
    v_exp_f32 v119, v119
    v_mfma_f32_32x32x16_bf16 v[96:111], v[224:227], v[148:151], v[96:111]
    buffer_load_dwordx4 v[212:215], v1, s[8:11], s23 offen sc1
    buffer_load_dwordx4 v[216:219], v1, s[8:11], s23 offen offset:1024 sc1
    buffer_load_dwordx4 v[220:223], v1, s[8:11], s23 offen offset:2048 sc1
    buffer_load_dwordx4 v[224:227], v1, s[8:11], s23 offen offset:3072 sc1
    buffer_load_dwordx4 v1, s[8:11], s52 offen offset:3072 sc1 lds
    v_cvt_pk_bf16_f32 v146, v116, v117
    v_cvt_pk_bf16_f32 v147, v118, v119
    v_exp_f32 v120, v120
    v_exp_f32 v121, v121
    v_exp_f32 v122, v122
    v_exp_f32 v123, v123
    v_mfma_f32_32x32x16_bf16 v[48:63], v[188:191], v[144:147], v[48:63]
    v_cvt_pk_bf16_f32 v148, v120, v121
    v_cvt_pk_bf16_f32 v149, v122, v123
    v_exp_f32 v124, v124
    v_exp_f32 v125, v125
    v_exp_f32 v126, v126
    v_exp_f32 v127, v127
    v_cvt_pk_bf16_f32 v150, v124, v125
    v_cvt_pk_bf16_f32 v151, v126, v127
    v_mfma_f32_32x32x16_bf16 v[112:127], v[180:183], v[32:35], 0
    s_add_u32 s56, s20, 0
    v_lshlrev_b32 v14, 5, v0
    buffer_load_dword v9, v14, s[8:11], s56 offen sc1
    v_exp_f32 v128, v128
    v_exp_f32 v129, v129
    v_exp_f32 v130, v130
    v_exp_f32 v131, v131
    v_mfma_f32_32x32x16_bf16 v[112:127], v[184:187], v[36:39], v[112:127]
    v_cvt_pk_bf16_f32 v144, v128, v129
    v_cvt_pk_bf16_f32 v145, v130, v131
    v_exp_f32 v132, v132
    v_exp_f32 v133, v133
    v_exp_f32 v134, v134
    v_exp_f32 v135, v135
    v_mfma_f32_32x32x16_bf16 v[48:63], v[192:195], v[148:151], v[48:63]
    v_cvt_pk_bf16_f32 v146, v132, v133
    v_cvt_pk_bf16_f32 v147, v134, v135
    v_exp_f32 v136, v136
    v_exp_f32 v137, v137
    v_exp_f32 v138, v138
    v_exp_f32 v139, v139
    v_mfma_f32_32x32x16_bf16 v[64:79], v[188:191], v[144:147], v[64:79]
    v_cvt_pk_bf16_f32 v148, v136, v137
    v_cvt_pk_bf16_f32 v149, v138, v139
    v_exp_f32 v140, v140
    v_exp_f32 v141, v141
    v_exp_f32 v142, v142
    v_exp_f32 v143, v143
    v_cvt_pk_bf16_f32 v150, v140, v141
    v_cvt_pk_bf16_f32 v151, v142, v143
    v_mfma_f32_32x32x16_bf16 v[128:143], v[180:183], v[40:43], 0
    s_lshl_b32 s56, s31, 7
    s_add_u32 s56, s56, 1703936
    buffer_load_dword v9, v5, s[8:11], s56 offen sc1
    s_add_u32 s56, s56, 8192
    buffer_load_dword v9, v5, s[8:11], s56 offen sc1
    v_exp_f32 v112, v112
    v_exp_f32 v113, v113
    v_exp_f32 v114, v114
    v_exp_f32 v115, v115
    v_mfma_f32_32x32x16_bf16 v[128:143], v[184:187], v[44:47], v[128:143]
    v_cvt_pk_bf16_f32 v144, v112, v113
    v_cvt_pk_bf16_f32 v145, v114, v115
    v_exp_f32 v116, v116
    v_exp_f32 v117, v117
    v_exp_f32 v118, v118
    v_exp_f32 v119, v119
    v_mfma_f32_32x32x16_bf16 v[64:79], v[192:195], v[148:151], v[64:79]
    v_cvt_pk_bf16_f32 v146, v116, v117
    v_cvt_pk_bf16_f32 v147, v118, v119
    v_exp_f32 v120, v120
    v_exp_f32 v121, v121
    v_exp_f32 v122, v122
    v_exp_f32 v123, v123
    v_mfma_f32_32x32x16_bf16 v[80:95], v[188:191], v[144:147], v[80:95]
    v_cvt_pk_bf16_f32 v148, v120, v121
    v_cvt_pk_bf16_f32 v149, v122, v123
    v_exp_f32 v124, v124
    v_exp_f32 v125, v125
    v_exp_f32 v126, v126
    v_exp_f32 v127, v127
    v_cvt_pk_bf16_f32 v150, v124, v125
    v_cvt_pk_bf16_f32 v151, v126, v127
    s_waitcnt vmcnt(22)
    v_mfma_f32_32x32x16_bf16 v[112:127], v[152:155], v[16:19], 0
    s_add_u32 s56, s12, 6291456
    v_lshlrev_b32 v14, 5, v0
    buffer_load_dword v9, v14, s[8:11], s56 offen sc1
    v_exp_f32 v128, v128
    v_exp_f32 v129, v129
    v_exp_f32 v130, v130
    v_exp_f32 v131, v131
    v_mfma_f32_32x32x16_bf16 v[112:127], v[156:159], v[20:23], v[112:127]
    v_cvt_pk_bf16_f32 v144, v128, v129
    v_cvt_pk_bf16_f32 v145, v130, v131
    v_exp_f32 v132, v132
    v_exp_f32 v133, v133
    v_exp_f32 v134, v134
    v_exp_f32 v135, v135
    v_mfma_f32_32x32x16_bf16 v[80:95], v[192:195], v[148:151], v[80:95]
    s_add_u32 s56, s13, 6291456
    v_lshlrev_b32 v14, 2, v0
    buffer_load_dword v9, v14, s[8:11], s56 offen sc1
    v_cvt_pk_bf16_f32 v146, v132, v133
    v_cvt_pk_bf16_f32 v147, v134, v135
    v_exp_f32 v136, v136
    v_exp_f32 v137, v137
    v_exp_f32 v138, v138
    v_exp_f32 v139, v139
    v_mfma_f32_32x32x16_bf16 v[96:111], v[188:191], v[144:147], v[96:111]
    v_cvt_pk_bf16_f32 v148, v136, v137
    v_cvt_pk_bf16_f32 v149, v138, v139
    v_exp_f32 v140, v140
    v_exp_f32 v141, v141
    v_exp_f32 v142, v142
    v_exp_f32 v143, v143
    v_cvt_pk_bf16_f32 v150, v140, v141
    v_cvt_pk_bf16_f32 v151, v142, v143
    v_mfma_f32_32x32x16_bf16 v[128:143], v[152:155], v[24:27], 0
    v_exp_f32 v112, v112
    v_exp_f32 v113, v113
    v_exp_f32 v114, v114
    v_exp_f32 v115, v115
    v_mfma_f32_32x32x16_bf16 v[128:143], v[156:159], v[28:31], v[128:143]
    v_cvt_pk_bf16_f32 v144, v112, v113
    v_cvt_pk_bf16_f32 v145, v114, v115
    v_exp_f32 v116, v116
    v_exp_f32 v117, v117
    v_exp_f32 v118, v118
    v_exp_f32 v119, v119
    v_mfma_f32_32x32x16_bf16 v[96:111], v[192:195], v[148:151], v[96:111]
    s_mov_b32 s53, s46
    buffer_load_dwordx4 v[180:183], v1, s[8:11], s53 offen sc1
    buffer_load_dwordx4 v[184:187], v1, s[8:11], s53 offen offset:1024 sc1
    buffer_load_dwordx4 v[188:191], v1, s[8:11], s53 offen offset:2048 sc1
    buffer_load_dwordx4 v[192:195], v1, s[8:11], s53 offen offset:3072 sc1
    v_cvt_pk_bf16_f32 v146, v116, v117
    v_cvt_pk_bf16_f32 v147, v118, v119
    v_exp_f32 v120, v120
    v_exp_f32 v121, v121
    v_exp_f32 v122, v122
    v_exp_f32 v123, v123
    v_mfma_f32_32x32x16_bf16 v[48:63], v[160:163], v[144:147], v[48:63]
    v_cvt_pk_bf16_f32 v148, v120, v121
    v_cvt_pk_bf16_f32 v149, v122, v123
    v_exp_f32 v124, v124
    v_exp_f32 v125, v125
    v_exp_f32 v126, v126
    v_exp_f32 v127, v127
    v_cvt_pk_bf16_f32 v150, v124, v125
    v_cvt_pk_bf16_f32 v151, v126, v127
    v_mfma_f32_32x32x16_bf16 v[112:127], v[152:155], v[32:35], 0
    s_lshl_b32 s56, s29, 6
    s_add_u32 s56, s56, 1708032
    buffer_load_dword v9, v6, s[8:11], s56 offen sc1
    s_lshl_b32 s56, s36, 6
    s_add_u32 s56, s56, 1912832
    buffer_load_dword v9, v6, s[8:11], s56 offen sc1
    v_exp_f32 v128, v128
    v_exp_f32 v129, v129
    v_exp_f32 v130, v130
    v_exp_f32 v131, v131
    v_mfma_f32_32x32x16_bf16 v[112:127], v[156:159], v[36:39], v[112:127]
    v_cvt_pk_bf16_f32 v144, v128, v129
    v_cvt_pk_bf16_f32 v145, v130, v131
    v_exp_f32 v132, v132
    v_exp_f32 v133, v133
    v_exp_f32 v134, v134
    v_exp_f32 v135, v135
    v_mfma_f32_32x32x16_bf16 v[48:63], v[164:167], v[148:151], v[48:63]
    v_cvt_pk_bf16_f32 v146, v132, v133
    v_cvt_pk_bf16_f32 v147, v134, v135
    v_exp_f32 v136, v136
    v_exp_f32 v137, v137
    v_exp_f32 v138, v138
    v_exp_f32 v139, v139
    v_mfma_f32_32x32x16_bf16 v[64:79], v[160:163], v[144:147], v[64:79]
    v_cvt_pk_bf16_f32 v148, v136, v137
    v_cvt_pk_bf16_f32 v149, v138, v139
    v_exp_f32 v140, v140
    v_exp_f32 v141, v141
    v_exp_f32 v142, v142
    v_exp_f32 v143, v143
    v_cvt_pk_bf16_f32 v150, v140, v141
    v_cvt_pk_bf16_f32 v151, v142, v143
    v_mfma_f32_32x32x16_bf16 v[128:143], v[152:155], v[40:43], 0
    v_exp_f32 v112, v112
    v_exp_f32 v113, v113
    v_exp_f32 v114, v114
    v_exp_f32 v115, v115
    v_mfma_f32_32x32x16_bf16 v[128:143], v[156:159], v[44:47], v[128:143]
    v_cvt_pk_bf16_f32 v144, v112, v113
    v_cvt_pk_bf16_f32 v145, v114, v115
    v_exp_f32 v116, v116
    v_exp_f32 v117, v117
    v_exp_f32 v118, v118
    v_exp_f32 v119, v119
    v_mfma_f32_32x32x16_bf16 v[64:79], v[164:167], v[148:151], v[64:79]
    v_cvt_pk_bf16_f32 v146, v116, v117
    v_cvt_pk_bf16_f32 v147, v118, v119
    v_exp_f32 v120, v120
    v_exp_f32 v121, v121
    v_exp_f32 v122, v122
    v_exp_f32 v123, v123
    v_mfma_f32_32x32x16_bf16 v[80:95], v[160:163], v[144:147], v[80:95]
    v_cvt_pk_bf16_f32 v148, v120, v121
    v_cvt_pk_bf16_f32 v149, v122, v123
    v_exp_f32 v124, v124
    v_exp_f32 v125, v125
    v_exp_f32 v126, v126
    v_exp_f32 v127, v127
    v_cvt_pk_bf16_f32 v150, v124, v125
    v_cvt_pk_bf16_f32 v151, v126, v127
    s_waitcnt vmcnt(21)
    v_mfma_f32_32x32x16_bf16 v[112:127], v[196:199], v[24:27], 0
    v_exp_f32 v128, v128
    v_exp_f32 v129, v129
    v_exp_f32 v130, v130
    v_exp_f32 v131, v131
    v_mfma_f32_32x32x16_bf16 v[112:127], v[200:203], v[28:31], v[112:127]
    v_cvt_pk_bf16_f32 v144, v128, v129
    v_cvt_pk_bf16_f32 v145, v130, v131
    v_exp_f32 v132, v132
    v_exp_f32 v133, v133
    v_exp_f32 v134, v134
    v_exp_f32 v135, v135
    v_mfma_f32_32x32x16_bf16 v[80:95], v[164:167], v[148:151], v[80:95]
    v_cvt_pk_bf16_f32 v146, v132, v133
    v_cvt_pk_bf16_f32 v147, v134, v135
    v_exp_f32 v136, v136
    v_exp_f32 v137, v137
    v_exp_f32 v138, v138
    v_exp_f32 v139, v139
    v_mfma_f32_32x32x16_bf16 v[96:111], v[160:163], v[144:147], v[96:111]
    v_cvt_pk_bf16_f32 v148, v136, v137
    v_cvt_pk_bf16_f32 v149, v138, v139
    v_exp_f32 v140, v140
    v_exp_f32 v141, v141
    v_exp_f32 v142, v142
    v_exp_f32 v143, v143
    v_cvt_pk_bf16_f32 v150, v140, v141
    v_cvt_pk_bf16_f32 v151, v142, v143
    s_waitcnt vmcnt(38)
    v_cmp_eq_u32 vcc, s54, v172
    s_nop 0
    s_cmp_eq_u64 vcc, -1
    s_cselect_b32 s90, 268435456, 0
    s_waitcnt vmcnt(12)
    v_mfma_f32_32x32x16_bf16 v[128:143], v[212:215], v[24:27], 0
    v_exp_f32 v112, v112
    v_exp_f32 v113, v113
    v_exp_f32 v114, v114
    v_exp_f32 v115, v115
    v_mfma_f32_32x32x16_bf16 v[128:143], v[216:219], v[28:31], v[128:143]
    v_cvt_pk_bf16_f32 v144, v112, v113
    v_cvt_pk_bf16_f32 v145, v114, v115
    v_exp_f32 v116, v116
    v_exp_f32 v117, v117
    v_exp_f32 v118, v118
    v_exp_f32 v119, v119
    v_mfma_f32_32x32x16_bf16 v[96:111], v[164:167], v[148:151], v[96:111]
    s_add_u32 s53, s46, 4096
    buffer_load_dwordx4 v[152:155], v1, s[8:11], s53 offen sc1
    buffer_load_dwordx4 v[156:159], v1, s[8:11], s53 offen offset:1024 sc1
    buffer_load_dwordx4 v[160:163], v1, s[8:11], s53 offen offset:2048 sc1
    buffer_load_dwordx4 v[164:167], v1, s[8:11], s53 offen offset:3072 sc1
    s_add_u32 s53, s46, 8192
    buffer_load_dwordx4 v[24:27], v1, s[8:11], s53 offen sc1
    buffer_load_dwordx4 v[28:31], v1, s[8:11], s53 offen offset:1024 sc1
    v_cvt_pk_bf16_f32 v146, v116, v117
    v_cvt_pk_bf16_f32 v147, v118, v119
    v_exp_f32 v120, v120
    v_exp_f32 v121, v121
    v_exp_f32 v122, v122
    v_exp_f32 v123, v123
    v_mfma_f32_32x32x16_bf16 v[64:79], v[204:207], v[144:147], v[64:79]
    v_cvt_pk_bf16_f32 v148, v120, v121
    v_cvt_pk_bf16_f32 v149, v122, v123
    v_exp_f32 v124, v124
    v_exp_f32 v125, v125
    v_exp_f32 v126, v126
    v_exp_f32 v127, v127
    v_cvt_pk_bf16_f32 v150, v124, v125
    v_cvt_pk_bf16_f32 v151, v126, v127
    v_mfma_f32_32x32x16_bf16 v[112:127], v[196:199], v[32:35], 0
    v_exp_f32 v128, v128
    v_exp_f32 v129, v129
    v_exp_f32 v130, v130
    v_exp_f32 v131, v131
    v_mfma_f32_32x32x16_bf16 v[112:127], v[200:203], v[36:39], v[112:127]
    v_cvt_pk_bf16_f32 v144, v128, v129
    v_cvt_pk_bf16_f32 v145, v130, v131
    v_exp_f32 v132, v132
    v_exp_f32 v133, v133
    v_exp_f32 v134, v134
    v_exp_f32 v135, v135
    v_mfma_f32_32x32x16_bf16 v[64:79], v[208:211], v[148:151], v[64:79]
    v_cvt_pk_bf16_f32 v146, v132, v133
    v_cvt_pk_bf16_f32 v147, v134, v135
    v_exp_f32 v136, v136
    v_exp_f32 v137, v137
    v_exp_f32 v138, v138
    v_exp_f32 v139, v139
    v_mfma_f32_32x32x16_bf16 v[64:79], v[220:223], v[144:147], v[64:79]
    v_cvt_pk_bf16_f32 v148, v136, v137
    v_cvt_pk_bf16_f32 v149, v138, v139
    v_exp_f32 v140, v140
    v_exp_f32 v141, v141
    v_exp_f32 v142, v142
    v_exp_f32 v143, v143
    v_cvt_pk_bf16_f32 v150, v140, v141
    v_cvt_pk_bf16_f32 v151, v142, v143
    v_mfma_f32_32x32x16_bf16 v[128:143], v[212:215], v[32:35], 0
    v_exp_f32 v112, v112
    v_exp_f32 v113, v113
    v_exp_f32 v114, v114
    v_exp_f32 v115, v115
    v_mfma_f32_32x32x16_bf16 v[128:143], v[216:219], v[36:39], v[128:143]
    v_cvt_pk_bf16_f32 v144, v112, v113
    v_cvt_pk_bf16_f32 v145, v114, v115
    v_exp_f32 v116, v116
    v_exp_f32 v117, v117
    v_exp_f32 v118, v118
    v_exp_f32 v119, v119
    v_mfma_f32_32x32x16_bf16 v[64:79], v[224:227], v[148:151], v[64:79]
    s_add_u32 s53, s46, 8192
    buffer_load_dwordx4 v[32:35], v1, s[8:11], s53 offen offset:2048 sc1
    buffer_load_dwordx4 v[36:39], v1, s[8:11], s53 offen offset:3072 sc1
    v_cvt_pk_bf16_f32 v146, v116, v117
    v_cvt_pk_bf16_f32 v147, v118, v119
    v_exp_f32 v120, v120
    v_exp_f32 v121, v121
    v_exp_f32 v122, v122
    v_exp_f32 v123, v123
    v_mfma_f32_32x32x16_bf16 v[80:95], v[204:207], v[144:147], v[80:95]
    v_cvt_pk_bf16_f32 v148, v120, v121
    v_cvt_pk_bf16_f32 v149, v122, v123
    v_exp_f32 v124, v124
    v_exp_f32 v125, v125
    v_exp_f32 v126, v126
    v_exp_f32 v127, v127
    v_cvt_pk_bf16_f32 v150, v124, v125
    v_cvt_pk_bf16_f32 v151, v126, v127
    v_mfma_f32_32x32x16_bf16 v[112:127], v[196:199], v[40:43], 0
    ds_write_b128 v10, v[64:67]
    v_exp_f32 v128, v128
    v_exp_f32 v129, v129
    v_exp_f32 v130, v130
    v_exp_f32 v131, v131
    v_mfma_f32_32x32x16_bf16 v[112:127], v[200:203], v[44:47], v[112:127]
    ds_write_b128 v10, v[68:71] offset:1024
    v_cvt_pk_bf16_f32 v144, v128, v129
    v_cvt_pk_bf16_f32 v145, v130, v131
    v_exp_f32 v132, v132
    v_exp_f32 v133, v133
    v_exp_f32 v134, v134
    v_exp_f32 v135, v135
    v_mfma_f32_32x32x16_bf16 v[80:95], v[208:211], v[148:151], v[80:95]
    ds_write_b128 v10, v[72:75] offset:2048
    v_cvt_pk_bf16_f32 v146, v132, v133
    v_cvt_pk_bf16_f32 v147, v134, v135
    v_exp_f32 v136, v136
    v_exp_f32 v137, v137
    v_exp_f32 v138, v138
    v_exp_f32 v139, v139
    v_mfma_f32_32x32x16_bf16 v[80:95], v[220:223], v[144:147], v[80:95]
    ds_write_b128 v10, v[76:79] offset:3072
    v_cvt_pk_bf16_f32 v148, v136, v137
    v_cvt_pk_bf16_f32 v149, v138, v139
    v_exp_f32 v140, v140
    v_exp_f32 v141, v141
    v_exp_f32 v142, v142
    v_exp_f32 v143, v143
    v_cvt_pk_bf16_f32 v150, v140, v141
    v_cvt_pk_bf16_f32 v151, v142, v143
    v_mfma_f32_32x32x16_bf16 v[128:143], v[212:215], v[40:43], 0
    v_exp_f32 v112, v112
    v_exp_f32 v113, v113
    v_exp_f32 v114, v114
    v_exp_f32 v115, v115
    v_mfma_f32_32x32x16_bf16 v[128:143], v[216:219], v[44:47], v[128:143]
    v_cvt_pk_bf16_f32 v144, v112, v113
    v_cvt_pk_bf16_f32 v145, v114, v115
    v_exp_f32 v116, v116
    v_exp_f32 v117, v117
    v_exp_f32 v118, v118
    v_exp_f32 v119, v119
    v_mfma_f32_32x32x16_bf16 v[80:95], v[224:227], v[148:151], v[80:95]
    s_add_u32 s53, s46, 12288
    buffer_load_dwordx4 v[40:43], v1, s[8:11], s53 offen sc1
    buffer_load_dwordx4 v[44:47], v1, s[8:11], s53 offen offset:1024 sc1
    v_cvt_pk_bf16_f32 v146, v116, v117
    v_cvt_pk_bf16_f32 v147, v118, v119
    v_exp_f32 v120, v120
    v_exp_f32 v121, v121
    v_exp_f32 v122, v122
    v_exp_f32 v123, v123
    v_mfma_f32_32x32x16_bf16 v[96:111], v[204:207], v[144:147], v[96:111]
    v_cvt_pk_bf16_f32 v148, v120, v121
    v_cvt_pk_bf16_f32 v149, v122, v123
    v_exp_f32 v124, v124
    v_exp_f32 v125, v125
    v_exp_f32 v126, v126
    v_exp_f32 v127, v127
    v_cvt_pk_bf16_f32 v150, v124, v125
    v_cvt_pk_bf16_f32 v151, v126, v127
    v_mfma_f32_32x32x16_bf16 v[112:127], v[196:199], v[16:19], 0
    ds_write_b128 v11, v[80:83] offset:16384
    v_exp_f32 v128, v128
    v_exp_f32 v129, v129
    v_exp_f32 v130, v130
    v_exp_f32 v131, v131
    v_mfma_f32_32x32x16_bf16 v[112:127], v[200:203], v[20:23], v[112:127]
    ds_write_b128 v11, v[84:87] offset:17408
    v_cvt_pk_bf16_f32 v144, v128, v129
    v_cvt_pk_bf16_f32 v145, v130, v131
    v_exp_f32 v132, v132
    v_exp_f32 v133, v133
    v_exp_f32 v134, v134
    v_exp_f32 v135, v135
    v_mfma_f32_32x32x16_bf16 v[96:111], v[208:211], v[148:151], v[96:111]
    ds_write_b128 v11, v[88:91] offset:18432
    v_cvt_pk_bf16_f32 v146, v132, v133
    v_cvt_pk_bf16_f32 v147, v134, v135
    v_exp_f32 v136, v136
    v_exp_f32 v137, v137
    v_exp_f32 v138, v138
    v_exp_f32 v139, v139
    v_mfma_f32_32x32x16_bf16 v[96:111], v[220:223], v[144:147], v[96:111]
    ds_write_b128 v11, v[92:95] offset:19456
    v_cvt_pk_bf16_f32 v148, v136, v137
    v_cvt_pk_bf16_f32 v149, v138, v139
    v_exp_f32 v140, v140
    v_exp_f32 v141, v141
    v_exp_f32 v142, v142
    v_exp_f32 v143, v143
    v_cvt_pk_bf16_f32 v150, v140, v141
    v_cvt_pk_bf16_f32 v151, v142, v143
    v_mfma_f32_32x32x16_bf16 v[128:143], v[212:215], v[16:19], 0
    v_exp_f32 v112, v112
    v_exp_f32 v113, v113
    v_exp_f32 v114, v114
    v_exp_f32 v115, v115
    v_mfma_f32_32x32x16_bf16 v[128:143], v[216:219], v[20:23], v[128:143]
    v_cvt_pk_bf16_f32 v144, v112, v113
    v_cvt_pk_bf16_f32 v145, v114, v115
    v_exp_f32 v116, v116
    v_exp_f32 v117, v117
    v_exp_f32 v118, v118
    v_exp_f32 v119, v119
    v_mfma_f32_32x32x16_bf16 v[96:111], v[224:227], v[148:151], v[96:111]
    v_cvt_pk_bf16_f32 v146, v116, v117
    v_cvt_pk_bf16_f32 v147, v118, v119
    v_exp_f32 v120, v120
    v_exp_f32 v121, v121
    v_exp_f32 v122, v122
    v_exp_f32 v123, v123
    v_mfma_f32_32x32x16_bf16 v[48:63], v[204:207], v[144:147], v[48:63]
    v_cvt_pk_bf16_f32 v148, v120, v121
    v_cvt_pk_bf16_f32 v149, v122, v123
    v_exp_f32 v124, v124
    v_exp_f32 v125, v125
    v_exp_f32 v126, v126
    v_exp_f32 v127, v127
    v_cvt_pk_bf16_f32 v150, v124, v125
    v_cvt_pk_bf16_f32 v151, v126, v127
    ds_write_b128 v12, v[96:99] offset:32768
    ds_write_b128 v12, v[100:103] offset:33792
    ds_write_b128 v12, v[104:107] offset:34816
    ds_write_b128 v12, v[108:111] offset:35840
    v_exp_f32 v128, v128
    v_exp_f32 v129, v129
    v_exp_f32 v130, v130
    v_exp_f32 v131, v131
    s_waitcnt lgkmcnt(0)
    s_barrier
    ds_read_b128 v[64:67], v13
    ds_read_b128 v[68:71], v13 offset:1024
    ds_read_b128 v[72:75], v13 offset:2048
    ds_read_b128 v[76:79], v13 offset:3072
    ds_read_b128 v[80:83], v13 offset:16384
    ds_read_b128 v[84:87], v13 offset:17408
    ds_read_b128 v[88:91], v13 offset:18432
    ds_read_b128 v[92:95], v13 offset:19456
    ds_read_b128 v[96:99], v13 offset:32768
    ds_read_b128 v[100:103], v13 offset:33792
    ds_read_b128 v[104:107], v13 offset:34816
    ds_read_b128 v[108:111], v13 offset:35840
    v_cvt_pk_bf16_f32 v144, v128, v129
    v_cvt_pk_bf16_f32 v145, v130, v131
    v_exp_f32 v132, v132
    v_exp_f32 v133, v133
    v_exp_f32 v134, v134
    v_exp_f32 v135, v135
    v_mfma_f32_32x32x16_bf16 v[48:63], v[208:211], v[148:151], v[48:63]
    v_cvt_pk_bf16_f32 v146, v132, v133
    v_cvt_pk_bf16_f32 v147, v134, v135
    v_exp_f32 v136, v136
    v_exp_f32 v137, v137
    v_exp_f32 v138, v138
    v_exp_f32 v139, v139
    v_mfma_f32_32x32x16_bf16 v[48:63], v[220:223], v[144:147], v[48:63]
    v_cvt_pk_bf16_f32 v148, v136, v137
    v_cvt_pk_bf16_f32 v149, v138, v139
    v_exp_f32 v140, v140
    v_exp_f32 v141, v141
    v_exp_f32 v142, v142
    v_exp_f32 v143, v143
    v_cvt_pk_bf16_f32 v150, v140, v141
    v_cvt_pk_bf16_f32 v151, v142, v143
    s_waitcnt lgkmcnt(0)
    v_pk_add_f32 v[76:77], v[76:77], v[92:93]
    v_mfma_f32_32x32x16_bf16 v[48:63], v[224:227], v[148:151], v[48:63]
    s_mov_b32 s7, 0x4e800000
    v_pk_add_f32 v[64:65], v[64:65], v[80:81]
    v_pk_add_f32 v[66:67], v[66:67], v[82:83]
    v_pk_add_f32 v[68:69], v[68:69], v[84:85]
    v_pk_add_f32 v[70:71], v[70:71], v[86:87]
    v_pk_add_f32 v[72:73], v[72:73], v[88:89]
    v_pk_add_f32 v[74:75], v[74:75], v[90:91]
    v_pk_add_f32 v[78:79], v[78:79], v[94:95]
    v_pk_add_f32 v[76:77], v[76:77], v[108:109]
    v_pk_add_f32 v[64:65], v[64:65], v[96:97]
    v_pk_add_f32 v[66:67], v[66:67], v[98:99]
    v_pk_add_f32 v[68:69], v[68:69], v[100:101]
    v_pk_add_f32 v[70:71], v[70:71], v[102:103]
    v_pk_add_f32 v[72:73], v[72:73], v[104:105]
    v_pk_add_f32 v[74:75], v[74:75], v[106:107]
    v_pk_add_f32 v[78:79], v[78:79], v[110:111]
    v_pk_add_f32 v[60:61], v[60:61], v[76:77]
    v_pk_add_f32 v[48:49], v[48:49], v[64:65]
    v_cmp_nlt_f32 vcc, v60, s7
    v_mov_b32 v112, v60
    v_mov_b32 v113, v60
    v_pk_add_f32 v[50:51], v[50:51], v[66:67]
    s_and_b64 vcc, vcc, s[24:25]
    v_permlane32_swap_b32 v112, v113
    s_cbranch_scc1 AEXACT0
    v_rcp_f32 v114, v113
    v_pk_add_f32 v[52:53], v[52:53], v[68:69]
    v_pk_add_f32 v[54:55], v[54:55], v[70:71]
    v_pk_add_f32 v[56:57], v[56:57], v[72:73]
    v_pk_add_f32 v[58:59], v[58:59], v[74:75]
    v_pk_add_f32 v[62:63], v[62:63], v[78:79]
    v_pk_mul_f32 v[48:49], v[48:49], v[114:115] op_sel_hi:[1,0]
    v_pk_mul_f32 v[50:51], v[50:51], v[114:115] op_sel_hi:[1,0]
    v_pk_mul_f32 v[52:53], v[52:53], v[114:115] op_sel_hi:[1,0]
    v_pk_mul_f32 v[54:55], v[54:55], v[114:115] op_sel_hi:[1,0]
    v_pk_mul_f32 v[56:57], v[56:57], v[114:115] op_sel_hi:[1,0]
    v_pk_mul_f32 v[58:59], v[58:59], v[114:115] op_sel_hi:[1,0]
    v_pk_mul_f32 v[60:61], v[60:61], v[114:115] op_sel_hi:[1,0]
    v_pk_mul_f32 v[62:63], v[62:63], v[114:115] op_sel_hi:[1,0]
ASTORE0:
    v_cvt_pk_bf16_f32 v144, v48, v49
    v_cvt_pk_bf16_f32 v145, v50, v51
    v_cvt_pk_bf16_f32 v146, v52, v53
    v_cvt_pk_bf16_f32 v147, v54, v55
    buffer_store_dwordx4 v[144:147], v1, s[88:91], s20 offen
    v_cvt_pk_bf16_f32 v148, v56, v57
    v_cvt_pk_bf16_f32 v149, v58, v59
    v_cvt_pk_bf16_f32 v150, v60, v61
    v_cvt_pk_bf16_f32 v151, v62, v63
    v_cndmask_b32 v150, v150, 0, s[24:25]
    v_cndmask_b32 v151, v151, 0, s[24:25]
    buffer_store_dwordx4 v[148:151], v1, s[88:91], s20 offen offset:1024
    s_cmp_eq_u32 s90, 0
    s_cbranch_scc1 REM_1
    s_mov_b64 exec, 1
    s_waitcnt vmcnt(0)
    buffer_store_dword v8, off, s[8:11], s22
REM_1B:
    s_mov_b64 exec, -1
    s_barrier
    s_cmp_ge_u32 s5, 28
    s_cbranch_scc1 IDLE0
    s_lshl_b32 s39, s31, 7
    s_add_u32 s39, s39, 1703936
    s_lshl_b32 s40, s48, 15
    s_lshl_b32 s7, s3, 13
    s_add_u32 s40, s40, s7
    s_add_u32 s40, s40, 4194304
    s_xor_b32 s41, s40, 0x8000
    s_lshl_b32 s23, s49, 6
    v_lshrrev_b32 v15, 5, v0
    v_lshlrev_b32 v15, 3, v15
    v_permlane32_swap_b32 v248, v250
    v_permlane32_swap_b32 v249, v251
    v_permlane32_swap_b32 v252, v254
    v_permlane32_swap_b32 v253, v255
    v_lshlrev_b32 v240, 16, v248
    v_and_b32 v241, 0xffff0000, v248
    v_lshlrev_b32 v242, 16, v249
    v_and_b32 v243, 0xffff0000, v249
    v_lshlrev_b32 v244, 16, v250
    v_and_b32 v245, 0xffff0000, v250
    v_lshlrev_b32 v246, 16, v251
    v_and_b32 v247, 0xffff0000, v251
    v_lshlrev_b32 v248, 16, v252
    v_and_b32 v249, 0xffff0000, v252
    v_lshlrev_b32 v250, 16, v253
    v_and_b32 v251, 0xffff0000, v253
    v_lshlrev_b32 v252, 16, v254
    v_and_b32 v253, 0xffff0000, v254
    v_lshlrev_b32 v254, 16, v255
    v_and_b32 v255, 0xffff0000, v255
    s_mov_b32 s7, 0
POLL_2:
    buffer_load_dword v14, v5, s[8:11], s39 offen sc1
    s_waitcnt vmcnt(0)
    v_cmp_eq_u32 vcc, v8, v14
    s_nop 0
    s_cmp_eq_u64 vcc, -1
    s_cbranch_scc1 POLLD_3
    s_sleep 1
    s_add_u32 s7, s7, 1
    s_cmp_lt_u32 s7, 0x8000
    s_cbranch_scc1 POLL_2
POLLD_3:
    s_mov_b32 s20, s41
    buffer_load_dwordx4 v[48:51], v1, s[8:11], s20 offen sc1
    buffer_load_dwordx4 v[52:55], v1, s[8:11], s20 offen offset:1024 sc1
    buffer_load_dwordx4 v[56:59], v1, s[8:11], s20 offen offset:2048 sc1
    buffer_load_dwordx4 v[60:63], v1, s[8:11], s20 offen offset:3072 sc1
    s_add_u32 s20, s41, 4096
    buffer_load_dwordx4 v[64:67], v1, s[8:11], s20 offen sc1
    buffer_load_dwordx4 v[68:71], v1, s[8:11], s20 offen offset:1024 sc1
    buffer_load_dwordx4 v[72:75], v1, s[8:11], s20 offen offset:2048 sc1
    buffer_load_dwordx4 v[76:79], v1, s[8:11], s20 offen offset:3072 sc1
    s_mov_b32 s20, s40
    buffer_load_dwordx4 v[80:83], v1, s[8:11], s20 offen sc1
    buffer_load_dwordx4 v[84:87], v1, s[8:11], s20 offen offset:1024 sc1
    s_waitcnt vmcnt(9)
    v_mfma_f32_32x32x16_bf16 v[128:143], v[180:183], v[48:51], 0
    v_mfma_f32_32x32x16_bf16 v[212:227], v[184:187], v[48:51], 0
    buffer_load_dwordx4 v[88:91], v1, s[8:11], s20 offen offset:2048 sc1
    s_waitcnt vmcnt(9)
    v_mfma_f32_32x32x16_bf16 v[128:143], v[188:191], v[52:55], v[128:143]
    v_mfma_f32_32x32x16_bf16 v[212:227], v[192:195], v[52:55], v[212:227]
    buffer_load_dwordx4 v[92:95], v1, s[8:11], s20 offen offset:3072 sc1
    s_waitcnt vmcnt(9)
    v_mfma_f32_32x32x16_bf16 v[128:143], v[152:155], v[56:59], v[128:143]
    s_add_u32 s20, s40, 4096
    buffer_load_dwordx4 v[96:99], v1, s[8:11], s20 offen sc1
    v_mfma_f32_32x32x16_bf16 v[212:227], v[156:159], v[56:59], v[212:227]
    buffer_load_dwordx4 v[100:103], v1, s[8:11], s20 offen offset:1024 sc1
    s_waitcnt vmcnt(10)
    v_mfma_f32_32x32x16_bf16 v[128:143], v[160:163], v[60:63], v[128:143]
    v_mfma_f32_32x32x16_bf16 v[212:227], v[164:167], v[60:63], v[212:227]
    buffer_load_dwordx4 v[104:107], v1, s[8:11], s20 offen offset:2048 sc1
    s_waitcnt vmcnt(10)
    v_mfma_f32_32x32x16_bf16 v[128:143], v[24:27], v[64:67], v[128:143]
    buffer_load_dwordx4 v[108:111], v1, s[8:11], s20 offen offset:3072 sc1
    v_mfma_f32_32x32x16_bf16 v[212:227], v[28:31], v[64:67], v[212:227]
    buffer_load_dwordx2 v[196:197], v15, s[96:99], s23 offen
    s_waitcnt vmcnt(11)
    v_mfma_f32_32x32x16_bf16 v[128:143], v[32:35], v[68:71], v[128:143]
    v_mfma_f32_32x32x16_bf16 v[212:227], v[36:39], v[68:71], v[212:227]
    buffer_load_dwordx2 v[198:199], v15, s[96:99], s23 offen offset:16
    s_waitcnt vmcnt(11)
    v_mfma_f32_32x32x16_bf16 v[128:143], v[40:43], v[72:75], v[128:143]
    v_mfma_f32_32x32x16_bf16 v[212:227], v[44:47], v[72:75], v[212:227]
    buffer_load_dwordx2 v[200:201], v15, s[96:99], s23 offen offset:32
    s_waitcnt vmcnt(11)
    v_mfma_f32_32x32x16_bf16 v[128:143], v[228:231], v[76:79], v[128:143]
    v_mfma_f32_32x32x16_bf16 v[212:227], v[232:235], v[76:79], v[212:227]
    buffer_load_dwordx2 v[202:203], v15, s[96:99], s23 offen offset:48
    s_waitcnt vmcnt(11)
    v_mfma_f32_32x32x16_bf16 v[240:255], v[180:183], v[80:83], v[240:255]
    v_mfma_f32_32x32x16_bf16 v[112:127], v[184:187], v[80:83], 0
    s_add_u32 s57, s34, 12288
    buffer_load_dwordx4 a[56:59], v1, s[8:11], s57 offen offset:2048 sc1
    s_waitcnt vmcnt(11)
    v_mfma_f32_32x32x16_bf16 v[240:255], v[188:191], v[84:87], v[240:255]
    v_mfma_f32_32x32x16_bf16 v[112:127], v[192:195], v[84:87], v[112:127]
    buffer_load_dwordx4 a[60:63], v1, s[8:11], s57 offen offset:3072 sc1
    s_waitcnt vmcnt(11)
    v_mfma_f32_32x32x16_bf16 v[240:255], v[152:155], v[88:91], v[240:255]
    v_mfma_f32_32x32x16_bf16 v[112:127], v[156:159], v[88:91], v[112:127]
    s_add_u32 s57, s34, 16384
    buffer_load_dwordx4 a[64:67], v1, s[8:11], s57 offen sc1
    s_waitcnt vmcnt(11)
    v_mfma_f32_32x32x16_bf16 v[240:255], v[160:163], v[92:95], v[240:255]
    v_mfma_f32_32x32x16_bf16 v[112:127], v[164:167], v[92:95], v[112:127]
    buffer_load_dwordx4 a[68:71], v1, s[8:11], s57 offen offset:1024 sc1
    ds_write_b128 v11, v[128:131] offset:16384
    ds_write_b128 v11, v[132:135] offset:17408
    s_waitcnt vmcnt(11)
    v_mfma_f32_32x32x16_bf16 v[112:127], v[28:31], v[96:99], v[112:127]
    buffer_load_dwordx4 a[72:75], v1, s[8:11], s57 offen offset:2048 sc1
    ds_write_b128 v11, v[136:139] offset:18432
    ds_write_b128 v11, v[140:143] offset:19456
    s_waitcnt vmcnt(11)
    v_mfma_f32_32x32x16_bf16 v[112:127], v[36:39], v[100:103], v[112:127]
    buffer_load_dwordx4 a[76:79], v1, s[8:11], s57 offen offset:3072 sc1
    ds_write_b128 v12, v[212:215] offset:32768
    ds_write_b128 v12, v[216:219] offset:33792
    s_waitcnt vmcnt(11)
    v_mfma_f32_32x32x16_bf16 v[112:127], v[44:47], v[104:107], v[112:127]
    s_add_u32 s57, s34, 20480
    buffer_load_dwordx4 a[80:83], v1, s[8:11], s57 offen sc1
    ds_write_b128 v12, v[220:223] offset:34816
    ds_write_b128 v12, v[224:227] offset:35840
    s_waitcnt vmcnt(11)
    v_mfma_f32_32x32x16_bf16 v[112:127], v[232:235], v[108:111], v[112:127]
    buffer_load_dwordx4 a[84:87], v1, s[8:11], s57 offen offset:1024 sc1
    v_mfma_f32_32x32x16_bf16 v[240:255], v[24:27], v[96:99], v[240:255]
    v_mfma_f32_32x32x16_bf16 v[240:255], v[32:35], v[100:103], v[240:255]
    s_nop 8
    ds_write_b128 v10, v[112:115]
    ds_write_b128 v10, v[116:119] offset:1024
    ds_write_b128 v10, v[120:123] offset:2048
    ds_write_b128 v10, v[124:127] offset:3072
    s_waitcnt lgkmcnt(0)
    s_barrier
    v_mfma_f32_32x32x16_bf16 v[240:255], v[40:43], v[104:107], v[240:255]
    ds_read_b128 v[48:51], v13
    ds_read_b128 v[52:55], v13 offset:1024
    ds_read_b128 v[56:59], v13 offset:2048
    ds_read_b128 v[60:63], v13 offset:3072
    ds_read_b128 v[64:67], v13 offset:16384
    ds_read_b128 v[68:71], v13 offset:17408
    v_mfma_f32_32x32x16_bf16 v[240:255], v[228:231], v[108:111], v[240:255]
    ds_read_b128 v[72:75], v13 offset:18432
    ds_read_b128 v[76:79], v13 offset:19456
    ds_read_b128 v[80:83], v13 offset:32768
    ds_read_b128 v[84:87], v13 offset:33792
    ds_read_b128 v[88:91], v13 offset:34816
    ds_read_b128 v[92:95], v13 offset:35840
    buffer_load_dwordx4 a[88:91], v1, s[8:11], s57 offen offset:2048 sc1
    buffer_load_dwordx4 a[92:95], v1, s[8:11], s57 offen offset:3072 sc1
    s_add_u32 s57, s34, 24576
    buffer_load_dwordx4 a[96:99], v1, s[8:11], s57 offen sc1
    buffer_load_dwordx4 a[100:103], v1, s[8:11], s57 offen offset:1024 sc1
    buffer_load_dwordx4 a[104:107], v1, s[8:11], s57 offen offset:2048 sc1
    buffer_load_dwordx4 a[108:111], v1, s[8:11], s57 offen offset:3072 sc1
    s_add_u32 s20, s12, 6291456
    s_add_u32 s21, s13, 6291456
    s_add_u32 s22, s14, 1708032
    s_waitcnt lgkmcnt(8)
    v_pk_add_f32 v[240:241], v[240:241], v[48:49]
    v_pk_add_f32 v[242:243], v[242:243], v[50:51]
    v_pk_add_f32 v[244:245], v[244:245], v[52:53]
    v_pk_add_f32 v[246:247], v[246:247], v[54:55]
    v_pk_add_f32 v[248:249], v[248:249], v[56:57]
    v_pk_add_f32 v[250:251], v[250:251], v[58:59]
    v_pk_add_f32 v[252:253], v[252:253], v[60:61]
    v_pk_add_f32 v[254:255], v[254:255], v[62:63]
    s_waitcnt lgkmcnt(4)
    v_pk_add_f32 v[240:241], v[240:241], v[64:65]
    v_pk_add_f32 v[242:243], v[242:243], v[66:67]
    v_pk_add_f32 v[244:245], v[244:245], v[68:69]
    v_pk_add_f32 v[246:247], v[246:247], v[70:71]
    v_pk_add_f32 v[248:249], v[248:249], v[72:73]
    v_pk_add_f32 v[250:251], v[250:251], v[74:75]
    v_pk_add_f32 v[252:253], v[252:253], v[76:77]
    v_pk_add_f32 v[254:255], v[254:255], v[78:79]
    s_waitcnt lgkmcnt(0)
    v_pk_add_f32 v[240:241], v[240:241], v[80:81]
    v_pk_add_f32 v[242:243], v[242:243], v[82:83]
    v_pk_add_f32 v[244:245], v[244:245], v[84:85]
    v_pk_add_f32 v[246:247], v[246:247], v[86:87]
    v_pk_add_f32 v[248:249], v[248:249], v[88:89]
    v_pk_add_f32 v[250:251], v[250:251], v[90:91]
    v_pk_add_f32 v[252:253], v[252:253], v[92:93]
    v_pk_add_f32 v[254:255], v[254:255], v[94:95]
    v_cvt_pk_bf16_f32 v96, v240, v241
    v_cvt_pk_bf16_f32 v97, v242, v243
    v_cvt_pk_bf16_f32 v98, v244, v245
    v_cvt_pk_bf16_f32 v99, v246, v247
    buffer_store_dwordx4 v[96:99], v1, s[88:91], s20 offen
    v_cvt_pk_bf16_f32 v100, v248, v249
    v_cvt_pk_bf16_f32 v101, v250, v251
    v_cvt_pk_bf16_f32 v102, v252, v253
    v_cvt_pk_bf16_f32 v103, v254, v255
    buffer_store_dwordx4 v[100:103], v1, s[88:91], s20 offen offset:1024
    v_pk_add_f32 v[104:105], v[240:241], v[242:243]
    v_pk_mul_f32 v[106:107], v[240:241], v[240:241]
    v_pk_fma_f32 v[106:107], v[242:243], v[242:243], v[106:107]
    v_pk_add_f32 v[104:105], v[104:105], v[244:245]
    v_pk_fma_f32 v[106:107], v[244:245], v[244:245], v[106:107]
    v_pk_add_f32 v[104:105], v[104:105], v[246:247]
    v_pk_fma_f32 v[106:107], v[246:247], v[246:247], v[106:107]
    v_pk_add_f32 v[104:105], v[104:105], v[248:249]
    v_pk_fma_f32 v[106:107], v[248:249], v[248:249], v[106:107]
    v_pk_add_f32 v[104:105], v[104:105], v[250:251]
    v_pk_fma_f32 v[106:107], v[250:251], v[250:251], v[106:107]
    v_pk_add_f32 v[104:105], v[104:105], v[252:253]
    v_pk_fma_f32 v[106:107], v[252:253], v[252:253], v[106:107]
    v_pk_add_f32 v[104:105], v[104:105], v[254:255]
    v_pk_fma_f32 v[106:107], v[254:255], v[254:255], v[106:107]
    v_add_f32 v104, v104, v105
    v_add_f32 v105, v106, v107
    v_mov_b32 v106, v104
    v_mov_b32 v107, v105
    s_nop 0
    v_permlane32_swap_b32 v104, v106
    v_permlane32_swap_b32 v105, v107
    v_pk_add_f32 v[104:105], v[104:105], v[106:107]
    s_mov_b32 exec_hi, 0
    buffer_store_dwordx2 v[104:105], v3, s[88:91], s21 offen
    s_cmp_eq_u32 s90, 0
    s_cbranch_scc1 REM_4
    s_mov_b64 exec, 1
    s_waitcnt vmcnt(0)
    buffer_store_dword v8, off, s[8:11], s22
REM_4B:
    s_mov_b64 exec, -1
    s_barrier
    v_lshlrev_b32 v14, 16, v196
    v_and_b32 v15, 0xffff0000, v196
    v_pk_add_f32 v[240:241], v[240:241], v[14:15]
    v_lshlrev_b32 v14, 16, v197
    v_and_b32 v15, 0xffff0000, v197
    v_pk_add_f32 v[242:243], v[242:243], v[14:15]
    v_lshlrev_b32 v14, 16, v198
    v_and_b32 v15, 0xffff0000, v198
    v_pk_add_f32 v[244:245], v[244:245], v[14:15]
    v_lshlrev_b32 v14, 16, v199
    v_and_b32 v15, 0xffff0000, v199
    v_pk_add_f32 v[246:247], v[246:247], v[14:15]
    v_lshlrev_b32 v14, 16, v200
    v_and_b32 v15, 0xffff0000, v200
    v_pk_add_f32 v[248:249], v[248:249], v[14:15]
    v_lshlrev_b32 v14, 16, v201
    v_and_b32 v15, 0xffff0000, v201
    v_pk_add_f32 v[250:251], v[250:251], v[14:15]
    v_lshlrev_b32 v14, 16, v202
    v_and_b32 v15, 0xffff0000, v202
    v_pk_add_f32 v[252:253], v[252:253], v[14:15]
    v_lshlrev_b32 v14, 16, v203
    v_and_b32 v15, 0xffff0000, v203
    v_pk_add_f32 v[254:255], v[254:255], v[14:15]
    s_lshl_b32 s37, s29, 15
    s_add_u32 s37, s37, 6291456
    s_lshl_b32 s39, s29, 6
    s_add_u32 s39, s39, 1708032
    s_add_u32 s41, s15, 4096
    s_lshl_b32 s22, s29, 4
    s_add_u32 s22, s22, s30
    s_lshl_b32 s22, s22, 2
    s_add_u32 s22, s22, 1712128
    ds_read_b128 v[128:131], v2
    ds_read_b128 v[132:135], v2 offset:1024
    ds_read_b128 v[136:139], v2 offset:4096
    ds_read_b128 v[140:143], v2 offset:5120
    ds_read_b128 v[144:147], v2 offset:2048
    ds_read_b128 v[148:151], v2 offset:8192
    s_mov_b32 s7, 0
POLL_5:
    buffer_load_dword v14, v6, s[8:11], s39 offen sc1
    s_waitcnt vmcnt(0)
    v_cmp_eq_u32 vcc, v8, v14
    s_nop 0
    s_cmp_eq_u64 vcc, -1
    s_cbranch_scc1 POLLD_6
    s_sleep 1
    s_add_u32 s7, s7, 1
    s_cmp_lt_u32 s7, 0x8000
    s_cbranch_scc1 POLL_5
POLLD_6:
    s_mov_b32 s20, s37
    buffer_load_dwordx4 v[16:19], v1, s[8:11], s20 offen sc1
    buffer_load_dwordx4 v[20:23], v1, s[8:11], s20 offen offset:1024 sc1
    buffer_load_dwordx4 v[24:27], v1, s[8:11], s20 offen offset:2048 sc1
    buffer_load_dwordx4 v[28:31], v1, s[8:11], s20 offen offset:3072 sc1
    s_add_u32 s20, s37, 4096
    buffer_load_dwordx4 v[32:35], v1, s[8:11], s20 offen sc1
    buffer_load_dwordx4 v[36:39], v1, s[8:11], s20 offen offset:1024 sc1
    buffer_load_dwordx4 v[40:43], v1, s[8:11], s20 offen offset:2048 sc1
    buffer_load_dwordx4 v[44:47], v1, s[8:11], s20 offen offset:3072 sc1
    s_add_u32 s20, s37, 8192
    buffer_load_dwordx4 v[48:51], v1, s[8:11], s20 offen sc1
    buffer_load_dwordx4 v[52:55], v1, s[8:11], s20 offen offset:1024 sc1
    s_waitcnt vmcnt(9) lgkmcnt(4)
    v_mfma_f32_32x32x16_bf16 v[164:179], v[128:131], v[16:19], 0
    ds_read_b128 v[152:155], v2 offset:9216
    v_mfma_f32_32x32x16_bf16 v[180:195], v[132:135], v[16:19], 0
    ds_read_b128 v[156:159], v2 offset:12288
    buffer_load_dwordx4 v[56:59], v1, s[8:11], s20 offen offset:2048 sc1
    s_waitcnt vmcnt(9) lgkmcnt(4)
    v_mfma_f32_32x32x16_bf16 v[164:179], v[136:139], v[20:23], v[164:179]
    ds_read_b128 v[160:163], v2 offset:13312
    v_mfma_f32_32x32x16_bf16 v[180:195], v[140:143], v[20:23], v[180:195]
    ds_read_b128 v[128:131], v2 offset:6144
    buffer_load_dwordx4 v[60:63], v1, s[8:11], s20 offen offset:3072 sc1
    s_waitcnt lgkmcnt(4)
    v_mfma_f32_32x32x16_bf16 v[196:211], v[144:147], v[16:19], 0
    ds_read_b128 v[132:135], v2 offset:16384
    s_waitcnt vmcnt(9)
    v_mfma_f32_32x32x16_bf16 v[164:179], v[148:151], v[24:27], v[164:179]
    ds_read_b128 v[136:139], v2 offset:17408
    s_add_u32 s20, s37, 12288
    buffer_load_dwordx4 v[64:67], v1, s[8:11], s20 offen sc1
    s_waitcnt lgkmcnt(4)
    v_mfma_f32_32x32x16_bf16 v[180:195], v[152:155], v[24:27], v[180:195]
    ds_read_b128 v[140:143], v2 offset:20480
    s_waitcnt vmcnt(9)
    v_mfma_f32_32x32x16_bf16 v[164:179], v[156:159], v[28:31], v[164:179]
    ds_read_b128 v[144:147], v2 offset:21504
    buffer_load_dwordx4 v[68:71], v1, s[8:11], s20 offen offset:1024 sc1
    s_waitcnt lgkmcnt(4)
    v_mfma_f32_32x32x16_bf16 v[180:195], v[160:163], v[28:31], v[180:195]
    ds_read_b128 v[148:151], v2 offset:10240
    v_mfma_f32_32x32x16_bf16 v[196:211], v[128:131], v[20:23], v[196:211]
    ds_read_b128 v[152:155], v2 offset:24576
    buffer_load_dwordx4 v[72:75], v1, s[8:11], s20 offen offset:2048 sc1
    s_waitcnt vmcnt(10) lgkmcnt(4)
    v_mfma_f32_32x32x16_bf16 v[164:179], v[132:135], v[32:35], v[164:179]
    ds_read_b128 v[156:159], v2 offset:25600
    v_mfma_f32_32x32x16_bf16 v[180:195], v[136:139], v[32:35], v[180:195]
    ds_read_b128 v[160:163], v2 offset:28672
    buffer_load_dwordx4 v[76:79], v1, s[8:11], s20 offen offset:3072 sc1
    s_waitcnt vmcnt(10) lgkmcnt(4)
    v_mfma_f32_32x32x16_bf16 v[164:179], v[140:143], v[36:39], v[164:179]
    ds_read_b128 v[128:131], v2 offset:29696
    v_mfma_f32_32x32x16_bf16 v[180:195], v[144:147], v[36:39], v[180:195]
    ds_read_b128 v[132:135], v2 offset:14336
    s_add_u32 s21, s37, 28672
    buffer_load_dwordx2 v[212:213], v3, s[8:11], s21 offen sc1
    s_waitcnt lgkmcnt(4)
    v_mfma_f32_32x32x16_bf16 v[196:211], v[148:151], v[24:27], v[196:211]
    ds_read_b128 v[136:139], v2 offset:32768
    s_waitcnt vmcnt(10)
    v_mfma_f32_32x32x16_bf16 v[164:179], v[152:155], v[40:43], v[164:179]
    ds_read_b128 v[140:143], v2 offset:33792
    buffer_load_dwordx2 v[214:215], v3, s[8:11], s21 offen offset:512 sc1
    s_waitcnt lgkmcnt(4)
    v_mfma_f32_32x32x16_bf16 v[180:195], v[156:159], v[40:43], v[180:195]
    ds_read_b128 v[144:147], v2 offset:36864
    s_waitcnt vmcnt(10)
    v_mfma_f32_32x32x16_bf16 v[164:179], v[160:163], v[44:47], v[164:179]
    ds_read_b128 v[148:151], v2 offset:37888
    buffer_load_dwordx2 v[216:217], v3, s[8:11], s21 offen offset:1024 sc1
    s_waitcnt lgkmcnt(4)
    v_mfma_f32_32x32x16_bf16 v[180:195], v[128:131], v[44:47], v[180:195]
    ds_read_b128 v[152:155], v2 offset:18432
    v_mfma_f32_32x32x16_bf16 v[196:211], v[132:135], v[28:31], v[196:211]
    ds_read_b128 v[156:159], v2 offset:40960
    buffer_load_dwordx2 v[218:219], v3, s[8:11], s21 offen offset:1536 sc1
    s_waitcnt vmcnt(11) lgkmcnt(4)
    v_mfma_f32_32x32x16_bf16 v[164:179], v[136:139], v[48:51], v[164:179]
    ds_read_b128 v[160:163], v2 offset:41984
    v_mfma_f32_32x32x16_bf16 v[180:195], v[140:143], v[48:51], v[180:195]
    ds_read_b128 v[128:131], v2 offset:45056
    buffer_load_dwordx2 v[220:221], v3, s[8:11], s21 offen offset:2048 sc1
    s_waitcnt vmcnt(11) lgkmcnt(4)
    v_mfma_f32_32x32x16_bf16 v[164:179], v[144:147], v[52:55], v[164:179]
    ds_read_b128 v[132:135], v2 offset:46080
    v_mfma_f32_32x32x16_bf16 v[180:195], v[148:151], v[52:55], v[180:195]
    ds_read_b128 v[136:139], v2 offset:22528
    buffer_load_dwordx2 v[222:223], v3, s[8:11], s21 offen offset:2560 sc1
    s_waitcnt lgkmcnt(4)
    v_mfma_f32_32x32x16_bf16 v[196:211], v[152:155], v[32:35], v[196:211]
    ds_read_b128 v[140:143], v2 offset:49152
    s_waitcnt vmcnt(11)
    v_mfma_f32_32x32x16_bf16 v[164:179], v[156:159], v[56:59], v[164:179]
    ds_read_b128 v[144:147], v2 offset:50176
    buffer_load_dwordx2 v[224:225], v3, s[8:11], s21 offen offset:3072 sc1
    s_waitcnt lgkmcnt(4)
    v_mfma_f32_32x32x16_bf16 v[180:195], v[160:163], v[56:59], v[180:195]
    ds_read_b128 v[148:151], v2 offset:53248
    s_waitcnt vmcnt(11)
    v_mfma_f32_32x32x16_bf16 v[164:179], v[128:131], v[60:63], v[164:179]
    ds_read_b128 v[152:155], v2 offset:54272
    s_add_u32 s20, s37, 16384
    buffer_load_dwordx4 v[80:83], v1, s[8:11], s20 offen sc1
    s_waitcnt lgkmcnt(4)
    v_mfma_f32_32x32x16_bf16 v[180:195], v[132:135], v[60:63], v[180:195]
    ds_read_b128 v[156:159], v2 offset:26624
    v_mfma_f32_32x32x16_bf16 v[196:211], v[136:139], v[36:39], v[196:211]
    ds_read_b128 v[160:163], v2 offset:57344
    buffer_load_dwordx4 v[84:87], v1, s[8:11], s20 offen offset:1024 sc1
    s_waitcnt vmcnt(12) lgkmcnt(4)
    v_mfma_f32_32x32x16_bf16 v[164:179], v[140:143], v[64:67], v[164:179]
    ds_read_b128 v[128:131], v2 offset:58368
    v_mfma_f32_32x32x16_bf16 v[180:195], v[144:147], v[64:67], v[180:195]
    ds_read_b128 v[132:135], v2 offset:61440
    buffer_load_dwordx4 v[88:91], v1, s[8:11], s20 offen offset:2048 sc1
    s_waitcnt vmcnt(12) lgkmcnt(4)
    v_mfma_f32_32x32x16_bf16 v[164:179], v[148:151], v[68:71], v[164:179]
    ds_read_b128 v[136:139], v2 offset:62464
    v_mfma_f32_32x32x16_bf16 v[180:195], v[152:155], v[68:71], v[180:195]
    ds_read_b128 v[140:143], v2 offset:30720
    buffer_load_dwordx4 v[92:95], v1, s[8:11], s20 offen offset:3072 sc1
    s_waitcnt lgkmcnt(4)
    v_mfma_f32_32x32x16_bf16 v[196:211], v[156:159], v[40:43], v[196:211]
    ds_read_b128 v[144:147], v7
    s_waitcnt vmcnt(12)
    v_mfma_f32_32x32x16_bf16 v[164:179], v[160:163], v[72:75], v[164:179]
    ds_read_b128 v[148:151], v7 offset:1024
    s_add_u32 s20, s37, 20480
    buffer_load_dwordx4 v[96:99], v1, s[8:11], s20 offen sc1
    s_waitcnt lgkmcnt(4)
    v_mfma_f32_32x32x16_bf16 v[180:195], v[128:131], v[72:75], v[180:195]
    ds_read_b128 v[152:155], v7 offset:4096
    s_waitcnt vmcnt(12)
    v_mfma_f32_32x32x16_bf16 v[164:179], v[132:135], v[76:79], v[164:179]
    ds_read_b128 v[156:159], v7 offset:5120
    buffer_load_dwordx4 v[100:103], v1, s[8:11], s20 offen offset:1024 sc1
    s_waitcnt lgkmcnt(4)
    v_mfma_f32_32x32x16_bf16 v[180:195], v[136:139], v[76:79], v[180:195]
    ds_read_b128 v[160:163], v2 offset:34816
    v_mfma_f32_32x32x16_bf16 v[196:211], v[140:143], v[44:47], v[196:211]
    ds_read_b128 v[128:131], v7 offset:8192
    buffer_load_dwordx4 v[104:107], v1, s[8:11], s20 offen offset:2048 sc1
    s_waitcnt vmcnt(6) lgkmcnt(4)
    v_mfma_f32_32x32x16_bf16 v[164:179], v[144:147], v[80:83], v[164:179]
    ds_read_b128 v[132:135], v7 offset:9216
    v_add_f32 v212, v212, v214
    v_add_f32 v213, v213, v215
    v_add_f32 v212, v212, v216
    v_mfma_f32_32x32x16_bf16 v[180:195], v[148:151], v[80:83], v[180:195]
    ds_read_b128 v[136:139], v7 offset:12288
    buffer_load_dwordx4 v[108:111], v1, s[8:11], s20 offen offset:3072 sc1
    v_add_f32 v213, v213, v217
    v_add_f32 v212, v212, v218
    v_add_f32 v213, v213, v219
    s_waitcnt vmcnt(6) lgkmcnt(4)
    v_mfma_f32_32x32x16_bf16 v[164:179], v[152:155], v[84:87], v[164:179]
    ds_read_b128 v[140:143], v7 offset:13312
    v_add_f32 v212, v212, v220
    v_add_f32 v213, v213, v221
    v_add_f32 v212, v212, v222
    v_mfma_f32_32x32x16_bf16 v[180:195], v[156:159], v[84:87], v[180:195]
    ds_read_b128 v[144:147], v2 offset:38912
    s_add_u32 s20, s37, 24576
    buffer_load_dwordx4 v[112:115], v1, s[8:11], s20 offen sc1
    v_add_f32 v213, v213, v223
    v_add_f32 v212, v212, v224
    v_add_f32 v213, v213, v225
    s_waitcnt lgkmcnt(4)
    v_mfma_f32_32x32x16_bf16 v[196:211], v[160:163], v[48:51], v[196:211]
    ds_read_b128 v[148:151], v7 offset:16384
    v_mov_b32 v214, v212
    v_mov_b32 v215, v213
    s_nop 0
    s_waitcnt vmcnt(6)
    v_mfma_f32_32x32x16_bf16 v[164:179], v[128:131], v[88:91], v[164:179]
    ds_read_b128 v[152:155], v7 offset:17408
    buffer_load_dwordx4 v[116:119], v1, s[8:11], s20 offen offset:1024 sc1
    v_permlane32_swap_b32 v212, v214
    v_permlane32_swap_b32 v213, v215
    v_add_f32 v212, v212, v214
    s_waitcnt lgkmcnt(4)
    v_mfma_f32_32x32x16_bf16 v[180:195], v[132:135], v[88:91], v[180:195]
    ds_read_b128 v[156:159], v7 offset:20480
    v_add_f32 v213, v213, v215
    v_mul_f32 v214, 0xbb124925, v212
    v_mul_f32 v215, 0x3b124925, v213
    s_waitcnt vmcnt(6)
    v_mfma_f32_32x32x16_bf16 v[164:179], v[136:139], v[92:95], v[164:179]
    ds_read_b128 v[160:163], v7 offset:21504
    buffer_load_dwordx4 v[120:123], v1, s[8:11], s20 offen offset:2048 sc1
    v_fma_f32 v215, -v214, v214, v215
    v_max_f32 v215, 0, v215
    v_add_f32 v215, 0x3727c5ac, v215
    s_waitcnt lgkmcnt(4)
    v_mfma_f32_32x32x16_bf16 v[180:195], v[140:143], v[92:95], v[180:195]
    ds_read_b128 v[128:131], v2 offset:43008
    v_rsq_f32 v232, v215
    v_cvt_pk_bf16_f32 v228, v214, v214
    v_mul_f32 v215, v215, v232
    v_mfma_f32_32x32x16_bf16 v[196:211], v[144:147], v[52:55], v[196:211]
    ds_read_b128 v[132:135], v7 offset:24576
    buffer_load_dwordx4 v[124:127], v1, s[8:11], s20 offen offset:3072 sc1
    v_and_b32 v216, 0xffff0000, v228
    v_sub_f32 v216, v214, v216
    v_cvt_pk_bf16_f32 v229, v216, v215
    s_waitcnt vmcnt(7) lgkmcnt(4)
    v_mfma_f32_32x32x16_bf16 v[164:179], v[148:151], v[96:99], v[164:179]
    ds_read_b128 v[136:139], v7 offset:25600
    v_and_b32 v217, 0xffff0000, v229
    v_sub_f32 v217, v215, v217
    v_mov_b32 v230, v228
    v_mfma_f32_32x32x16_bf16 v[180:195], v[152:155], v[96:99], v[180:195]
    ds_read_b128 v[140:143], v7 offset:28672
    s_add_u32 s57, s34, 28672
    buffer_load_dwordx4 a[112:115], v1, s[8:11], s57 offen sc1
    v_cvt_pk_bf16_f32 v231, v216, v217
    v_mul_f32 v233, v232, v232
    s_waitcnt vmcnt(7) lgkmcnt(4)
    v_mfma_f32_32x32x16_bf16 v[164:179], v[156:159], v[100:103], v[164:179]
    ds_read_b128 v[144:147], v7 offset:29696
    v_mfma_f32_32x32x16_bf16 v[180:195], v[160:163], v[100:103], v[180:195]
    ds_read_b128 v[148:151], v2 offset:47104
    buffer_load_dwordx4 a[116:119], v1, s[8:11], s57 offen offset:1024 sc1
    s_waitcnt lgkmcnt(4)
    v_mfma_f32_32x32x16_bf16 v[196:211], v[128:131], v[56:59], v[196:211]
    ds_read_b128 v[152:155], v7 offset:32768
    s_waitcnt vmcnt(7)
    v_mfma_f32_32x32x16_bf16 v[164:179], v[132:135], v[104:107], v[164:179]
    ds_read_b128 v[156:159], v7 offset:33792
    buffer_load_dwordx4 a[120:123], v1, s[8:11], s57 offen offset:2048 sc1
    s_waitcnt lgkmcnt(4)
    v_mfma_f32_32x32x16_bf16 v[180:195], v[136:139], v[104:107], v[180:195]
    ds_read_b128 v[160:163], v7 offset:36864
    s_waitcnt vmcnt(7)
    v_mfma_f32_32x32x16_bf16 v[164:179], v[140:143], v[108:111], v[164:179]
    ds_read_b128 v[128:131], v7 offset:37888
    buffer_load_dwordx4 a[124:127], v1, s[8:11], s57 offen offset:3072 sc1
    s_waitcnt lgkmcnt(4)
    v_mfma_f32_32x32x16_bf16 v[180:195], v[144:147], v[108:111], v[180:195]
    ds_read_b128 v[132:135], v2 offset:51200
    v_mfma_f32_32x32x16_bf16 v[196:211], v[148:151], v[60:63], v[196:211]
    ds_read_b128 v[136:139], v7 offset:40960
    s_add_u32 s57, s34, 32768
    buffer_load_dwordx4 a[128:131], v1, s[8:11], s57 offen sc1
    s_waitcnt vmcnt(8) lgkmcnt(4)
    v_mfma_f32_32x32x16_bf16 v[164:179], v[152:155], v[112:115], v[164:179]
    ds_read_b128 v[140:143], v7 offset:41984
    v_mfma_f32_32x32x16_bf16 v[180:195], v[156:159], v[112:115], v[180:195]
    ds_read_b128 v[144:147], v7 offset:45056
    buffer_load_dwordx4 a[132:135], v1, s[8:11], s57 offen offset:1024 sc1
    s_waitcnt vmcnt(8) lgkmcnt(4)
    v_mfma_f32_32x32x16_bf16 v[164:179], v[160:163], v[116:119], v[164:179]
    ds_read_b128 v[148:151], v7 offset:46080
    v_mfma_f32_32x32x16_bf16 v[180:195], v[128:131], v[116:119], v[180:195]
    ds_read_b128 v[152:155], v2 offset:55296
    buffer_load_dwordx4 a[136:139], v1, s[8:11], s57 offen offset:2048 sc1
    s_waitcnt lgkmcnt(4)
    v_mfma_f32_32x32x16_bf16 v[196:211], v[132:135], v[64:67], v[196:211]
    ds_read_b128 v[156:159], v2 offset:59392
    s_waitcnt vmcnt(8)
    v_mfma_f32_32x32x16_bf16 v[164:179], v[136:139], v[120:123], v[164:179]
    ds_read_b128 v[160:163], v2 offset:63488
    buffer_load_dwordx4 a[140:143], v1, s[8:11], s57 offen offset:3072 sc1
    s_waitcnt lgkmcnt(4)
    v_mfma_f32_32x32x16_bf16 v[180:195], v[140:143], v[120:123], v[180:195]
    ds_read_b128 v[128:131], v7 offset:2048
    s_waitcnt vmcnt(8)
    v_mfma_f32_32x32x16_bf16 v[164:179], v[144:147], v[124:127], v[164:179]
    ds_read_b128 v[132:135], v7 offset:6144
    s_add_u32 s57, s34, 36864
    buffer_load_dwordx4 a[144:147], v1, s[8:11], s57 offen sc1
    s_waitcnt lgkmcnt(4)
    v_mfma_f32_32x32x16_bf16 v[180:195], v[148:151], v[124:127], v[180:195]
    ds_read_b128 v[136:139], v7 offset:10240
    v_mfma_f32_32x32x16_bf16 v[196:211], v[152:155], v[68:71], v[196:211]
    ds_read_b128 v[140:143], v7 offset:14336
    buffer_load_dwordx4 a[148:151], v1, s[8:11], s57 offen offset:1024 sc1
    v_mfma_f32_32x32x16_bf16 v[164:179], a[224:227], v[228:231], v[164:179]
    v_mfma_f32_32x32x16_bf16 v[180:195], a[228:231], v[228:231], v[180:195]
    buffer_load_dwordx4 a[152:155], v1, s[8:11], s57 offen offset:2048 sc1
    v_mfma_f32_32x32x16_bf16 v[196:211], a[232:235], v[228:231], v[196:211]
    s_waitcnt lgkmcnt(4)
    v_mfma_f32_32x32x16_bf16 v[196:211], v[156:159], v[72:75], v[196:211]
    ds_read_b128 v[144:147], v7 offset:18432
    buffer_load_dwordx4 a[156:159], v1, s[8:11], s57 offen offset:3072 sc1
    s_nop 4
    v_mul_f32 v164, v164, |v164|
    v_mul_f32 v165, v165, |v165|
    v_mul_f32 v166, v166, |v166|
    v_mul_f32 v167, v167, |v167|
    v_mfma_f32_32x32x16_bf16 v[196:211], v[160:163], v[76:79], v[196:211]
    ds_read_b128 v[148:151], v7 offset:22528
    v_mul_f32 v168, v168, |v168|
    v_mul_f32 v169, v169, |v169|
    v_mul_f32 v170, v170, |v170|
    v_mul_f32 v171, v171, |v171|
    s_waitcnt lgkmcnt(4)
    v_mfma_f32_32x32x16_bf16 v[196:211], v[128:131], v[80:83], v[196:211]
    ds_read_b128 v[152:155], v7 offset:26624
    s_add_u32 s57, s34, 40960
    buffer_load_dwordx4 a[160:163], v1, s[8:11], s57 offen sc1
    v_mul_f32 v164, v164, v233
    v_mul_f32 v165, v165, v233
    v_mul_f32 v166, v166, v233
    v_mul_f32 v167, v167, v233
    v_mfma_f32_32x32x16_bf16 v[196:211], v[132:135], v[84:87], v[196:211]
    ds_read_b128 v[156:159], v7 offset:30720
    v_mul_f32 v168, v168, v233
    v_mul_f32 v169, v169, v233
    v_mul_f32 v170, v170, v233
    v_mul_f32 v171, v171, v233
    s_waitcnt lgkmcnt(4)
    v_mfma_f32_32x32x16_bf16 v[196:211], v[136:139], v[88:91], v[196:211]
    ds_read_b128 v[160:163], v7 offset:34816
    buffer_load_dwordx4 a[164:167], v1, s[8:11], s57 offen offset:1024 sc1
    v_cvt_pk_bf16_f32 v164, v164, v165
    v_cvt_pk_bf16_f32 v165, v166, v167
    v_cvt_pk_bf16_f32 v166, v168, v169
    v_cvt_pk_bf16_f32 v167, v170, v171
    v_mfma_f32_32x32x16_bf16 v[196:211], v[140:143], v[92:95], v[196:211]
    ds_read_b128 v[128:131], v7 offset:38912
    v_pk_max_i16 v164, v164, 0
    v_pk_max_i16 v165, v165, 0
    v_pk_max_i16 v166, v166, 0
    v_pk_max_i16 v167, v167, 0
    s_waitcnt lgkmcnt(4)
    v_mfma_f32_32x32x16_bf16 v[196:211], v[144:147], v[96:99], v[196:211]
    ds_read_b128 v[132:135], v7 offset:43008
    buffer_load_dwordx4 a[168:171], v1, s[8:11], s57 offen offset:2048 sc1
    buffer_store_dwordx4 v[164:167], v1, s[8:11], s15 offen sc1
    v_mul_f32 v172, v172, |v172|
    v_mul_f32 v173, v173, |v173|
    v_mul_f32 v174, v174, |v174|
    v_mfma_f32_32x32x16_bf16 v[196:211], v[148:151], v[100:103], v[196:211]
    ds_read_b128 v[136:139], v7 offset:47104
    v_mul_f32 v175, v175, |v175|
    v_mul_f32 v176, v176, |v176|
    v_mul_f32 v177, v177, |v177|
    v_mul_f32 v178, v178, |v178|
    s_waitcnt lgkmcnt(4)
    v_mfma_f32_32x32x16_bf16 v[196:211], v[152:155], v[104:107], v[196:211]
    ds_read_b128 v[140:143], v2 offset:3072
    buffer_load_dwordx4 a[172:175], v1, s[8:11], s57 offen offset:3072 sc1
    v_mul_f32 v179, v179, |v179|
    v_mul_f32 v172, v172, v233
    v_mul_f32 v173, v173, v233
    v_mul_f32 v174, v174, v233
    v_mfma_f32_32x32x16_bf16 v[196:211], v[156:159], v[108:111], v[196:211]
    ds_read_b128 v[144:147], v2 offset:7168
    v_mul_f32 v175, v175, v233
    v_mul_f32 v176, v176, v233
    v_mul_f32 v177, v177, v233
    v_mul_f32 v178, v178, v233
    s_waitcnt lgkmcnt(4)
    v_mfma_f32_32x32x16_bf16 v[196:211], v[160:163], v[112:115], v[196:211]
    ds_read_b128 v[148:151], v2 offset:11264
    s_add_u32 s57, s34, 45056
    buffer_load_dwordx4 a[176:179], v1, s[8:11], s57 offen sc1
    v_mul_f32 v179, v179, v233
    v_cvt_pk_bf16_f32 v172, v172, v173
    v_cvt_pk_bf16_f32 v173, v174, v175
    v_cvt_pk_bf16_f32 v174, v176, v177
    v_mfma_f32_32x32x16_bf16 v[196:211], v[128:131], v[116:119], v[196:211]
    ds_read_b128 v[152:155], v2 offset:15360
    v_cvt_pk_bf16_f32 v175, v178, v179
    v_pk_max_i16 v172, v172, 0
    v_pk_max_i16 v173, v173, 0
    v_pk_max_i16 v174, v174, 0
    s_waitcnt lgkmcnt(4)
    v_mfma_f32_32x32x16_bf16 v[196:211], v[132:135], v[120:123], v[196:211]
    ds_read_b128 v[156:159], v2 offset:19456
    buffer_load_dwordx4 a[180:183], v1, s[8:11], s57 offen offset:1024 sc1
    v_pk_max_i16 v175, v175, 0
    buffer_store_dwordx4 v[172:175], v1, s[8:11], s15 offen offset:1024 sc1
    v_mul_f32 v180, v180, |v180|
    v_mul_f32 v181, v181, |v181|
    v_mfma_f32_32x32x16_bf16 v[196:211], v[136:139], v[124:127], v[196:211]
    ds_read_b128 v[160:163], v2 offset:23552
    v_mul_f32 v182, v182, |v182|
    v_mul_f32 v183, v183, |v183|
    v_mul_f32 v184, v184, |v184|
    v_mul_f32 v185, v185, |v185|
    v_mfma_f32_32x32x16_bf16 v[212:227], a[236:239], v[228:231], 0
    buffer_load_dwordx4 a[184:187], v1, s[8:11], s57 offen offset:2048 sc1
    v_mul_f32 v186, v186, |v186|
    v_mul_f32 v187, v187, |v187|
    v_mul_f32 v180, v180, v233
    v_mul_f32 v181, v181, v233
    s_waitcnt lgkmcnt(4)
    v_mfma_f32_32x32x16_bf16 v[212:227], v[140:143], v[16:19], v[212:227]
    ds_read_b128 v[128:131], v2 offset:27648
    v_mul_f32 v182, v182, v233
    v_mul_f32 v183, v183, v233
    v_mul_f32 v184, v184, v233
    v_mul_f32 v185, v185, v233
    v_mfma_f32_32x32x16_bf16 v[212:227], v[144:147], v[20:23], v[212:227]
    ds_read_b128 v[132:135], v2 offset:31744
    buffer_load_dwordx4 a[188:191], v1, s[8:11], s57 offen offset:3072 sc1
    v_mul_f32 v186, v186, v233
    v_mul_f32 v187, v187, v233
    v_cvt_pk_bf16_f32 v180, v180, v181
    v_cvt_pk_bf16_f32 v181, v182, v183
    s_waitcnt lgkmcnt(4)
    v_mfma_f32_32x32x16_bf16 v[212:227], v[148:151], v[24:27], v[212:227]
    ds_read_b128 v[136:139], v2 offset:35840
    v_cvt_pk_bf16_f32 v182, v184, v185
    v_cvt_pk_bf16_f32 v183, v186, v187
    v_pk_max_i16 v180, v180, 0
    v_pk_max_i16 v181, v181, 0
    v_mfma_f32_32x32x16_bf16 v[212:227], v[152:155], v[28:31], v[212:227]
    ds_read_b128 v[140:143], v2 offset:39936
    s_add_u32 s57, s34, 49152
    buffer_load_dwordx4 a[192:195], v1, s[8:11], s57 offen sc1
    v_pk_max_i16 v182, v182, 0
    v_pk_max_i16 v183, v183, 0
    buffer_store_dwordx4 v[180:183], v1, s[8:11], s15 offen offset:2048 sc1
    v_mul_f32 v188, v188, |v188|
    s_waitcnt lgkmcnt(4)
    v_mfma_f32_32x32x16_bf16 v[212:227], v[156:159], v[32:35], v[212:227]
    ds_read_b128 v[144:147], v2 offset:44032
    v_mul_f32 v189, v189, |v189|
    v_mul_f32 v190, v190, |v190|
    v_mul_f32 v191, v191, |v191|
    v_mul_f32 v192, v192, |v192|
    v_mfma_f32_32x32x16_bf16 v[212:227], v[160:163], v[36:39], v[212:227]
    ds_read_b128 v[148:151], v2 offset:48128
    buffer_load_dwordx4 a[196:199], v1, s[8:11], s57 offen offset:1024 sc1
    v_mul_f32 v193, v193, |v193|
    v_mul_f32 v194, v194, |v194|
    v_mul_f32 v195, v195, |v195|
    v_mul_f32 v188, v188, v233
    s_waitcnt lgkmcnt(4)
    v_mfma_f32_32x32x16_bf16 v[212:227], v[128:131], v[40:43], v[212:227]
    ds_read_b128 v[152:155], v2 offset:52224
    v_mul_f32 v189, v189, v233
    v_mul_f32 v190, v190, v233
    v_mul_f32 v191, v191, v233
    v_mul_f32 v192, v192, v233
    v_mfma_f32_32x32x16_bf16 v[212:227], v[132:135], v[44:47], v[212:227]
    ds_read_b128 v[156:159], v2 offset:56320
    buffer_load_dwordx4 a[200:203], v1, s[8:11], s57 offen offset:2048 sc1
    v_mul_f32 v193, v193, v233
    v_mul_f32 v194, v194, v233
    v_mul_f32 v195, v195, v233
    v_cvt_pk_bf16_f32 v188, v188, v189
    s_waitcnt lgkmcnt(4)
    v_mfma_f32_32x32x16_bf16 v[212:227], v[136:139], v[48:51], v[212:227]
    ds_read_b128 v[160:163], v2 offset:60416
    v_cvt_pk_bf16_f32 v189, v190, v191
    v_cvt_pk_bf16_f32 v190, v192, v193
    v_cvt_pk_bf16_f32 v191, v194, v195
    v_pk_max_i16 v188, v188, 0
    v_mfma_f32_32x32x16_bf16 v[212:227], v[140:143], v[52:55], v[212:227]
    ds_read_b128 v[128:131], v2 offset:64512
    buffer_load_dwordx4 a[204:207], v1, s[8:11], s57 offen offset:3072 sc1
    v_pk_max_i16 v189, v189, 0
    v_pk_max_i16 v190, v190, 0
    v_pk_max_i16 v191, v191, 0
    buffer_store_dwordx4 v[188:191], v1, s[8:11], s15 offen offset:3072 sc1
    s_waitcnt lgkmcnt(4)
    v_mfma_f32_32x32x16_bf16 v[212:227], v[144:147], v[56:59], v[212:227]
    ds_read_b128 v[132:135], v7 offset:3072
    v_mul_f32 v196, v196, |v196|
    v_mul_f32 v197, v197, |v197|
    v_mul_f32 v198, v198, |v198|
    v_mul_f32 v199, v199, |v199|
    v_mfma_f32_32x32x16_bf16 v[212:227], v[148:151], v[60:63], v[212:227]
    ds_read_b128 v[136:139], v7 offset:7168
    s_add_u32 s57, s34, 53248
    buffer_load_dwordx4 a[208:211], v1, s[8:11], s57 offen sc1
    v_mul_f32 v200, v200, |v200|
    v_mul_f32 v201, v201, |v201|
    v_mul_f32 v202, v202, |v202|
    v_mul_f32 v203, v203, |v203|
    s_waitcnt lgkmcnt(4)
    v_mfma_f32_32x32x16_bf16 v[212:227], v[152:155], v[64:67], v[212:227]
    ds_read_b128 v[140:143], v7 offset:11264
    v_mul_f32 v196, v196, v233
    v_mul_f32 v197, v197, v233
    v_mul_f32 v198, v198, v233
    v_mul_f32 v199, v199, v233
    v_mfma_f32_32x32x16_bf16 v[212:227], v[156:159], v[68:71], v[212:227]
    ds_read_b128 v[144:147], v7 offset:15360
    buffer_load_dwordx4 a[212:215], v1, s[8:11], s57 offen offset:1024 sc1
    v_mul_f32 v200, v200, v233
    v_mul_f32 v201, v201, v233
    v_mul_f32 v202, v202, v233
    v_mul_f32 v203, v203, v233
    s_waitcnt lgkmcnt(4)
    v_mfma_f32_32x32x16_bf16 v[212:227], v[160:163], v[72:75], v[212:227]
    ds_read_b128 v[148:151], v7 offset:19456
    v_cvt_pk_bf16_f32 v196, v196, v197
    v_cvt_pk_bf16_f32 v197, v198, v199
    v_cvt_pk_bf16_f32 v198, v200, v201
    v_cvt_pk_bf16_f32 v199, v202, v203
    v_mfma_f32_32x32x16_bf16 v[212:227], v[128:131], v[76:79], v[212:227]
    ds_read_b128 v[152:155], v7 offset:23552
    buffer_load_dwordx4 a[216:219], v1, s[8:11], s57 offen offset:2048 sc1
    v_pk_max_i16 v196, v196, 0
    v_pk_max_i16 v197, v197, 0
    v_pk_max_i16 v198, v198, 0
    v_pk_max_i16 v199, v199, 0
    s_waitcnt lgkmcnt(4)
    v_mfma_f32_32x32x16_bf16 v[212:227], v[132:135], v[80:83], v[212:227]
    ds_read_b128 v[156:159], v7 offset:27648
    buffer_store_dwordx4 v[196:199], v1, s[8:11], s41 offen sc1
    v_mul_f32 v204, v204, |v204|
    v_mul_f32 v205, v205, |v205|
    v_mul_f32 v206, v206, |v206|
    v_mfma_f32_32x32x16_bf16 v[212:227], v[136:139], v[84:87], v[212:227]
    ds_read_b128 v[160:163], v7 offset:31744
    buffer_load_dwordx4 a[220:223], v1, s[8:11], s57 offen offset:3072 sc1
    v_mul_f32 v207, v207, |v207|
    v_mul_f32 v208, v208, |v208|
    v_mul_f32 v209, v209, |v209|
    v_mul_f32 v210, v210, |v210|
    s_waitcnt lgkmcnt(4)
    v_mfma_f32_32x32x16_bf16 v[212:227], v[140:143], v[88:91], v[212:227]
    ds_read_b128 v[128:131], v7 offset:35840
    v_mul_f32 v211, v211, |v211|
    v_mul_f32 v204, v204, v233
    v_mul_f32 v205, v205, v233
    v_mul_f32 v206, v206, v233
    v_mfma_f32_32x32x16_bf16 v[212:227], v[144:147], v[92:95], v[212:227]
    ds_read_b128 v[132:135], v7 offset:39936
    v_mul_f32 v207, v207, v233
    v_mul_f32 v208, v208, v233
    v_mul_f32 v209, v209, v233
    v_mul_f32 v210, v210, v233
    s_waitcnt lgkmcnt(4)
    v_mfma_f32_32x32x16_bf16 v[212:227], v[148:151], v[96:99], v[212:227]
    ds_read_b128 v[136:139], v7 offset:44032
    v_mul_f32 v211, v211, v233
    v_cvt_pk_bf16_f32 v204, v204, v205
    v_cvt_pk_bf16_f32 v205, v206, v207
    v_cvt_pk_bf16_f32 v206, v208, v209
    v_mfma_f32_32x32x16_bf16 v[212:227], v[152:155], v[100:103], v[212:227]
    ds_read_b128 v[140:143], v7 offset:48128
    v_cvt_pk_bf16_f32 v207, v210, v211
    v_pk_max_i16 v204, v204, 0
    v_pk_max_i16 v205, v205, 0
    v_pk_max_i16 v206, v206, 0
    s_waitcnt lgkmcnt(4)
    v_mfma_f32_32x32x16_bf16 v[212:227], v[156:159], v[104:107], v[212:227]
    v_pk_max_i16 v207, v207, 0
    buffer_store_dwordx4 v[204:207], v1, s[8:11], s41 offen offset:1024 sc1
    v_mfma_f32_32x32x16_bf16 v[212:227], v[160:163], v[108:111], v[212:227]
    s_waitcnt lgkmcnt(2)
    v_mfma_f32_32x32x16_bf16 v[212:227], v[128:131], v[112:115], v[212:227]
    v_mfma_f32_32x32x16_bf16 v[212:227], v[132:135], v[116:119], v[212:227]
    s_waitcnt lgkmcnt(0)
    v_mfma_f32_32x32x16_bf16 v[212:227], v[136:139], v[120:123], v[212:227]
    v_mfma_f32_32x32x16_bf16 v[212:227], v[140:143], v[124:127], v[212:227]
    s_nop 11
    v_pk_mul_f32 v[212:213], v[212:213], v[232:233] op_sel_hi:[1,0]
    v_pk_mul_f32 v[214:215], v[214:215], v[232:233] op_sel_hi:[1,0]
    v_pk_mul_f32 v[216:217], v[216:217], v[232:233] op_sel_hi:[1,0]
    v_pk_mul_f32 v[218:219], v[218:219], v[232:233] op_sel_hi:[1,0]
    v_mul_f32 v212, v212, |v212|
    v_mul_f32 v213, v213, |v213|
    v_mul_f32 v214, v214, |v214|
    v_mul_f32 v215, v215, |v215|
    v_mul_f32 v216, v216, |v216|
    v_mul_f32 v217, v217, |v217|
    v_mul_f32 v218, v218, |v218|
    v_mul_f32 v219, v219, |v219|
    v_cvt_pk_bf16_f32 v212, v212, v213
    v_cvt_pk_bf16_f32 v213, v214, v215
    v_cvt_pk_bf16_f32 v214, v216, v217
    v_cvt_pk_bf16_f32 v215, v218, v219
    v_pk_max_i16 v212, v212, 0
    v_pk_max_i16 v213, v213, 0
    v_pk_max_i16 v214, v214, 0
    v_pk_max_i16 v215, v215, 0
    buffer_store_dwordx4 v[212:215], v1, s[8:11], s41 offen offset:2048 sc1
    v_pk_mul_f32 v[220:221], v[220:221], v[232:233] op_sel_hi:[1,0]
    v_pk_mul_f32 v[222:223], v[222:223], v[232:233] op_sel_hi:[1,0]
    v_pk_mul_f32 v[224:225], v[224:225], v[232:233] op_sel_hi:[1,0]
    v_pk_mul_f32 v[226:227], v[226:227], v[232:233] op_sel_hi:[1,0]
    v_mul_f32 v220, v220, |v220|
    v_mul_f32 v221, v221, |v221|
    v_mul_f32 v222, v222, |v222|
    v_mul_f32 v223, v223, |v223|
    v_mul_f32 v224, v224, |v224|
    v_mul_f32 v225, v225, |v225|
    v_mul_f32 v226, v226, |v226|
    v_mul_f32 v227, v227, |v227|
    v_cvt_pk_bf16_f32 v220, v220, v221
    v_cvt_pk_bf16_f32 v221, v222, v223
    v_cvt_pk_bf16_f32 v222, v224, v225
    v_cvt_pk_bf16_f32 v223, v226, v227
    v_pk_max_i16 v220, v220, 0
    v_pk_max_i16 v221, v221, 0
    v_pk_max_i16 v222, v222, 0
    v_pk_max_i16 v223, v223, 0
    buffer_store_dwordx4 v[220:223], v1, s[8:11], s41 offen offset:3072 sc1
    s_cmp_eq_u32 s90, 0
    s_cbranch_scc1 REM_7
    s_mov_b64 exec, 1
    s_waitcnt vmcnt(0)
    buffer_store_dword v8, off, s[8:11], s22
REM_7B:
    s_mov_b64 exec, -1
    s_barrier
    s_lshl_b32 s39, s31, 7
    s_add_u32 s39, s39, 1712128
    s_mul_i32 s7, s3, 28672
    s_add_u32 s7, s7, 20971520
    s_mul_i32 s40, s48, 114688
    s_add_u32 s40, s40, s7
    s_xor_b32 s41, s48, 1
    s_mul_i32 s41, s41, 114688
    s_add_u32 s41, s41, s7
    v_lshlrev_b32 v9, 2, v0
    v_and_b32 v9, 64, v9
    v_add_u32 v9, v9, v6
    s_mul_i32 s51, s3, 13312
    s_add_u32 s51, s51, 32768
    s_add_u32 s50, s51, s33
    s_add_u32 s51, s51, 16384
    s_lshl_b32 s43, s3, 13
    s_add_u32 s42, s43, s33
    s_add_u32 s43, s43, 16384
    s_mov_b32 s7, 0
POLL_8:
    buffer_load_dword v14, v9, s[8:11], s39 offen sc1
    s_waitcnt vmcnt(0)
    v_cmp_eq_u32 vcc, v8, v14
    s_nop 0
    s_cmp_eq_u64 vcc, -1
    s_cbranch_scc1 POLLD_9
    s_sleep 1
    s_add_u32 s7, s7, 1
    s_cmp_lt_u32 s7, 0x8000
    s_cbranch_scc1 POLL_8
POLLD_9:
    s_mov_b32 s20, s41
    buffer_load_dwordx4 v[16:19], v1, s[8:11], s20 offen sc1
    buffer_load_dwordx4 v[20:23], v1, s[8:11], s20 offen offset:1024 sc1
    buffer_load_dwordx4 v[24:27], v1, s[8:11], s20 offen offset:2048 sc1
    buffer_load_dwordx4 v[28:31], v1, s[8:11], s20 offen offset:3072 sc1
    s_add_u32 s20, s41, 4096
    buffer_load_dwordx4 v[32:35], v1, s[8:11], s20 offen sc1
    buffer_load_dwordx4 v[36:39], v1, s[8:11], s20 offen offset:1024 sc1
    buffer_load_dwordx4 v[40:43], v1, s[8:11], s20 offen offset:2048 sc1
    buffer_load_dwordx4 v[44:47], v1, s[8:11], s20 offen offset:3072 sc1
    s_add_u32 s20, s41, 8192
    buffer_load_dwordx4 v[48:51], v1, s[8:11], s20 offen sc1
    buffer_load_dwordx4 v[52:55], v1, s[8:11], s20 offen offset:1024 sc1
    buffer_load_dwordx4 v[56:59], v1, s[8:11], s20 offen offset:2048 sc1
    s_waitcnt vmcnt(10)
    v_mfma_f32_32x32x16_bf16 v[192:207], a[0:3], v[16:19], 0
    v_mfma_f32_32x32x16_bf16 v[208:223], a[4:7], v[16:19], 0
    buffer_load_dwordx4 v[60:63], v1, s[8:11], s20 offen offset:3072 sc1
    s_waitcnt vmcnt(10)
    v_mfma_f32_32x32x16_bf16 v[192:207], a[8:11], v[20:23], v[192:207]
    v_mfma_f32_32x32x16_bf16 v[208:223], a[12:15], v[20:23], v[208:223]
    s_add_u32 s20, s41, 12288
    buffer_load_dwordx4 v[16:19], v1, s[8:11], s20 offen sc1
    s_waitcnt vmcnt(10)
    v_mfma_f32_32x32x16_bf16 v[192:207], a[16:19], v[24:27], v[192:207]
    buffer_load_dwordx4 v[20:23], v1, s[8:11], s20 offen offset:1024 sc1
    v_mfma_f32_32x32x16_bf16 v[208:223], a[20:23], v[24:27], v[208:223]
    buffer_load_dwordx4 v[24:27], v1, s[8:11], s20 offen offset:2048 sc1
    s_waitcnt vmcnt(11)
    v_mfma_f32_32x32x16_bf16 v[192:207], a[24:27], v[28:31], v[192:207]
    v_mfma_f32_32x32x16_bf16 v[208:223], a[28:31], v[28:31], v[208:223]
    buffer_load_dwordx4 v[28:31], v1, s[8:11], s20 offen offset:3072 sc1
    s_waitcnt vmcnt(11)
    v_mfma_f32_32x32x16_bf16 v[192:207], a[32:35], v[32:35], v[192:207]
    v_mfma_f32_32x32x16_bf16 v[208:223], a[36:39], v[32:35], v[208:223]
    s_add_u32 s20, s41, 16384
    buffer_load_dwordx4 v[32:35], v1, s[8:11], s20 offen sc1
    s_waitcnt vmcnt(11)
    v_mfma_f32_32x32x16_bf16 v[192:207], a[40:43], v[36:39], v[192:207]
    v_mfma_f32_32x32x16_bf16 v[208:223], a[44:47], v[36:39], v[208:223]
    buffer_load_dwordx4 v[36:39], v1, s[8:11], s20 offen offset:1024 sc1
    s_waitcnt vmcnt(11)
    v_mfma_f32_32x32x16_bf16 v[192:207], a[48:51], v[40:43], v[192:207]
    v_mfma_f32_32x32x16_bf16 v[208:223], a[52:55], v[40:43], v[208:223]
    buffer_load_dwordx4 v[40:43], v1, s[8:11], s20 offen offset:2048 sc1
    s_waitcnt vmcnt(11)
    v_mfma_f32_32x32x16_bf16 v[192:207], a[56:59], v[44:47], v[192:207]
    v_mfma_f32_32x32x16_bf16 v[208:223], a[60:63], v[44:47], v[208:223]
    buffer_load_dwordx4 v[44:47], v1, s[8:11], s20 offen offset:3072 sc1
    s_waitcnt vmcnt(11)
    v_mfma_f32_32x32x16_bf16 v[192:207], a[64:67], v[48:51], v[192:207]
    v_mfma_f32_32x32x16_bf16 v[208:223], a[68:71], v[48:51], v[208:223]
    s_add_u32 s20, s41, 20480
    buffer_load_dwordx4 v[48:51], v1, s[8:11], s20 offen sc1
    s_waitcnt vmcnt(11)
    v_mfma_f32_32x32x16_bf16 v[192:207], a[72:75], v[52:55], v[192:207]
    v_mfma_f32_32x32x16_bf16 v[208:223], a[76:79], v[52:55], v[208:223]
    buffer_load_dwordx4 v[52:55], v1, s[8:11], s20 offen offset:1024 sc1
    s_waitcnt vmcnt(11)
    v_mfma_f32_32x32x16_bf16 v[192:207], a[80:83], v[56:59], v[192:207]
    v_mfma_f32_32x32x16_bf16 v[208:223], a[84:87], v[56:59], v[208:223]
    buffer_load_dwordx4 v[56:59], v1, s[8:11], s20 offen offset:2048 sc1
    s_waitcnt vmcnt(11)
    v_mfma_f32_32x32x16_bf16 v[192:207], a[88:91], v[60:63], v[192:207]
    v_mfma_f32_32x32x16_bf16 v[208:223], a[92:95], v[60:63], v[208:223]
    buffer_load_dwordx4 v[60:63], v1, s[8:11], s20 offen offset:3072 sc1
    s_waitcnt vmcnt(11)
    v_mfma_f32_32x32x16_bf16 v[192:207], a[96:99], v[16:19], v[192:207]
    v_mfma_f32_32x32x16_bf16 v[208:223], a[100:103], v[16:19], v[208:223]
    s_add_u32 s20, s41, 24576
    buffer_load_dwordx4 v[16:19], v1, s[8:11], s20 offen sc1
    s_waitcnt vmcnt(11)
    v_mfma_f32_32x32x16_bf16 v[192:207], a[104:107], v[20:23], v[192:207]
    v_mfma_f32_32x32x16_bf16 v[208:223], a[108:111], v[20:23], v[208:223]
    buffer_load_dwordx4 v[20:23], v1, s[8:11], s20 offen offset:1024 sc1
    s_waitcnt vmcnt(11)
    v_mfma_f32_32x32x16_bf16 v[192:207], a[112:115], v[24:27], v[192:207]
    v_mfma_f32_32x32x16_bf16 v[208:223], a[116:119], v[24:27], v[208:223]
    buffer_load_dwordx4 v[24:27], v1, s[8:11], s20 offen offset:2048 sc1
    s_waitcnt vmcnt(11)
    v_mfma_f32_32x32x16_bf16 v[192:207], a[120:123], v[28:31], v[192:207]
    v_mfma_f32_32x32x16_bf16 v[208:223], a[124:127], v[28:31], v[208:223]
    buffer_load_dwordx4 v[28:31], v1, s[8:11], s20 offen offset:3072 sc1
    s_waitcnt vmcnt(11)
    v_mfma_f32_32x32x16_bf16 v[192:207], a[128:131], v[32:35], v[192:207]
    v_mfma_f32_32x32x16_bf16 v[208:223], a[132:135], v[32:35], v[208:223]
    s_mov_b32 s20, s40
    buffer_load_dwordx4 v[32:35], v1, s[8:11], s20 offen sc1
    s_waitcnt vmcnt(11)
    v_mfma_f32_32x32x16_bf16 v[192:207], a[136:139], v[36:39], v[192:207]
    v_mfma_f32_32x32x16_bf16 v[208:223], a[140:143], v[36:39], v[208:223]
    buffer_load_dwordx4 v[36:39], v1, s[8:11], s20 offen offset:1024 sc1
    s_waitcnt vmcnt(11)
    v_mfma_f32_32x32x16_bf16 v[192:207], a[144:147], v[40:43], v[192:207]
    v_mfma_f32_32x32x16_bf16 v[208:223], a[148:151], v[40:43], v[208:223]
    buffer_load_dwordx4 v[40:43], v1, s[8:11], s20 offen offset:2048 sc1
    s_waitcnt vmcnt(11)
    v_mfma_f32_32x32x16_bf16 v[192:207], a[152:155], v[44:47], v[192:207]
    v_mfma_f32_32x32x16_bf16 v[208:223], a[156:159], v[44:47], v[208:223]
    buffer_load_dwordx4 v[44:47], v1, s[8:11], s20 offen offset:3072 sc1
    s_waitcnt vmcnt(11)
    v_mfma_f32_32x32x16_bf16 v[192:207], a[160:163], v[48:51], v[192:207]
    v_mfma_f32_32x32x16_bf16 v[208:223], a[164:167], v[48:51], v[208:223]
    s_add_u32 s20, s40, 4096
    buffer_load_dwordx4 v[48:51], v1, s[8:11], s20 offen sc1
    s_waitcnt vmcnt(11)
    v_mfma_f32_32x32x16_bf16 v[192:207], a[168:171], v[52:55], v[192:207]
    v_mfma_f32_32x32x16_bf16 v[208:223], a[172:175], v[52:55], v[208:223]
    buffer_load_dwordx4 v[52:55], v1, s[8:11], s20 offen offset:1024 sc1
    s_waitcnt vmcnt(11)
    v_mfma_f32_32x32x16_bf16 v[192:207], a[176:179], v[56:59], v[192:207]
    v_mfma_f32_32x32x16_bf16 v[208:223], a[180:183], v[56:59], v[208:223]
    buffer_load_dwordx4 v[56:59], v1, s[8:11], s20 offen offset:2048 sc1
    s_waitcnt vmcnt(11)
    v_mfma_f32_32x32x16_bf16 v[192:207], a[184:187], v[60:63], v[192:207]
    v_mfma_f32_32x32x16_bf16 v[208:223], a[188:191], v[60:63], v[208:223]
    buffer_load_dwordx4 v[60:63], v1, s[8:11], s20 offen offset:3072 sc1
    s_waitcnt vmcnt(11)
    v_mfma_f32_32x32x16_bf16 v[192:207], a[192:195], v[16:19], v[192:207]
    v_mfma_f32_32x32x16_bf16 v[208:223], a[196:199], v[16:19], v[208:223]
    s_add_u32 s20, s40, 8192
    buffer_load_dwordx4 v[16:19], v1, s[8:11], s20 offen sc1
    s_waitcnt vmcnt(11)
    v_mfma_f32_32x32x16_bf16 v[192:207], a[200:203], v[20:23], v[192:207]
    v_mfma_f32_32x32x16_bf16 v[208:223], a[204:207], v[20:23], v[208:223]
    buffer_load_dwordx4 v[20:23], v1, s[8:11], s20 offen offset:1024 sc1
    s_waitcnt vmcnt(11)
    v_mfma_f32_32x32x16_bf16 v[192:207], a[208:211], v[24:27], v[192:207]
    v_mfma_f32_32x32x16_bf16 v[208:223], a[212:215], v[24:27], v[208:223]
    buffer_load_dwordx4 v[24:27], v1, s[8:11], s20 offen offset:2048 sc1
    s_waitcnt vmcnt(11)
    v_mfma_f32_32x32x16_bf16 v[192:207], a[216:219], v[28:31], v[192:207]
    v_mfma_f32_32x32x16_bf16 v[208:223], a[220:223], v[28:31], v[208:223]
    buffer_load_dwordx4 v[28:31], v1, s[8:11], s20 offen offset:3072 sc1
    s_waitcnt vmcnt(11)
    v_mfma_f32_32x32x16_bf16 v[240:255], a[0:3], v[32:35], v[240:255]
    v_mfma_f32_32x32x16_bf16 v[176:191], a[4:7], v[32:35], 0
    s_add_u32 s20, s40, 12288
    buffer_load_dwordx4 v[32:35], v1, s[8:11], s20 offen sc1
    s_waitcnt vmcnt(11)
    v_mfma_f32_32x32x16_bf16 v[240:255], a[8:11], v[36:39], v[240:255]
    v_mfma_f32_32x32x16_bf16 v[176:191], a[12:15], v[36:39], v[176:191]
    buffer_load_dwordx4 v[36:39], v1, s[8:11], s20 offen offset:1024 sc1
    s_waitcnt vmcnt(11)
    v_mfma_f32_32x32x16_bf16 v[240:255], a[16:19], v[40:43], v[240:255]
    v_mfma_f32_32x32x16_bf16 v[176:191], a[20:23], v[40:43], v[176:191]
    buffer_load_dwordx4 v[40:43], v1, s[8:11], s20 offen offset:2048 sc1
    s_waitcnt vmcnt(11)
    v_mfma_f32_32x32x16_bf16 v[240:255], a[24:27], v[44:47], v[240:255]
    v_mfma_f32_32x32x16_bf16 v[176:191], a[28:31], v[44:47], v[176:191]
    buffer_load_dwordx4 v[44:47], v1, s[8:11], s20 offen offset:3072 sc1
    ds_write_b128 v11, v[192:195] offset:16384
    s_waitcnt vmcnt(11)
    v_mfma_f32_32x32x16_bf16 v[240:255], a[32:35], v[48:51], v[240:255]
    v_mfma_f32_32x32x16_bf16 v[176:191], a[36:39], v[48:51], v[176:191]
    s_add_u32 s20, s40, 16384
    buffer_load_dwordx4 v[48:51], v1, s[8:11], s20 offen sc1
    ds_write_b128 v11, v[196:199] offset:17408
    s_waitcnt vmcnt(11)
    v_mfma_f32_32x32x16_bf16 v[240:255], a[40:43], v[52:55], v[240:255]
    v_mfma_f32_32x32x16_bf16 v[176:191], a[44:47], v[52:55], v[176:191]
    buffer_load_dwordx4 v[52:55], v1, s[8:11], s20 offen offset:1024 sc1
    ds_write_b128 v11, v[200:203] offset:18432
    s_waitcnt vmcnt(11)
    v_mfma_f32_32x32x16_bf16 v[240:255], a[48:51], v[56:59], v[240:255]
    v_mfma_f32_32x32x16_bf16 v[176:191], a[52:55], v[56:59], v[176:191]
    buffer_load_dwordx4 v[56:59], v1, s[8:11], s20 offen offset:2048 sc1
    ds_write_b128 v11, v[204:207] offset:19456
    s_waitcnt vmcnt(11)
    v_mfma_f32_32x32x16_bf16 v[240:255], a[56:59], v[60:63], v[240:255]
    v_mfma_f32_32x32x16_bf16 v[176:191], a[60:63], v[60:63], v[176:191]
    buffer_load_dwordx4 v[60:63], v1, s[8:11], s20 offen offset:3072 sc1
    ds_write_b128 v12, v[208:211] offset:32768
    s_waitcnt vmcnt(11)
    v_mfma_f32_32x32x16_bf16 v[240:255], a[64:67], v[16:19], v[240:255]
    v_mfma_f32_32x32x16_bf16 v[176:191], a[68:71], v[16:19], v[176:191]
    s_add_u32 s20, s40, 20480
    buffer_load_dwordx4 v[16:19], v1, s[8:11], s20 offen sc1
    ds_write_b128 v12, v[212:215] offset:33792
    s_waitcnt vmcnt(11)
    v_mfma_f32_32x32x16_bf16 v[240:255], a[72:75], v[20:23], v[240:255]
    v_mfma_f32_32x32x16_bf16 v[176:191], a[76:79], v[20:23], v[176:191]
    buffer_load_dwordx4 v[20:23], v1, s[8:11], s20 offen offset:1024 sc1
    ds_write_b128 v12, v[216:219] offset:34816
    s_waitcnt vmcnt(11)
    v_mfma_f32_32x32x16_bf16 v[240:255], a[80:83], v[24:27], v[240:255]
    v_mfma_f32_32x32x16_bf16 v[176:191], a[84:87], v[24:27], v[176:191]
    buffer_load_dwordx4 v[24:27], v1, s[8:11], s20 offen offset:2048 sc1
    ds_write_b128 v12, v[220:223] offset:35840
    s_waitcnt vmcnt(11)
    v_mfma_f32_32x32x16_bf16 v[240:255], a[88:91], v[28:31], v[240:255]
    v_mfma_f32_32x32x16_bf16 v[176:191], a[92:95], v[28:31], v[176:191]
    buffer_load_dwordx4 v[28:31], v1, s[8:11], s20 offen offset:3072 sc1
    s_waitcnt vmcnt(11)
    v_mfma_f32_32x32x16_bf16 v[240:255], a[96:99], v[32:35], v[240:255]
    v_mfma_f32_32x32x16_bf16 v[176:191], a[100:103], v[32:35], v[176:191]
    s_add_u32 s20, s40, 24576
    buffer_load_dwordx4 v[32:35], v1, s[8:11], s20 offen sc1
    s_waitcnt lgkmcnt(0)
    s_barrier
    ds_read_b128 v[192:195], v13 offset:16384
    ds_read_b128 v[196:199], v13 offset:17408
    ds_read_b128 v[200:203], v13 offset:18432
    ds_read_b128 v[204:207], v13 offset:19456
    ds_read_b128 v[208:211], v13 offset:32768
    ds_read_b128 v[212:215], v13 offset:33792
    ds_read_b128 v[216:219], v13 offset:34816
    ds_read_b128 v[220:223], v13 offset:35840
    s_waitcnt vmcnt(11)
    v_mfma_f32_32x32x16_bf16 v[240:255], a[104:107], v[36:39], v[240:255]
    v_mfma_f32_32x32x16_bf16 v[176:191], a[108:111], v[36:39], v[176:191]
    buffer_load_dwordx4 v[36:39], v1, s[8:11], s20 offen offset:1024 sc1
    s_waitcnt vmcnt(11)
    v_mfma_f32_32x32x16_bf16 v[240:255], a[112:115], v[40:43], v[240:255]
    v_mfma_f32_32x32x16_bf16 v[176:191], a[116:119], v[40:43], v[176:191]
    buffer_load_dwordx4 v[40:43], v1, s[8:11], s20 offen offset:2048 sc1
    s_waitcnt vmcnt(11)
    v_mfma_f32_32x32x16_bf16 v[240:255], a[120:123], v[44:47], v[240:255]
    v_mfma_f32_32x32x16_bf16 v[176:191], a[124:127], v[44:47], v[176:191]
    buffer_load_dwordx4 v[44:47], v1, s[8:11], s20 offen offset:3072 sc1
    s_waitcnt lgkmcnt(0)
    s_waitcnt vmcnt(11)
    v_mfma_f32_32x32x16_bf16 v[240:255], a[128:131], v[48:51], v[240:255]
    v_mfma_f32_32x32x16_bf16 v[176:191], a[132:135], v[48:51], v[176:191]
    s_mov_b32 s52, s50
    s_add_u32 m0, s51, 0
    s_nop 0
    buffer_load_dwordx4 v1, s[8:11], s52 offen sc1 lds
    v_add_f32 v192, v192, v208
    v_add_f32 v193, v193, v209
    v_add_f32 v194, v194, v210
    v_add_f32 v195, v195, v211
    s_waitcnt vmcnt(11)
    v_mfma_f32_32x32x16_bf16 v[240:255], a[136:139], v[52:55], v[240:255]
    v_mfma_f32_32x32x16_bf16 v[176:191], a[140:143], v[52:55], v[176:191]
    buffer_load_dwordx4 v1, s[8:11], s52 offen offset:1024 sc1 lds
    v_add_f32 v196, v196, v212
    v_add_f32 v197, v197, v213
    v_add_f32 v198, v198, v214
    v_add_f32 v199, v199, v215
    s_waitcnt vmcnt(11)
    v_mfma_f32_32x32x16_bf16 v[240:255], a[144:147], v[56:59], v[240:255]
    v_mfma_f32_32x32x16_bf16 v[176:191], a[148:151], v[56:59], v[176:191]
    buffer_load_dwordx4 v1, s[8:11], s52 offen offset:2048 sc1 lds
    v_add_f32 v200, v200, v216
    v_add_f32 v201, v201, v217
    v_add_f32 v202, v202, v218
    v_add_f32 v203, v203, v219
    s_waitcnt vmcnt(11)
    v_mfma_f32_32x32x16_bf16 v[240:255], a[152:155], v[60:63], v[240:255]
    v_mfma_f32_32x32x16_bf16 v[176:191], a[156:159], v[60:63], v[176:191]
    buffer_load_dwordx4 v1, s[8:11], s52 offen offset:3072 sc1 lds
    v_add_f32 v204, v204, v220
    v_add_f32 v205, v205, v221
    v_add_f32 v206, v206, v222
    v_add_f32 v207, v207, v223
    s_waitcnt vmcnt(11)
    v_mfma_f32_32x32x16_bf16 v[176:191], a[164:167], v[16:19], v[176:191]
    s_add_u32 s52, s50, 4096
    s_add_u32 m0, s51, 4096
    s_nop 0
    buffer_load_dwordx4 v1, s[8:11], s52 offen sc1 lds
    s_waitcnt vmcnt(11)
    v_mfma_f32_32x32x16_bf16 v[176:191], a[172:175], v[20:23], v[176:191]
    buffer_load_dwordx4 v1, s[8:11], s52 offen offset:1024 sc1 lds
    s_waitcnt vmcnt(11)
    v_mfma_f32_32x32x16_bf16 v[176:191], a[180:183], v[24:27], v[176:191]
    v_add_f32 v240, v240, v192
    v_add_f32 v241, v241, v193
    v_add_f32 v242, v242, v194
    buffer_load_dwordx4 v1, s[8:11], s52 offen offset:2048 sc1 lds
    s_waitcnt vmcnt(11)
    v_mfma_f32_32x32x16_bf16 v[176:191], a[188:191], v[28:31], v[176:191]
    v_add_f32 v243, v243, v195
    v_add_f32 v244, v244, v196
    v_add_f32 v245, v245, v197
    buffer_load_dwordx4 v1, s[8:11], s52 offen offset:3072 sc1 lds
    s_waitcnt vmcnt(11)
    v_mfma_f32_32x32x16_bf16 v[176:191], a[196:199], v[32:35], v[176:191]
    v_add_f32 v246, v246, v198
    v_add_f32 v247, v247, v199
    v_add_f32 v248, v248, v200
    s_add_u32 s52, s50, 8192
    s_add_u32 m0, s51, 8192
    s_nop 0
    buffer_load_dwordx4 v1, s[8:11], s52 offen sc1 lds
    s_waitcnt vmcnt(11)
    v_mfma_f32_32x32x16_bf16 v[176:191], a[204:207], v[36:39], v[176:191]
    v_add_f32 v249, v249, v201
    v_add_f32 v250, v250, v202
    v_add_f32 v251, v251, v203
    buffer_load_dwordx4 v1, s[8:11], s52 offen offset:1024 sc1 lds
    s_waitcnt vmcnt(11)
    v_mfma_f32_32x32x16_bf16 v[176:191], a[212:215], v[40:43], v[176:191]
    v_add_f32 v252, v252, v204
    v_add_f32 v253, v253, v205
    v_add_f32 v254, v254, v206
    buffer_load_dwordx4 v1, s[8:11], s52 offen offset:2048 sc1 lds
    s_waitcnt vmcnt(11)
    v_mfma_f32_32x32x16_bf16 v[176:191], a[220:223], v[44:47], v[176:191]
    v_add_f32 v255, v255, v207
    buffer_load_dwordx4 v1, s[8:11], s52 offen offset:3072 sc1 lds
    s_nop 0
    v_mfma_f32_32x32x16_bf16 v[240:255], a[160:163], v[16:19], v[240:255]
    v_mfma_f32_32x32x16_bf16 v[240:255], a[168:171], v[20:23], v[240:255]
    s_nop 6
    ds_write_b128 v10, v[176:179]
    v_mfma_f32_32x32x16_bf16 v[240:255], a[176:179], v[24:27], v[240:255]
    ds_write_b128 v10, v[180:183] offset:1024
    v_mfma_f32_32x32x16_bf16 v[240:255], a[184:187], v[28:31], v[240:255]
    ds_write_b128 v10, v[184:187] offset:2048
    ds_write_b128 v10, v[188:191] offset:3072
    s_waitcnt lgkmcnt(0)
    s_barrier
    v_mfma_f32_32x32x16_bf16 v[240:255], a[192:195], v[32:35], v[240:255]
    ds_read_b128 v[112:115], v13
    ds_read_b128 v[116:119], v13 offset:1024
    ds_read_b128 v[120:123], v13 offset:2048
    ds_read_b128 v[124:127], v13 offset:3072
    v_mfma_f32_32x32x16_bf16 v[240:255], a[200:203], v[36:39], v[240:255]
    v_mfma_f32_32x32x16_bf16 v[240:255], a[208:211], v[40:43], v[240:255]
    v_mfma_f32_32x32x16_bf16 v[240:255], a[216:219], v[44:47], v[240:255]
    s_add_u32 s20, s12, 4194304
    s_add_u32 s21, s13, 4194304
    s_add_u32 s22, s14, 1912832
    s_waitcnt lgkmcnt(0)
    s_nop 7
    v_pk_add_f32 v[240:241], v[240:241], v[112:113]
    v_pk_add_f32 v[242:243], v[242:243], v[114:115]
    v_pk_add_f32 v[244:245], v[244:245], v[116:117]
    v_pk_add_f32 v[246:247], v[246:247], v[118:119]
    v_pk_add_f32 v[248:249], v[248:249], v[120:121]
    v_pk_add_f32 v[250:251], v[250:251], v[122:123]
    v_pk_add_f32 v[252:253], v[252:253], v[124:125]
    v_pk_add_f32 v[254:255], v[254:255], v[126:127]
    v_cvt_pk_bf16_f32 v160, v240, v241
    v_cvt_pk_bf16_f32 v161, v242, v243
    v_cvt_pk_bf16_f32 v162, v244, v245
    v_cvt_pk_bf16_f32 v163, v246, v247
    buffer_store_dwordx4 v[160:163], v1, s[88:91], s20 offen
    v_cvt_pk_bf16_f32 v164, v248, v249
    v_cvt_pk_bf16_f32 v165, v250, v251
    v_cvt_pk_bf16_f32 v166, v252, v253
    v_cvt_pk_bf16_f32 v167, v254, v255
    buffer_store_dwordx4 v[164:167], v1, s[88:91], s20 offen offset:1024
    v_pk_add_f32 v[168:169], v[240:241], v[242:243]
    v_pk_mul_f32 v[170:171], v[240:241], v[240:241]
    v_pk_fma_f32 v[170:171], v[242:243], v[242:243], v[170:171]
    v_pk_add_f32 v[168:169], v[168:169], v[244:245]
    v_pk_fma_f32 v[170:171], v[244:245], v[244:245], v[170:171]
    v_pk_add_f32 v[168:169], v[168:169], v[246:247]
    v_pk_fma_f32 v[170:171], v[246:247], v[246:247], v[170:171]
    v_pk_add_f32 v[168:169], v[168:169], v[248:249]
    v_pk_fma_f32 v[170:171], v[248:249], v[248:249], v[170:171]
    v_pk_add_f32 v[168:169], v[168:169], v[250:251]
    v_pk_fma_f32 v[170:171], v[250:251], v[250:251], v[170:171]
    v_pk_add_f32 v[168:169], v[168:169], v[252:253]
    v_pk_fma_f32 v[170:171], v[252:253], v[252:253], v[170:171]
    v_pk_add_f32 v[168:169], v[168:169], v[254:255]
    v_pk_fma_f32 v[170:171], v[254:255], v[254:255], v[170:171]
    v_add_f32 v168, v168, v169
    v_add_f32 v169, v170, v171
    v_mov_b32 v170, v168
    v_mov_b32 v171, v169
    s_nop 0
    v_permlane32_swap_b32 v168, v170
    v_permlane32_swap_b32 v169, v171
    v_pk_add_f32 v[168:169], v[168:169], v[170:171]
    s_mov_b32 exec_hi, 0
    buffer_store_dwordx2 v[168:169], v3, s[88:91], s21 offen
    s_cmp_eq_u32 s90, 0
    s_cbranch_scc1 REM_10
    s_mov_b64 exec, 1
    s_waitcnt vmcnt(0)
    buffer_store_dword v8, off, s[8:11], s22
REM_10B:
    s_mov_b64 exec, -1
    s_add_u32 s52, s50, 12288
    s_add_u32 m0, s51, 12288
    s_nop 0
    buffer_load_dwordx4 v1, s[8:11], s52 offen sc1 lds
    s_mov_b32 s52, s42
    s_add_u32 m0, s43, 0
    s_nop 0
    buffer_load_dwordx4 v1, s[8:11], s52 offen sc1 lds
    buffer_load_dwordx4 v1, s[8:11], s52 offen offset:1024 sc1 lds
    buffer_load_dwordx4 v1, s[8:11], s52 offen offset:2048 sc1 lds
    buffer_load_dwordx4 v1, s[8:11], s52 offen offset:3072 sc1 lds
    s_add_u32 s52, s42, 4096
    s_add_u32 m0, s43, 4096
    s_nop 0
    buffer_load_dwordx4 v1, s[8:11], s52 offen sc1 lds
    buffer_load_dwordx4 v1, s[8:11], s52 offen offset:1024 sc1 lds
    buffer_load_dwordx4 v1, s[8:11], s52 offen offset:2048 sc1 lds
    buffer_load_dwordx4 v1, s[8:11], s52 offen offset:3072 sc1 lds
NEXT0:
    s_lshl_b32 s37, s36, 15
    s_add_u32 s37, s37, 4194304
    s_lshl_b32 s40, s27, 6
    s_add_u32 s40, s40, s36
    s_lshl_b32 s41, s40, 12
    s_add_u32 s41, s41, 16777216
    s_lshl_b32 s38, s3, 12
    s_add_u32 s38, s38, 2048
    s_lshl_b32 s39, s36, 6
    s_add_u32 s39, s39, 1912832
    s_mov_b32 s7, 0
POLL_11:
    buffer_load_dword v14, v6, s[8:11], s39 offen sc1
    s_waitcnt vmcnt(0)
    v_cmp_eq_u32 vcc, v8, v14
    s_nop 0
    s_cmp_eq_u64 vcc, -1
    s_cbranch_scc1 POLLD_12
    s_sleep 1
    s_add_u32 s7, s7, 1
    s_cmp_lt_u32 s7, 0x8000
    s_cbranch_scc1 POLL_11
POLLD_12:
    s_mov_b32 s20, s37
    buffer_load_dwordx4 v[16:19], v1, s[8:11], s20 offen sc1
    buffer_load_dwordx4 v[20:23], v1, s[8:11], s20 offen offset:1024 sc1
    buffer_load_dwordx4 v[24:27], v1, s[8:11], s20 offen offset:2048 sc1
    buffer_load_dwordx4 v[28:31], v1, s[8:11], s20 offen offset:3072 sc1
    s_add_u32 s20, s37, 4096
    buffer_load_dwordx4 v[32:35], v1, s[8:11], s20 offen sc1
    buffer_load_dwordx4 v[36:39], v1, s[8:11], s20 offen offset:1024 sc1
    s_barrier
    ds_read_b128 v[128:131], v1 offset:17408
    ds_read_b128 v[132:135], v1 offset:18432
    ds_read_b128 v[136:139], v1 offset:20480
    ds_read_b128 v[140:143], v1 offset:21504
    ds_read_b128 v[144:147], v1 offset:16384
    ds_read_b128 v[148:151], v1 offset:23552
    buffer_load_dwordx4 v[40:43], v1, s[8:11], s20 offen offset:2048 sc1
    buffer_load_dwordx4 v[44:47], v1, s[8:11], s20 offen offset:3072 sc1
    s_add_u32 s20, s37, 8192
    buffer_load_dwordx4 v[48:51], v1, s[8:11], s20 offen sc1
    buffer_load_dwordx4 v[52:55], v1, s[8:11], s20 offen offset:1024 sc1
    s_waitcnt vmcnt(9) lgkmcnt(4)
    v_mfma_f32_32x32x16_bf16 v[180:195], v[128:131], v[16:19], 0
    ds_read_b128 v[152:155], v1 offset:24576
    v_mfma_f32_32x32x16_bf16 v[196:211], v[16:19], v[132:135], 0
    ds_read_b128 v[156:159], v1 offset:26624
    buffer_load_dwordx4 v[56:59], v1, s[8:11], s20 offen offset:2048 sc1
    s_waitcnt vmcnt(9) lgkmcnt(4)
    v_mfma_f32_32x32x16_bf16 v[180:195], v[136:139], v[20:23], v[180:195]
    ds_read_b128 v[160:163], v1 offset:27648
    v_mfma_f32_32x32x16_bf16 v[196:211], v[20:23], v[140:143], v[196:211]
    ds_read_b128 v[128:131], v1 offset:19456
    buffer_load_dwordx4 v[60:63], v1, s[8:11], s20 offen offset:3072 sc1
    s_waitcnt lgkmcnt(4)
    v_mfma_f32_32x32x16_bf16 v[164:179], v[144:147], v[16:19], 0
    ds_read_b128 v[132:135], v1 offset:29696
    s_waitcnt vmcnt(9)
    v_mfma_f32_32x32x16_bf16 v[180:195], v[148:151], v[24:27], v[180:195]
    ds_read_b128 v[136:139], v1 offset:30720
    s_add_u32 s20, s37, 12288
    buffer_load_dwordx4 v[64:67], v1, s[8:11], s20 offen sc1
    s_waitcnt lgkmcnt(4)
    v_mfma_f32_32x32x16_bf16 v[196:211], v[24:27], v[152:155], v[196:211]
    ds_read_b128 v[140:143], v1 offset:32768
    s_waitcnt vmcnt(9)
    v_mfma_f32_32x32x16_bf16 v[180:195], v[156:159], v[28:31], v[180:195]
    ds_read_b128 v[144:147], v1 offset:33792
    buffer_load_dwordx4 v[68:71], v1, s[8:11], s20 offen offset:1024 sc1
    s_waitcnt lgkmcnt(4)
    v_mfma_f32_32x32x16_bf16 v[196:211], v[28:31], v[160:163], v[196:211]
    ds_read_b128 v[148:151], v1 offset:22528
    v_mfma_f32_32x32x16_bf16 v[164:179], v[128:131], v[20:23], v[164:179]
    ds_read_b128 v[152:155], v1 offset:35840
    buffer_load_dwordx4 v[72:75], v1, s[8:11], s20 offen offset:2048 sc1
    s_waitcnt vmcnt(10) lgkmcnt(4)
    v_mfma_f32_32x32x16_bf16 v[180:195], v[132:135], v[32:35], v[180:195]
    ds_read_b128 v[156:159], v1 offset:36864
    v_mfma_f32_32x32x16_bf16 v[196:211], v[32:35], v[136:139], v[196:211]
    ds_read_b128 v[160:163], v1 offset:38912
    buffer_load_dwordx4 v[76:79], v1, s[8:11], s20 offen offset:3072 sc1
    s_waitcnt vmcnt(10) lgkmcnt(4)
    v_mfma_f32_32x32x16_bf16 v[180:195], v[140:143], v[36:39], v[180:195]
    ds_read_b128 v[128:131], v1 offset:39936
    v_mfma_f32_32x32x16_bf16 v[196:211], v[36:39], v[144:147], v[196:211]
    ds_read_b128 v[132:135], v1 offset:25600
    s_add_u32 s21, s37, 28672
    buffer_load_dwordx2 v[212:213], v3, s[8:11], s21 offen sc1
    s_waitcnt lgkmcnt(4)
    v_mfma_f32_32x32x16_bf16 v[164:179], v[148:151], v[24:27], v[164:179]
    ds_read_b128 v[136:139], v1 offset:41984
    s_waitcnt vmcnt(10)
    v_mfma_f32_32x32x16_bf16 v[180:195], v[152:155], v[40:43], v[180:195]
    ds_read_b128 v[140:143], v1 offset:43008
    buffer_load_dwordx2 v[214:215], v3, s[8:11], s21 offen offset:512 sc1
    s_waitcnt lgkmcnt(4)
    v_mfma_f32_32x32x16_bf16 v[196:211], v[40:43], v[156:159], v[196:211]
    ds_read_b128 v[144:147], v1 offset:45056
    s_waitcnt vmcnt(10)
    v_mfma_f32_32x32x16_bf16 v[180:195], v[160:163], v[44:47], v[180:195]
    ds_read_b128 v[148:151], v1 offset:46080
    buffer_load_dwordx2 v[216:217], v3, s[8:11], s21 offen offset:1024 sc1
    s_waitcnt lgkmcnt(4)
    v_mfma_f32_32x32x16_bf16 v[196:211], v[44:47], v[128:131], v[196:211]
    ds_read_b128 v[152:155], v1 offset:28672
    v_mfma_f32_32x32x16_bf16 v[164:179], v[132:135], v[28:31], v[164:179]
    ds_read_b128 v[156:159], v1 offset:48128
    buffer_load_dwordx2 v[218:219], v3, s[8:11], s21 offen offset:1536 sc1
    s_waitcnt vmcnt(11) lgkmcnt(4)
    v_mfma_f32_32x32x16_bf16 v[180:195], v[136:139], v[48:51], v[180:195]
    ds_read_b128 v[160:163], v2
    v_mfma_f32_32x32x16_bf16 v[196:211], v[48:51], v[140:143], v[196:211]
    ds_read_b128 v[128:131], v2 offset:2048
    buffer_load_dwordx2 v[220:221], v3, s[8:11], s21 offen offset:2048 sc1
    s_waitcnt vmcnt(11) lgkmcnt(4)
    v_mfma_f32_32x32x16_bf16 v[180:195], v[144:147], v[52:55], v[180:195]
    ds_read_b128 v[132:135], v2 offset:3072
    v_mfma_f32_32x32x16_bf16 v[196:211], v[52:55], v[148:151], v[196:211]
    ds_read_b128 v[136:139], v1 offset:31744
    buffer_load_dwordx2 v[222:223], v3, s[8:11], s21 offen offset:2560 sc1
    s_waitcnt lgkmcnt(4)
    v_mfma_f32_32x32x16_bf16 v[164:179], v[152:155], v[32:35], v[164:179]
    ds_read_b128 v[140:143], v2 offset:5120
    s_waitcnt vmcnt(11)
    v_mfma_f32_32x32x16_bf16 v[180:195], v[156:159], v[56:59], v[180:195]
    ds_read_b128 v[144:147], v2 offset:6144
    buffer_load_dwordx2 v[224:225], v3, s[8:11], s21 offen offset:3072 sc1
    s_waitcnt lgkmcnt(4)
    v_mfma_f32_32x32x16_bf16 v[196:211], v[56:59], v[160:163], v[196:211]
    ds_read_b128 v[148:151], v2 offset:8192
    s_waitcnt vmcnt(11)
    v_mfma_f32_32x32x16_bf16 v[180:195], v[128:131], v[60:63], v[180:195]
    ds_read_b128 v[152:155], v2 offset:9216
    s_add_u32 s20, s37, 16384
    buffer_load_dwordx4 v[80:83], v1, s[8:11], s20 offen sc1
    s_waitcnt lgkmcnt(4)
    v_mfma_f32_32x32x16_bf16 v[196:211], v[60:63], v[132:135], v[196:211]
    ds_read_b128 v[156:159], v1 offset:34816
    v_mfma_f32_32x32x16_bf16 v[164:179], v[136:139], v[36:39], v[164:179]
    ds_read_b128 v[160:163], v2 offset:11264
    buffer_load_dwordx4 v[84:87], v1, s[8:11], s20 offen offset:1024 sc1
    s_waitcnt vmcnt(12) lgkmcnt(4)
    v_mfma_f32_32x32x16_bf16 v[180:195], v[140:143], v[64:67], v[180:195]
    ds_read_b128 v[128:131], v2 offset:12288
    v_mfma_f32_32x32x16_bf16 v[196:211], v[64:67], v[144:147], v[196:211]
    ds_read_b128 v[132:135], v2 offset:14336
    buffer_load_dwordx4 v[88:91], v1, s[8:11], s20 offen offset:2048 sc1
    s_waitcnt vmcnt(12) lgkmcnt(4)
    v_mfma_f32_32x32x16_bf16 v[180:195], v[148:151], v[68:71], v[180:195]
    ds_read_b128 v[136:139], v2 offset:15360
    v_mfma_f32_32x32x16_bf16 v[196:211], v[68:71], v[152:155], v[196:211]
    ds_read_b128 v[140:143], v1 offset:37888
    buffer_load_dwordx4 v[92:95], v1, s[8:11], s20 offen offset:3072 sc1
    s_waitcnt lgkmcnt(4)
    v_mfma_f32_32x32x16_bf16 v[164:179], v[156:159], v[40:43], v[164:179]
    ds_read_b128 v[144:147], v2 offset:17408
    s_waitcnt vmcnt(12)
    v_mfma_f32_32x32x16_bf16 v[180:195], v[160:163], v[72:75], v[180:195]
    ds_read_b128 v[148:151], v2 offset:18432
    s_add_u32 s20, s37, 20480
    buffer_load_dwordx4 v[96:99], v1, s[8:11], s20 offen sc1
    s_waitcnt lgkmcnt(4)
    v_mfma_f32_32x32x16_bf16 v[196:211], v[72:75], v[128:131], v[196:211]
    ds_read_b128 v[152:155], v2 offset:20480
    s_waitcnt vmcnt(12)
    v_mfma_f32_32x32x16_bf16 v[180:195], v[132:135], v[76:79], v[180:195]
    ds_read_b128 v[156:159], v2 offset:21504
    buffer_load_dwordx4 v[100:103], v1, s[8:11], s20 offen offset:1024 sc1
    s_waitcnt lgkmcnt(4)
    v_mfma_f32_32x32x16_bf16 v[196:211], v[76:79], v[136:139], v[196:211]
    ds_read_b128 v[160:163], v1 offset:40960
    v_mfma_f32_32x32x16_bf16 v[164:179], v[140:143], v[44:47], v[164:179]
    ds_read_b128 v[128:131], v2 offset:23552
    buffer_load_dwordx4 v[104:107], v1, s[8:11], s20 offen offset:2048 sc1
    s_waitcnt vmcnt(6) lgkmcnt(4)
    v_mfma_f32_32x32x16_bf16 v[180:195], v[144:147], v[80:83], v[180:195]
    ds_read_b128 v[132:135], v2 offset:24576
    v_add_u32 v15, s38, v5
    v_lshrrev_b32 v14, 5, v0
    v_lshl_add_u32 v14, v14, 4, s38
    v_mfma_f32_32x32x16_bf16 v[196:211], v[80:83], v[148:151], v[196:211]
    ds_read_b128 v[136:139], v2 offset:26624
    buffer_load_dwordx4 v[108:111], v1, s[8:11], s20 offen offset:3072 sc1
    v_add_f32 v212, v212, v214
    v_add_f32 v213, v213, v215
    v_add_f32 v212, v212, v216
    s_waitcnt vmcnt(6) lgkmcnt(4)
    v_mfma_f32_32x32x16_bf16 v[180:195], v[152:155], v[84:87], v[180:195]
    ds_read_b128 v[140:143], v2 offset:27648
    v_add_f32 v213, v213, v217
    v_add_f32 v212, v212, v218
    v_add_f32 v213, v213, v219
    v_mfma_f32_32x32x16_bf16 v[196:211], v[84:87], v[156:159], v[196:211]
    ds_read_b128 v[144:147], v1 offset:44032
    s_add_u32 s20, s37, 24576
    buffer_load_dwordx4 v[112:115], v1, s[8:11], s20 offen sc1
    v_add_f32 v212, v212, v220
    v_add_f32 v213, v213, v221
    v_add_f32 v212, v212, v222
    s_waitcnt lgkmcnt(4)
    v_mfma_f32_32x32x16_bf16 v[164:179], v[160:163], v[48:51], v[164:179]
    ds_read_b128 v[148:151], v2 offset:29696
    v_add_f32 v213, v213, v223
    v_add_f32 v212, v212, v224
    v_add_f32 v213, v213, v225
    s_waitcnt vmcnt(6)
    v_mfma_f32_32x32x16_bf16 v[180:195], v[128:131], v[88:91], v[180:195]
    ds_read_b128 v[152:155], v2 offset:30720
    buffer_load_dwordx4 v[116:119], v1, s[8:11], s20 offen offset:1024 sc1
    v_mov_b32 v214, v212
    v_mov_b32 v215, v213
    s_nop 0
    s_waitcnt lgkmcnt(4)
    v_mfma_f32_32x32x16_bf16 v[196:211], v[88:91], v[132:135], v[196:211]
    ds_read_b128 v[156:159], v2 offset:32768
    v_permlane32_swap_b32 v212, v214
    v_permlane32_swap_b32 v213, v215
    v_add_f32 v212, v212, v214
    s_waitcnt vmcnt(6)
    v_mfma_f32_32x32x16_bf16 v[180:195], v[136:139], v[92:95], v[180:195]
    ds_read_b128 v[160:163], v2 offset:33792
    buffer_load_dwordx4 v[120:123], v1, s[8:11], s20 offen offset:2048 sc1
    v_add_f32 v213, v213, v215
    v_mul_f32 v214, 0xbb124925, v212
    v_mul_f32 v215, 0x3b124925, v213
    s_waitcnt lgkmcnt(4)
    v_mfma_f32_32x32x16_bf16 v[196:211], v[92:95], v[140:143], v[196:211]
    ds_read_b128 v[128:131], v1 offset:47104
    v_fma_f32 v215, -v214, v214, v215
    v_max_f32 v215, 0, v215
    v_add_f32 v215, 0x3727c5ac, v215
    v_mfma_f32_32x32x16_bf16 v[164:179], v[144:147], v[52:55], v[164:179]
    ds_read_b128 v[132:135], v2 offset:35840
    buffer_load_dwordx4 v[124:127], v1, s[8:11], s20 offen offset:3072 sc1
    v_rsq_f32 v232, v215
    v_cvt_pk_bf16_f32 v228, v214, v214
    v_mul_f32 v215, v215, v232
    s_waitcnt vmcnt(7) lgkmcnt(4)
    v_mfma_f32_32x32x16_bf16 v[180:195], v[148:151], v[96:99], v[180:195]
    ds_read_b128 v[136:139], v2 offset:36864
    v_and_b32 v216, 0xffff0000, v228
    v_sub_f32 v216, v214, v216
    v_cvt_pk_bf16_f32 v229, v216, v215
    v_mfma_f32_32x32x16_bf16 v[196:211], v[96:99], v[152:155], v[196:211]
    ds_read_b128 v[140:143], v2 offset:38912
    v_and_b32 v217, 0xffff0000, v229
    v_sub_f32 v217, v215, v217
    v_mov_b32 v230, v228
    s_waitcnt vmcnt(6) lgkmcnt(4)
    v_mfma_f32_32x32x16_bf16 v[180:195], v[156:159], v[100:103], v[180:195]
    ds_read_b128 v[144:147], v2 offset:39936
    v_cvt_pk_bf16_f32 v231, v216, v217
    ds_write_b32 v15, v232
    ds_read_b128 v[16:19], v14
    v_mfma_f32_32x32x16_bf16 v[196:211], v[100:103], v[160:163], v[196:211]
    ds_read_b128 v[148:151], v2 offset:1024
    ds_read_b128 v[20:23], v14 offset:32
    ds_read_b128 v[24:27], v14 offset:64
    ds_read_b128 v[28:31], v14 offset:96
    s_waitcnt lgkmcnt(9)
    v_mfma_f32_32x32x16_bf16 v[164:179], v[128:131], v[56:59], v[164:179]
    ds_read_b128 v[152:155], v2 offset:41984
    v_mul_f32 v233, 0x3e8b97f6, v232
    s_waitcnt vmcnt(5)
    v_mfma_f32_32x32x16_bf16 v[180:195], v[132:135], v[104:107], v[180:195]
    ds_read_b128 v[156:159], v2 offset:43008
    s_waitcnt lgkmcnt(9)
    v_mfma_f32_32x32x16_bf16 v[196:211], v[104:107], v[136:139], v[196:211]
    ds_read_b128 v[160:163], v2 offset:45056
    s_waitcnt vmcnt(4)
    v_mfma_f32_32x32x16_bf16 v[180:195], v[140:143], v[108:111], v[180:195]
    ds_read_b128 v[128:131], v2 offset:46080
    s_waitcnt lgkmcnt(7)
    v_mfma_f32_32x32x16_bf16 v[196:211], v[108:111], v[144:147], v[196:211]
    ds_read_b128 v[132:135], v2 offset:4096
    v_mfma_f32_32x32x16_bf16 v[164:179], v[148:151], v[60:63], v[164:179]
    ds_read_b128 v[136:139], v2 offset:48128
    s_waitcnt vmcnt(3) lgkmcnt(4)
    v_mfma_f32_32x32x16_bf16 v[180:195], v[152:155], v[112:115], v[180:195]
    ds_read_b128 v[140:143], v2 offset:49152
    v_mfma_f32_32x32x16_bf16 v[196:211], v[112:115], v[156:159], v[196:211]
    ds_read_b128 v[144:147], v2 offset:51200
    s_waitcnt vmcnt(2) lgkmcnt(4)
    v_mfma_f32_32x32x16_bf16 v[180:195], v[160:163], v[116:119], v[180:195]
    ds_read_b128 v[148:151], v2 offset:52224
    v_mfma_f32_32x32x16_bf16 v[196:211], v[116:119], v[128:131], v[196:211]
    ds_read_b128 v[152:155], v2 offset:7168
    s_waitcnt lgkmcnt(4)
    v_mfma_f32_32x32x16_bf16 v[164:179], v[132:135], v[64:67], v[164:179]
    ds_read_b128 v[156:159], v2 offset:10240
    s_waitcnt vmcnt(1)
    v_mfma_f32_32x32x16_bf16 v[180:195], v[136:139], v[120:123], v[180:195]
    ds_read_b128 v[160:163], v2 offset:13312
    s_waitcnt lgkmcnt(4)
    v_mfma_f32_32x32x16_bf16 v[196:211], v[120:123], v[140:143], v[196:211]
    ds_read_b128 v[128:131], v2 offset:16384
    s_waitcnt vmcnt(0)
    v_mfma_f32_32x32x16_bf16 v[180:195], v[144:147], v[124:127], v[180:195]
    ds_read_b128 v[132:135], v2 offset:19456
    s_waitcnt lgkmcnt(4)
    v_mfma_f32_32x32x16_bf16 v[196:211], v[124:127], v[148:151], v[196:211]
    ds_read_b128 v[136:139], v2 offset:22528
    v_mfma_f32_32x32x16_bf16 v[164:179], v[152:155], v[68:71], v[164:179]
    ds_read_b128 v[140:143], v2 offset:25600
    v_mfma_f32_32x32x16_bf16 v[180:195], a[244:247], v[228:231], v[180:195]
    v_mfma_f32_32x32x16_bf16 v[196:211], v[228:231], a[248:251], v[196:211]
    v_mfma_f32_32x32x16_bf16 v[164:179], a[240:243], v[228:231], v[164:179]
    s_waitcnt lgkmcnt(4)
    v_mfma_f32_32x32x16_bf16 v[164:179], v[156:159], v[72:75], v[164:179]
    ds_read_b128 v[144:147], v2 offset:28672
    s_nop 6
    v_mul_f32 v180, v180, v232
    v_mul_f32 v181, v181, v232
    v_mul_f32 v182, v182, v232
    v_mul_f32 v183, v183, v232
    v_mfma_f32_32x32x16_bf16 v[164:179], v[160:163], v[76:79], v[164:179]
    ds_read_b128 v[148:151], v2 offset:31744
    v_mul_f32 v184, v184, v232
    v_mul_f32 v185, v185, v232
    v_mul_f32 v186, v186, v232
    v_mul_f32 v187, v187, v232
    s_waitcnt lgkmcnt(4)
    v_mfma_f32_32x32x16_bf16 v[164:179], v[128:131], v[80:83], v[164:179]
    ds_read_b128 v[152:155], v2 offset:34816
    v_cvt_pk_bf16_f32 v180, v180, v181
    v_cvt_pk_bf16_f32 v181, v182, v183
    v_cvt_pk_bf16_f32 v182, v184, v185
    v_cvt_pk_bf16_f32 v183, v186, v187
    v_mfma_f32_32x32x16_bf16 v[164:179], v[132:135], v[84:87], v[164:179]
    ds_read_b128 v[156:159], v2 offset:37888
    buffer_store_dwordx4 v[180:183], v1, s[8:11], s41 offen sc1
    v_mul_f32 v188, v188, v232
    v_mul_f32 v189, v189, v232
    v_mul_f32 v190, v190, v232
    s_waitcnt lgkmcnt(4)
    v_mfma_f32_32x32x16_bf16 v[164:179], v[136:139], v[88:91], v[164:179]
    ds_read_b128 v[160:163], v2 offset:40960
    v_mul_f32 v191, v191, v232
    v_mul_f32 v192, v192, v232
    v_mul_f32 v193, v193, v232
    v_mul_f32 v194, v194, v232
    v_mfma_f32_32x32x16_bf16 v[164:179], v[140:143], v[92:95], v[164:179]
    ds_read_b128 v[128:131], v2 offset:44032
    v_mul_f32 v195, v195, v232
    v_cvt_pk_bf16_f32 v184, v188, v189
    v_cvt_pk_bf16_f32 v185, v190, v191
    v_cvt_pk_bf16_f32 v186, v192, v193
    s_waitcnt lgkmcnt(4)
    v_mfma_f32_32x32x16_bf16 v[164:179], v[144:147], v[96:99], v[164:179]
    ds_read_b128 v[132:135], v2 offset:47104
    v_cvt_pk_bf16_f32 v187, v194, v195
    buffer_store_dwordx4 v[184:187], v1, s[8:11], s41 offen offset:1024 sc1
    s_waitcnt lgkmcnt(15)
    v_mul_f32 v196, v196, v16
    v_mfma_f32_32x32x16_bf16 v[164:179], v[148:151], v[100:103], v[164:179]
    ds_read_b128 v[136:139], v2 offset:50176
    v_mul_f32 v197, v197, v17
    v_mul_f32 v198, v198, v18
    v_mul_f32 v199, v199, v19
    v_mul_f32 v200, v200, v20
    s_waitcnt lgkmcnt(4)
    v_mfma_f32_32x32x16_bf16 v[164:179], v[152:155], v[104:107], v[164:179]
    v_mul_f32 v201, v201, v21
    v_mul_f32 v202, v202, v22
    v_mul_f32 v203, v203, v23
    v_cvt_pk_bf16_f32 v188, v196, v197
    v_mfma_f32_32x32x16_bf16 v[164:179], v[156:159], v[108:111], v[164:179]
    v_cvt_pk_bf16_f32 v189, v198, v199
    v_cvt_pk_bf16_f32 v190, v200, v201
    v_cvt_pk_bf16_f32 v191, v202, v203
    buffer_store_dwordx4 v[188:191], v1, s[8:11], s41 offen offset:2048 sc1
    s_waitcnt lgkmcnt(2)
    v_mfma_f32_32x32x16_bf16 v[164:179], v[160:163], v[112:115], v[164:179]
    v_mul_f32 v204, v204, v24
    v_mul_f32 v205, v205, v25
    v_mul_f32 v206, v206, v26
    v_mul_f32 v207, v207, v27
    v_mfma_f32_32x32x16_bf16 v[164:179], v[128:131], v[116:119], v[164:179]
    v_mul_f32 v208, v208, v28
    v_mul_f32 v209, v209, v29
    v_mul_f32 v210, v210, v30
    v_mul_f32 v211, v211, v31
    s_waitcnt lgkmcnt(0)
    v_mfma_f32_32x32x16_bf16 v[164:179], v[132:135], v[120:123], v[164:179]
    v_cvt_pk_bf16_f32 v192, v204, v205
    v_cvt_pk_bf16_f32 v193, v206, v207
    v_cvt_pk_bf16_f32 v194, v208, v209
    v_cvt_pk_bf16_f32 v195, v210, v211
    v_mfma_f32_32x32x16_bf16 v[164:179], v[136:139], v[124:127], v[164:179]
    buffer_store_dwordx4 v[192:195], v1, s[8:11], s41 offen offset:3072 sc1
    s_nop 10
    v_mul_f32 v164, v164, v233
    v_mul_f32 v165, v165, v233
    v_mul_f32 v166, v166, v233
    v_mul_f32 v167, v167, v233
    v_mul_f32 v168, v168, v233
    v_mul_f32 v169, v169, v233
    v_mul_f32 v170, v170, v233
    v_mul_f32 v171, v171, v233
    v_cvt_pk_bf16_f32 v16, v164, v165
    v_cvt_pk_bf16_f32 v17, v166, v167
    v_cvt_pk_bf16_f32 v18, v168, v169
    v_cvt_pk_bf16_f32 v19, v170, v171
    ds_write_b128 v13, v[16:19]
    s_nop 0
    v_mfma_f32_32x32x16_bf16 v[112:127], v[180:183], v[16:19], 0
    v_mul_f32 v172, v172, v233
    v_mul_f32 v173, v173, v233
    v_mul_f32 v174, v174, v233
    v_mul_f32 v175, v175, v233
    v_mul_f32 v176, v176, v233
    v_mul_f32 v177, v177, v233
    v_mul_f32 v178, v178, v233
    v_mul_f32 v179, v179, v233
    v_cvt_pk_bf16_f32 v20, v172, v173
    v_cvt_pk_bf16_f32 v21, v174, v175
    v_cvt_pk_bf16_f32 v22, v176, v177
    v_cvt_pk_bf16_f32 v23, v178, v179
    s_lshl_b32 s22, s40, 7
    s_add_u32 s22, s22, 1769472
    s_lshl_b32 s39, s27, 13
    s_add_u32 s39, s39, 1769472
    v_mfma_f32_32x32x16_bf16 v[112:127], v[184:187], v[20:23], v[112:127]
    s_mov_b64 exec, 61440
    buffer_load_dword v173, v4, s[8:11], s39 offen sc1
    s_mov_b64 exec, -1
    s_mul_i32 s51, s3, 13312
    s_add_u32 s50, s51, s35
    s_add_u32 s51, s51, 49152
    s_nop 5
    v_max_f32 v168, v112, v113
    v_max3_f32 v168, v114, v115, v168
    v_max3_f32 v168, v116, v117, v168
    v_max3_f32 v168, v118, v119, v168
    v_max3_f32 v168, v120, v121, v168
    v_max3_f32 v168, v122, v123, v168
    v_max3_f32 v168, v124, v125, v168
    v_max3_f32 v168, v126, v127, v168
    v_mov_b32 v128, v168
    s_nop 1
    v_permlane32_swap_b32 v168, v128
    v_max_f32 v168, v168, v128
    v_and_b32 v128, 0xffff0000, v168
    v_sub_f32 v132, v168, v128
    v_and_b32 v136, 0xffff0000, v132
    v_sub_f32 v132, v132, v136
    v_cvt_pk_bf16_f32 v128, -v128, -v136
    v_cvt_pk_bf16_f32 v132, -v132, 0
    v_cndmask_b32 v22, v22, v128, s[24:25]
    v_cndmask_b32 v23, v23, v132, s[24:25]
    ds_write_b128 v13, v[20:23] offset:1024
    v_mfma_f32_32x32x16_bf16 v[112:127], v[180:183], v[16:19], 0
    v_mfma_f32_32x32x16_bf16 v[112:127], v[184:187], v[20:23], v[112:127]
    s_waitcnt lgkmcnt(0)
    s_barrier
    ds_read_b128 v[24:27], v10
    ds_read_b128 v[28:31], v10 offset:1024
    ds_read_b128 v[32:35], v11
    ds_read_b128 v[36:39], v11 offset:1024
    ds_read_b128 v[40:43], v12
    ds_read_b128 v[44:47], v12 offset:1024
    s_mov_b64 exec, 1
    s_waitcnt vmcnt(1)
    buffer_store_dword v8, off, s[8:11], s22 sc1
    s_mov_b64 exec, -1
    s_waitcnt vmcnt(1)
    v_cmp_ne_u32 vcc, v8, v173
    s_nop 0
    s_and_b32 s7, vcc_lo, 61440
    s_cbranch_scc1 KSLOW1_1
KBACK1_1:
    s_xor_b32 s23, s41, 245760
    buffer_load_dwordx4 v[152:155], v1, s[8:11], s23 offen sc1
    buffer_load_dwordx4 v[156:159], v1, s[8:11], s23 offen offset:1024 sc1
    buffer_load_dwordx4 v[160:163], v1, s[8:11], s23 offen offset:2048 sc1
    buffer_load_dwordx4 v[164:167], v1, s[8:11], s23 offen offset:3072 sc1
    s_waitcnt lgkmcnt(0)
    s_lshl_b32 s38, s36, 4
    s_add_u32 s38, s38, s27
    s_lshl_b32 s20, s38, 11
    s_add_u32 s20, s20, 6291456
    s_lshl_b32 s22, s38, 2
    s_add_u32 s22, s22, 1900544
    v_mfma_f32_32x32x16_bf16 v[128:143], v[180:183], v[24:27], 0
    s_xor_b32 s23, s41, 229376
    buffer_load_dwordx4 v[196:199], v1, s[8:11], s23 offen sc1
    buffer_load_dwordx4 v[200:203], v1, s[8:11], s23 offen offset:1024 sc1
    buffer_load_dwordx4 v[204:207], v1, s[8:11], s23 offen offset:2048 sc1
    buffer_load_dwordx4 v[208:211], v1, s[8:11], s23 offen offset:3072 sc1
    v_exp_f32 v112, v112
    v_exp_f32 v113, v113
    v_exp_f32 v114, v114
    v_exp_f32 v115, v115
    v_mfma_f32_32x32x16_bf16 v[128:143], v[184:187], v[28:31], v[128:143]
    v_cvt_pk_bf16_f32 v144, v112, v113
    v_cvt_pk_bf16_f32 v145, v114, v115
    v_exp_f32 v116, v116
    v_exp_f32 v117, v117
    v_exp_f32 v118, v118
    v_exp_f32 v119, v119
    v_cvt_pk_bf16_f32 v146, v116, v117
    v_cvt_pk_bf16_f32 v147, v118, v119
    v_exp_f32 v120, v120
    v_exp_f32 v121, v121
    v_exp_f32 v122, v122
    v_exp_f32 v123, v123
    v_mfma_f32_32x32x16_bf16 v[48:63], v[188:191], v[144:147], 0
    v_cvt_pk_bf16_f32 v148, v120, v121
    v_cvt_pk_bf16_f32 v149, v122, v123
    v_exp_f32 v124, v124
    v_exp_f32 v125, v125
    v_exp_f32 v126, v126
    v_exp_f32 v127, v127
    v_cvt_pk_bf16_f32 v150, v124, v125
    v_cvt_pk_bf16_f32 v151, v126, v127
    v_mfma_f32_32x32x16_bf16 v[112:127], v[180:183], v[32:35], 0
    s_xor_b32 s23, s41, 212992
    buffer_load_dwordx4 v[212:215], v1, s[8:11], s23 offen sc1
    buffer_load_dwordx4 v[216:219], v1, s[8:11], s23 offen offset:1024 sc1
    buffer_load_dwordx4 v[220:223], v1, s[8:11], s23 offen offset:2048 sc1
    buffer_load_dwordx4 v[224:227], v1, s[8:11], s23 offen offset:3072 sc1
    v_exp_f32 v128, v128
    v_exp_f32 v129, v129
    v_exp_f32 v130, v130
    v_exp_f32 v131, v131
    v_mfma_f32_32x32x16_bf16 v[112:127], v[184:187], v[36:39], v[112:127]
    s_mov_b64 exec, 3840
    buffer_load_dword v173, v4, s[8:11], s39 offen sc1
    s_mov_b64 exec, -1
    v_cvt_pk_bf16_f32 v144, v128, v129
    v_cvt_pk_bf16_f32 v145, v130, v131
    v_exp_f32 v132, v132
    v_exp_f32 v133, v133
    v_exp_f32 v134, v134
    v_exp_f32 v135, v135
    v_mfma_f32_32x32x16_bf16 v[48:63], v[192:195], v[148:151], v[48:63]
    v_cvt_pk_bf16_f32 v146, v132, v133
    v_cvt_pk_bf16_f32 v147, v134, v135
    v_exp_f32 v136, v136
    v_exp_f32 v137, v137
    v_exp_f32 v138, v138
    v_exp_f32 v139, v139
    v_mfma_f32_32x32x16_bf16 v[64:79], v[188:191], v[144:147], 0
    v_cvt_pk_bf16_f32 v148, v136, v137
    v_cvt_pk_bf16_f32 v149, v138, v139
    v_exp_f32 v140, v140
    v_exp_f32 v141, v141
    v_exp_f32 v142, v142
    v_exp_f32 v143, v143
    v_cvt_pk_bf16_f32 v150, v140, v141
    v_cvt_pk_bf16_f32 v151, v142, v143
    v_mfma_f32_32x32x16_bf16 v[128:143], v[180:183], v[40:43], 0
    v_exp_f32 v112, v112
    v_exp_f32 v113, v113
    v_exp_f32 v114, v114
    v_exp_f32 v115, v115
    v_mfma_f32_32x32x16_bf16 v[128:143], v[184:187], v[44:47], v[128:143]
    v_cvt_pk_bf16_f32 v144, v112, v113
    v_cvt_pk_bf16_f32 v145, v114, v115
    v_exp_f32 v116, v116
    v_exp_f32 v117, v117
    v_exp_f32 v118, v118
    v_exp_f32 v119, v119
    v_mfma_f32_32x32x16_bf16 v[64:79], v[192:195], v[148:151], v[64:79]
    v_cvt_pk_bf16_f32 v146, v116, v117
    v_cvt_pk_bf16_f32 v147, v118, v119
    v_exp_f32 v120, v120
    v_exp_f32 v121, v121
    v_exp_f32 v122, v122
    v_exp_f32 v123, v123
    v_mfma_f32_32x32x16_bf16 v[80:95], v[188:191], v[144:147], 0
    v_cvt_pk_bf16_f32 v148, v120, v121
    v_cvt_pk_bf16_f32 v149, v122, v123
    v_exp_f32 v124, v124
    v_exp_f32 v125, v125
    v_exp_f32 v126, v126
    v_exp_f32 v127, v127
    v_cvt_pk_bf16_f32 v150, v124, v125
    v_cvt_pk_bf16_f32 v151, v126, v127
    s_waitcnt vmcnt(11)
    v_mfma_f32_32x32x16_bf16 v[112:127], v[152:155], v[16:19], 0
    v_exp_f32 v128, v128
    v_exp_f32 v129, v129
    v_exp_f32 v130, v130
    v_exp_f32 v131, v131
    v_mfma_f32_32x32x16_bf16 v[112:127], v[156:159], v[20:23], v[112:127]
    v_cvt_pk_bf16_f32 v144, v128, v129
    v_cvt_pk_bf16_f32 v145, v130, v131
    v_exp_f32 v132, v132
    v_exp_f32 v133, v133
    v_exp_f32 v134, v134
    v_exp_f32 v135, v135
    v_mfma_f32_32x32x16_bf16 v[80:95], v[192:195], v[148:151], v[80:95]
    v_cvt_pk_bf16_f32 v146, v132, v133
    v_cvt_pk_bf16_f32 v147, v134, v135
    v_exp_f32 v136, v136
    v_exp_f32 v137, v137
    v_exp_f32 v138, v138
    v_exp_f32 v139, v139
    v_mfma_f32_32x32x16_bf16 v[96:111], v[188:191], v[144:147], 0
    v_cvt_pk_bf16_f32 v148, v136, v137
    v_cvt_pk_bf16_f32 v149, v138, v139
    v_exp_f32 v140, v140
    v_exp_f32 v141, v141
    v_exp_f32 v142, v142
    v_exp_f32 v143, v143
    v_cvt_pk_bf16_f32 v150, v140, v141
    v_cvt_pk_bf16_f32 v151, v142, v143
    s_waitcnt vmcnt(9)
    v_mfma_f32_32x32x16_bf16 v[128:143], v[152:155], v[24:27], 0
    v_exp_f32 v112, v112
    v_exp_f32 v113, v113
    v_exp_f32 v114, v114
    v_exp_f32 v115, v115
    v_mfma_f32_32x32x16_bf16 v[128:143], v[156:159], v[28:31], v[128:143]
    s_xor_b32 s23, s41, 196608
    v_cvt_pk_bf16_f32 v144, v112, v113
    v_cvt_pk_bf16_f32 v145, v114, v115
    v_exp_f32 v116, v116
    v_exp_f32 v117, v117
    v_exp_f32 v118, v118
    v_exp_f32 v119, v119
    v_mfma_f32_32x32x16_bf16 v[96:111], v[192:195], v[148:151], v[96:111]
    buffer_load_dwordx4 v[180:183], v1, s[8:11], s23 offen sc1
    buffer_load_dwordx4 v[184:187], v1, s[8:11], s23 offen offset:1024 sc1
    buffer_load_dwordx4 v[188:191], v1, s[8:11], s23 offen offset:2048 sc1
    buffer_load_dwordx4 v[192:195], v1, s[8:11], s23 offen offset:3072 sc1
    s_mov_b32 s52, s50
    s_add_u32 m0, s51, 0
    s_nop 0
    buffer_load_dwordx4 v1, s[8:11], s52 offen sc1 lds
    v_cvt_pk_bf16_f32 v146, v116, v117
    v_cvt_pk_bf16_f32 v147, v118, v119
    v_exp_f32 v120, v120
    v_exp_f32 v121, v121
    v_exp_f32 v122, v122
    v_exp_f32 v123, v123
    v_mfma_f32_32x32x16_bf16 v[48:63], v[160:163], v[144:147], v[48:63]
    v_cvt_pk_bf16_f32 v148, v120, v121
    v_cvt_pk_bf16_f32 v149, v122, v123
    v_exp_f32 v124, v124
    v_exp_f32 v125, v125
    v_exp_f32 v126, v126
    v_exp_f32 v127, v127
    v_cvt_pk_bf16_f32 v150, v124, v125
    v_cvt_pk_bf16_f32 v151, v126, v127
    v_mfma_f32_32x32x16_bf16 v[112:127], v[152:155], v[32:35], 0
    v_exp_f32 v128, v128
    v_exp_f32 v129, v129
    v_exp_f32 v130, v130
    v_exp_f32 v131, v131
    v_mfma_f32_32x32x16_bf16 v[112:127], v[156:159], v[36:39], v[112:127]
    v_cvt_pk_bf16_f32 v144, v128, v129
    v_cvt_pk_bf16_f32 v145, v130, v131
    v_exp_f32 v132, v132
    v_exp_f32 v133, v133
    v_exp_f32 v134, v134
    v_exp_f32 v135, v135
    v_mfma_f32_32x32x16_bf16 v[48:63], v[164:167], v[148:151], v[48:63]
    v_cvt_pk_bf16_f32 v146, v132, v133
    v_cvt_pk_bf16_f32 v147, v134, v135
    v_exp_f32 v136, v136
    v_exp_f32 v137, v137
    v_exp_f32 v138, v138
    v_exp_f32 v139, v139
    v_mfma_f32_32x32x16_bf16 v[64:79], v[160:163], v[144:147], v[64:79]
    v_cvt_pk_bf16_f32 v148, v136, v137
    v_cvt_pk_bf16_f32 v149, v138, v139
    v_exp_f32 v140, v140
    v_exp_f32 v141, v141
    v_exp_f32 v142, v142
    v_exp_f32 v143, v143
    v_cvt_pk_bf16_f32 v150, v140, v141
    v_cvt_pk_bf16_f32 v151, v142, v143
    v_mfma_f32_32x32x16_bf16 v[128:143], v[152:155], v[40:43], 0
    v_exp_f32 v112, v112
    v_exp_f32 v113, v113
    v_exp_f32 v114, v114
    v_exp_f32 v115, v115
    v_mfma_f32_32x32x16_bf16 v[128:143], v[156:159], v[44:47], v[128:143]
    v_cvt_pk_bf16_f32 v144, v112, v113
    v_cvt_pk_bf16_f32 v145, v114, v115
    v_exp_f32 v116, v116
    v_exp_f32 v117, v117
    v_exp_f32 v118, v118
    v_exp_f32 v119, v119
    v_mfma_f32_32x32x16_bf16 v[64:79], v[164:167], v[148:151], v[64:79]
    v_cvt_pk_bf16_f32 v146, v116, v117
    v_cvt_pk_bf16_f32 v147, v118, v119
    v_exp_f32 v120, v120
    v_exp_f32 v121, v121
    v_exp_f32 v122, v122
    v_exp_f32 v123, v123
    v_mfma_f32_32x32x16_bf16 v[80:95], v[160:163], v[144:147], v[80:95]
    v_cvt_pk_bf16_f32 v148, v120, v121
    v_cvt_pk_bf16_f32 v149, v122, v123
    v_exp_f32 v124, v124
    v_exp_f32 v125, v125
    v_exp_f32 v126, v126
    v_exp_f32 v127, v127
    v_cvt_pk_bf16_f32 v150, v124, v125
    v_cvt_pk_bf16_f32 v151, v126, v127
    s_waitcnt vmcnt(10)
    v_mfma_f32_32x32x16_bf16 v[112:127], v[196:199], v[16:19], 0
    v_exp_f32 v128, v128
    v_exp_f32 v129, v129
    v_exp_f32 v130, v130
    v_exp_f32 v131, v131
    v_mfma_f32_32x32x16_bf16 v[112:127], v[200:203], v[20:23], v[112:127]
    s_waitcnt vmcnt(5)
    v_cmp_ne_u32 vcc, v8, v173
    s_nop 0
    s_and_b32 s7, vcc_lo, 3840
    s_cbranch_scc1 KSLOW1_5
KBACK1_5:
    v_cvt_pk_bf16_f32 v144, v128, v129
    v_cvt_pk_bf16_f32 v145, v130, v131
    v_exp_f32 v132, v132
    v_exp_f32 v133, v133
    v_exp_f32 v134, v134
    v_exp_f32 v135, v135
    v_mfma_f32_32x32x16_bf16 v[80:95], v[164:167], v[148:151], v[80:95]
    v_cvt_pk_bf16_f32 v146, v132, v133
    v_cvt_pk_bf16_f32 v147, v134, v135
    v_exp_f32 v136, v136
    v_exp_f32 v137, v137
    v_exp_f32 v138, v138
    v_exp_f32 v139, v139
    v_mfma_f32_32x32x16_bf16 v[96:111], v[160:163], v[144:147], v[96:111]
    v_cvt_pk_bf16_f32 v148, v136, v137
    v_cvt_pk_bf16_f32 v149, v138, v139
    v_exp_f32 v140, v140
    v_exp_f32 v141, v141
    v_exp_f32 v142, v142
    v_exp_f32 v143, v143
    v_cvt_pk_bf16_f32 v150, v140, v141
    v_cvt_pk_bf16_f32 v151, v142, v143
    v_mfma_f32_32x32x16_bf16 v[128:143], v[196:199], v[24:27], 0
    v_exp_f32 v112, v112
    v_exp_f32 v113, v113
    v_exp_f32 v114, v114
    v_exp_f32 v115, v115
    v_mfma_f32_32x32x16_bf16 v[128:143], v[200:203], v[28:31], v[128:143]
    s_xor_b32 s23, s41, 180224
    v_cvt_pk_bf16_f32 v144, v112, v113
    v_cvt_pk_bf16_f32 v145, v114, v115
    v_exp_f32 v116, v116
    v_exp_f32 v117, v117
    v_exp_f32 v118, v118
    v_exp_f32 v119, v119
    v_mfma_f32_32x32x16_bf16 v[96:111], v[164:167], v[148:151], v[96:111]
    buffer_load_dwordx4 v[152:155], v1, s[8:11], s23 offen sc1
    buffer_load_dwordx4 v[156:159], v1, s[8:11], s23 offen offset:1024 sc1
    buffer_load_dwordx4 v[160:163], v1, s[8:11], s23 offen offset:2048 sc1
    buffer_load_dwordx4 v[164:167], v1, s[8:11], s23 offen offset:3072 sc1
    buffer_load_dwordx4 v1, s[8:11], s52 offen offset:1024 sc1 lds
    v_cvt_pk_bf16_f32 v146, v116, v117
    v_cvt_pk_bf16_f32 v147, v118, v119
    v_exp_f32 v120, v120
    v_exp_f32 v121, v121
    v_exp_f32 v122, v122
    v_exp_f32 v123, v123
    v_mfma_f32_32x32x16_bf16 v[48:63], v[204:207], v[144:147], v[48:63]
    v_cvt_pk_bf16_f32 v148, v120, v121
    v_cvt_pk_bf16_f32 v149, v122, v123
    v_exp_f32 v124, v124
    v_exp_f32 v125, v125
    v_exp_f32 v126, v126
    v_exp_f32 v127, v127
    v_cvt_pk_bf16_f32 v150, v124, v125
    v_cvt_pk_bf16_f32 v151, v126, v127
    v_mfma_f32_32x32x16_bf16 v[112:127], v[196:199], v[32:35], 0
    v_exp_f32 v128, v128
    v_exp_f32 v129, v129
    v_exp_f32 v130, v130
    v_exp_f32 v131, v131
    v_mfma_f32_32x32x16_bf16 v[112:127], v[200:203], v[36:39], v[112:127]
    v_cvt_pk_bf16_f32 v144, v128, v129
    v_cvt_pk_bf16_f32 v145, v130, v131
    v_exp_f32 v132, v132
    v_exp_f32 v133, v133
    v_exp_f32 v134, v134
    v_exp_f32 v135, v135
    v_mfma_f32_32x32x16_bf16 v[48:63], v[208:211], v[148:151], v[48:63]
    v_cvt_pk_bf16_f32 v146, v132, v133
    v_cvt_pk_bf16_f32 v147, v134, v135
    v_exp_f32 v136, v136
    v_exp_f32 v137, v137
    v_exp_f32 v138, v138
    v_exp_f32 v139, v139
    v_mfma_f32_32x32x16_bf16 v[64:79], v[204:207], v[144:147], v[64:79]
    v_cvt_pk_bf16_f32 v148, v136, v137
    v_cvt_pk_bf16_f32 v149, v138, v139
    v_exp_f32 v140, v140
    v_exp_f32 v141, v141
    v_exp_f32 v142, v142
    v_exp_f32 v143, v143
    v_cvt_pk_bf16_f32 v150, v140, v141
    v_cvt_pk_bf16_f32 v151, v142, v143
    v_mfma_f32_32x32x16_bf16 v[128:143], v[196:199], v[40:43], 0
    v_exp_f32 v112, v112
    v_exp_f32 v113, v113
    v_exp_f32 v114, v114
    v_exp_f32 v115, v115
    v_mfma_f32_32x32x16_bf16 v[128:143], v[200:203], v[44:47], v[128:143]
    v_cvt_pk_bf16_f32 v144, v112, v113
    v_cvt_pk_bf16_f32 v145, v114, v115
    v_exp_f32 v116, v116
    v_exp_f32 v117, v117
    v_exp_f32 v118, v118
    v_exp_f32 v119, v119
    v_mfma_f32_32x32x16_bf16 v[64:79], v[208:211], v[148:151], v[64:79]
    v_cvt_pk_bf16_f32 v146, v116, v117
    v_cvt_pk_bf16_f32 v147, v118, v119
    v_exp_f32 v120, v120
    v_exp_f32 v121, v121
    v_exp_f32 v122, v122
    v_exp_f32 v123, v123
    v_mfma_f32_32x32x16_bf16 v[80:95], v[204:207], v[144:147], v[80:95]
    v_cvt_pk_bf16_f32 v148, v120, v121
    v_cvt_pk_bf16_f32 v149, v122, v123
    v_exp_f32 v124, v124
    v_exp_f32 v125, v125
    v_exp_f32 v126, v126
    v_exp_f32 v127, v127
    v_cvt_pk_bf16_f32 v150, v124, v125
    v_cvt_pk_bf16_f32 v151, v126, v127
    s_waitcnt vmcnt(11)
    v_mfma_f32_32x32x16_bf16 v[112:127], v[212:215], v[16:19], 0
    v_exp_f32 v128, v128
    v_exp_f32 v129, v129
    v_exp_f32 v130, v130
    v_exp_f32 v131, v131
    v_mfma_f32_32x32x16_bf16 v[112:127], v[216:219], v[20:23], v[112:127]
    v_cvt_pk_bf16_f32 v144, v128, v129
    v_cvt_pk_bf16_f32 v145, v130, v131
    v_exp_f32 v132, v132
    v_exp_f32 v133, v133
    v_exp_f32 v134, v134
    v_exp_f32 v135, v135
    v_mfma_f32_32x32x16_bf16 v[80:95], v[208:211], v[148:151], v[80:95]
    v_cvt_pk_bf16_f32 v146, v132, v133
    v_cvt_pk_bf16_f32 v147, v134, v135
    v_exp_f32 v136, v136
    v_exp_f32 v137, v137
    v_exp_f32 v138, v138
    v_exp_f32 v139, v139
    v_mfma_f32_32x32x16_bf16 v[96:111], v[204:207], v[144:147], v[96:111]
    v_cvt_pk_bf16_f32 v148, v136, v137
    v_cvt_pk_bf16_f32 v149, v138, v139
    v_exp_f32 v140, v140
    v_exp_f32 v141, v141
    v_exp_f32 v142, v142
    v_exp_f32 v143, v143
    v_cvt_pk_bf16_f32 v150, v140, v141
    v_cvt_pk_bf16_f32 v151, v142, v143
    v_mfma_f32_32x32x16_bf16 v[128:143], v[212:215], v[24:27], 0
    v_exp_f32 v112, v112
    v_exp_f32 v113, v113
    v_exp_f32 v114, v114
    v_exp_f32 v115, v115
    v_mfma_f32_32x32x16_bf16 v[128:143], v[216:219], v[28:31], v[128:143]
    s_xor_b32 s23, s41, 163840
    v_cvt_pk_bf16_f32 v144, v112, v113
    v_cvt_pk_bf16_f32 v145, v114, v115
    v_exp_f32 v116, v116
    v_exp_f32 v117, v117
    v_exp_f32 v118, v118
    v_exp_f32 v119, v119
    v_mfma_f32_32x32x16_bf16 v[96:111], v[208:211], v[148:151], v[96:111]
    buffer_load_dwordx4 v[196:199], v1, s[8:11], s23 offen sc1
    buffer_load_dwordx4 v[200:203], v1, s[8:11], s23 offen offset:1024 sc1
    buffer_load_dwordx4 v[204:207], v1, s[8:11], s23 offen offset:2048 sc1
    buffer_load_dwordx4 v[208:211], v1, s[8:11], s23 offen offset:3072 sc1
    buffer_load_dwordx4 v1, s[8:11], s52 offen offset:2048 sc1 lds
    v_cvt_pk_bf16_f32 v146, v116, v117
    v_cvt_pk_bf16_f32 v147, v118, v119
    v_exp_f32 v120, v120
    v_exp_f32 v121, v121
    v_exp_f32 v122, v122
    v_exp_f32 v123, v123
    v_mfma_f32_32x32x16_bf16 v[48:63], v[220:223], v[144:147], v[48:63]
    v_cvt_pk_bf16_f32 v148, v120, v121
    v_cvt_pk_bf16_f32 v149, v122, v123
    v_exp_f32 v124, v124
    v_exp_f32 v125, v125
    v_exp_f32 v126, v126
    v_exp_f32 v127, v127
    v_cvt_pk_bf16_f32 v150, v124, v125
    v_cvt_pk_bf16_f32 v151, v126, v127
    v_mfma_f32_32x32x16_bf16 v[112:127], v[212:215], v[32:35], 0
    v_exp_f32 v128, v128
    v_exp_f32 v129, v129
    v_exp_f32 v130, v130
    v_exp_f32 v131, v131
    v_mfma_f32_32x32x16_bf16 v[112:127], v[216:219], v[36:39], v[112:127]
    s_mov_b64 exec, 254
    buffer_load_dword v173, v4, s[8:11], s39 offen sc1
    s_mov_b64 exec, -1
    v_cvt_pk_bf16_f32 v144, v128, v129
    v_cvt_pk_bf16_f32 v145, v130, v131
    v_exp_f32 v132, v132
    v_exp_f32 v133, v133
    v_exp_f32 v134, v134
    v_exp_f32 v135, v135
    v_mfma_f32_32x32x16_bf16 v[48:63], v[224:227], v[148:151], v[48:63]
    v_cvt_pk_bf16_f32 v146, v132, v133
    v_cvt_pk_bf16_f32 v147, v134, v135
    v_exp_f32 v136, v136
    v_exp_f32 v137, v137
    v_exp_f32 v138, v138
    v_exp_f32 v139, v139
    v_mfma_f32_32x32x16_bf16 v[64:79], v[220:223], v[144:147], v[64:79]
    v_cvt_pk_bf16_f32 v148, v136, v137
    v_cvt_pk_bf16_f32 v149, v138, v139
    v_exp_f32 v140, v140
    v_exp_f32 v141, v141
    v_exp_f32 v142, v142
    v_exp_f32 v143, v143
    v_cvt_pk_bf16_f32 v150, v140, v141
    v_cvt_pk_bf16_f32 v151, v142, v143
    v_mfma_f32_32x32x16_bf16 v[128:143], v[212:215], v[40:43], 0
    v_exp_f32 v112, v112
    v_exp_f32 v113, v113
    v_exp_f32 v114, v114
    v_exp_f32 v115, v115
    v_mfma_f32_32x32x16_bf16 v[128:143], v[216:219], v[44:47], v[128:143]
    v_cvt_pk_bf16_f32 v144, v112, v113
    v_cvt_pk_bf16_f32 v145, v114, v115
    v_exp_f32 v116, v116
    v_exp_f32 v117, v117
    v_exp_f32 v118, v118
    v_exp_f32 v119, v119
    v_mfma_f32_32x32x16_bf16 v[64:79], v[224:227], v[148:151], v[64:79]
    v_cvt_pk_bf16_f32 v146, v116, v117
    v_cvt_pk_bf16_f32 v147, v118, v119
    v_exp_f32 v120, v120
    v_exp_f32 v121, v121
    v_exp_f32 v122, v122
    v_exp_f32 v123, v123
    v_mfma_f32_32x32x16_bf16 v[80:95], v[220:223], v[144:147], v[80:95]
    v_cvt_pk_bf16_f32 v148, v120, v121
    v_cvt_pk_bf16_f32 v149, v122, v123
    v_exp_f32 v124, v124
    v_exp_f32 v125, v125
    v_exp_f32 v126, v126
    v_exp_f32 v127, v127
    v_cvt_pk_bf16_f32 v150, v124, v125
    v_cvt_pk_bf16_f32 v151, v126, v127
    s_waitcnt vmcnt(12)
    v_mfma_f32_32x32x16_bf16 v[112:127], v[180:183], v[16:19], 0
    v_exp_f32 v128, v128
    v_exp_f32 v129, v129
    v_exp_f32 v130, v130
    v_exp_f32 v131, v131
    v_mfma_f32_32x32x16_bf16 v[112:127], v[184:187], v[20:23], v[112:127]
    v_cvt_pk_bf16_f32 v144, v128, v129
    v_cvt_pk_bf16_f32 v145, v130, v131
    v_exp_f32 v132, v132
    v_exp_f32 v133, v133
    v_exp_f32 v134, v134
    v_exp_f32 v135, v135
    v_mfma_f32_32x32x16_bf16 v[80:95], v[224:227], v[148:151], v[80:95]
    v_cvt_pk_bf16_f32 v146, v132, v133
    v_cvt_pk_bf16_f32 v147, v134, v135
    v_exp_f32 v136, v136
    v_exp_f32 v137, v137
    v_exp_f32 v138, v138
    v_exp_f32 v139, v139
    v_mfma_f32_32x32x16_bf16 v[96:111], v[220:223], v[144:147], v[96:111]
    v_cvt_pk_bf16_f32 v148, v136, v137
    v_cvt_pk_bf16_f32 v149, v138, v139
    v_exp_f32 v140, v140
    v_exp_f32 v141, v141
    v_exp_f32 v142, v142
    v_exp_f32 v143, v143
    v_cvt_pk_bf16_f32 v150, v140, v141
    v_cvt_pk_bf16_f32 v151, v142, v143
    v_mfma_f32_32x32x16_bf16 v[128:143], v[180:183], v[24:27], 0
    v_exp_f32 v112, v112
    v_exp_f32 v113, v113
    v_exp_f32 v114, v114
    v_exp_f32 v115, v115
    v_mfma_f32_32x32x16_bf16 v[128:143], v[184:187], v[28:31], v[128:143]
    s_xor_b32 s23, s41, 147456
    v_cvt_pk_bf16_f32 v144, v112, v113
    v_cvt_pk_bf16_f32 v145, v114, v115
    v_exp_f32 v116, v116
    v_exp_f32 v117, v117
    v_exp_f32 v118, v118
    v_exp_f32 v119, v119
    v_mfma_f32_32x32x16_bf16 v[96:111], v[224:227], v[148:151], v[96:111]
    buffer_load_dwordx4 v[212:215], v1, s[8:11], s23 offen sc1
    buffer_load_dwordx4 v[216:219], v1, s[8:11], s23 offen offset:1024 sc1
    buffer_load_dwordx4 v[220:223], v1, s[8:11], s23 offen offset:2048 sc1
    buffer_load_dwordx4 v[224:227], v1, s[8:11], s23 offen offset:3072 sc1
    buffer_load_dwordx4 v1, s[8:11], s52 offen offset:3072 sc1 lds
    v_cvt_pk_bf16_f32 v146, v116, v117
    v_cvt_pk_bf16_f32 v147, v118, v119
    v_exp_f32 v120, v120
    v_exp_f32 v121, v121
    v_exp_f32 v122, v122
    v_exp_f32 v123, v123
    v_mfma_f32_32x32x16_bf16 v[48:63], v[188:191], v[144:147], v[48:63]
    v_cvt_pk_bf16_f32 v148, v120, v121
    v_cvt_pk_bf16_f32 v149, v122, v123
    v_exp_f32 v124, v124
    v_exp_f32 v125, v125
    v_exp_f32 v126, v126
    v_exp_f32 v127, v127
    v_cvt_pk_bf16_f32 v150, v124, v125
    v_cvt_pk_bf16_f32 v151, v126, v127
    v_mfma_f32_32x32x16_bf16 v[112:127], v[180:183], v[32:35], 0
    v_exp_f32 v128, v128
    v_exp_f32 v129, v129
    v_exp_f32 v130, v130
    v_exp_f32 v131, v131
    v_mfma_f32_32x32x16_bf16 v[112:127], v[184:187], v[36:39], v[112:127]
    v_cvt_pk_bf16_f32 v144, v128, v129
    v_cvt_pk_bf16_f32 v145, v130, v131
    v_exp_f32 v132, v132
    v_exp_f32 v133, v133
    v_exp_f32 v134, v134
    v_exp_f32 v135, v135
    v_mfma_f32_32x32x16_bf16 v[48:63], v[192:195], v[148:151], v[48:63]
    v_cvt_pk_bf16_f32 v146, v132, v133
    v_cvt_pk_bf16_f32 v147, v134, v135
    v_exp_f32 v136, v136
    v_exp_f32 v137, v137
    v_exp_f32 v138, v138
    v_exp_f32 v139, v139
    v_mfma_f32_32x32x16_bf16 v[64:79], v[188:191], v[144:147], v[64:79]
    v_cvt_pk_bf16_f32 v148, v136, v137
    v_cvt_pk_bf16_f32 v149, v138, v139
    v_exp_f32 v140, v140
    v_exp_f32 v141, v141
    v_exp_f32 v142, v142
    v_exp_f32 v143, v143
    v_cvt_pk_bf16_f32 v150, v140, v141
    v_cvt_pk_bf16_f32 v151, v142, v143
    v_mfma_f32_32x32x16_bf16 v[128:143], v[180:183], v[40:43], 0
    v_exp_f32 v112, v112
    v_exp_f32 v113, v113
    v_exp_f32 v114, v114
    v_exp_f32 v115, v115
    v_mfma_f32_32x32x16_bf16 v[128:143], v[184:187], v[44:47], v[128:143]
    v_cvt_pk_bf16_f32 v144, v112, v113
    v_cvt_pk_bf16_f32 v145, v114, v115
    v_exp_f32 v116, v116
    v_exp_f32 v117, v117
    v_exp_f32 v118, v118
    v_exp_f32 v119, v119
    v_mfma_f32_32x32x16_bf16 v[64:79], v[192:195], v[148:151], v[64:79]
    v_cvt_pk_bf16_f32 v146, v116, v117
    v_cvt_pk_bf16_f32 v147, v118, v119
    v_exp_f32 v120, v120
    v_exp_f32 v121, v121
    v_exp_f32 v122, v122
    v_exp_f32 v123, v123
    v_mfma_f32_32x32x16_bf16 v[80:95], v[188:191], v[144:147], v[80:95]
    v_cvt_pk_bf16_f32 v148, v120, v121
    v_cvt_pk_bf16_f32 v149, v122, v123
    v_exp_f32 v124, v124
    v_exp_f32 v125, v125
    v_exp_f32 v126, v126
    v_exp_f32 v127, v127
    v_cvt_pk_bf16_f32 v150, v124, v125
    v_cvt_pk_bf16_f32 v151, v126, v127
    s_waitcnt vmcnt(12)
    v_mfma_f32_32x32x16_bf16 v[112:127], v[152:155], v[16:19], 0
    v_exp_f32 v128, v128
    v_exp_f32 v129, v129
    v_exp_f32 v130, v130
    v_exp_f32 v131, v131
    v_mfma_f32_32x32x16_bf16 v[112:127], v[156:159], v[20:23], v[112:127]
    v_cvt_pk_bf16_f32 v144, v128, v129
    v_cvt_pk_bf16_f32 v145, v130, v131
    v_exp_f32 v132, v132
    v_exp_f32 v133, v133
    v_exp_f32 v134, v134
    v_exp_f32 v135, v135
    v_mfma_f32_32x32x16_bf16 v[80:95], v[192:195], v[148:151], v[80:95]
    v_cvt_pk_bf16_f32 v146, v132, v133
    v_cvt_pk_bf16_f32 v147, v134, v135
    v_exp_f32 v136, v136
    v_exp_f32 v137, v137
    v_exp_f32 v138, v138
    v_exp_f32 v139, v139
    v_mfma_f32_32x32x16_bf16 v[96:111], v[188:191], v[144:147], v[96:111]
    v_cvt_pk_bf16_f32 v148, v136, v137
    v_cvt_pk_bf16_f32 v149, v138, v139
    v_exp_f32 v140, v140
    v_exp_f32 v141, v141
    v_exp_f32 v142, v142
    v_exp_f32 v143, v143
    v_cvt_pk_bf16_f32 v150, v140, v141
    v_cvt_pk_bf16_f32 v151, v142, v143
    v_mfma_f32_32x32x16_bf16 v[128:143], v[152:155], v[24:27], 0
    v_exp_f32 v112, v112
    v_exp_f32 v113, v113
    v_exp_f32 v114, v114
    v_exp_f32 v115, v115
    v_mfma_f32_32x32x16_bf16 v[128:143], v[156:159], v[28:31], v[128:143]
    s_xor_b32 s23, s41, 131072
    v_cvt_pk_bf16_f32 v144, v112, v113
    v_cvt_pk_bf16_f32 v145, v114, v115
    v_exp_f32 v116, v116
    v_exp_f32 v117, v117
    v_exp_f32 v118, v118
    v_exp_f32 v119, v119
    v_mfma_f32_32x32x16_bf16 v[96:111], v[192:195], v[148:151], v[96:111]
    buffer_load_dwordx4 v[180:183], v1, s[8:11], s23 offen sc1
    buffer_load_dwordx4 v[184:187], v1, s[8:11], s23 offen offset:1024 sc1
    buffer_load_dwordx4 v[188:191], v1, s[8:11], s23 offen offset:2048 sc1
    buffer_load_dwordx4 v[192:195], v1, s[8:11], s23 offen offset:3072 sc1
    s_add_u32 s52, s50, 4096
    s_add_u32 m0, s51, 4096
    s_nop 0
    buffer_load_dwordx4 v1, s[8:11], s52 offen sc1 lds
    v_cvt_pk_bf16_f32 v146, v116, v117
    v_cvt_pk_bf16_f32 v147, v118, v119
    v_exp_f32 v120, v120
    v_exp_f32 v121, v121
    v_exp_f32 v122, v122
    v_exp_f32 v123, v123
    v_mfma_f32_32x32x16_bf16 v[48:63], v[160:163], v[144:147], v[48:63]
    v_cvt_pk_bf16_f32 v148, v120, v121
    v_cvt_pk_bf16_f32 v149, v122, v123
    v_exp_f32 v124, v124
    v_exp_f32 v125, v125
    v_exp_f32 v126, v126
    v_exp_f32 v127, v127
    v_cvt_pk_bf16_f32 v150, v124, v125
    v_cvt_pk_bf16_f32 v151, v126, v127
    v_mfma_f32_32x32x16_bf16 v[112:127], v[152:155], v[32:35], 0
    v_exp_f32 v128, v128
    v_exp_f32 v129, v129
    v_exp_f32 v130, v130
    v_exp_f32 v131, v131
    v_mfma_f32_32x32x16_bf16 v[112:127], v[156:159], v[36:39], v[112:127]
    v_cvt_pk_bf16_f32 v144, v128, v129
    v_cvt_pk_bf16_f32 v145, v130, v131
    v_exp_f32 v132, v132
    v_exp_f32 v133, v133
    v_exp_f32 v134, v134
    v_exp_f32 v135, v135
    v_mfma_f32_32x32x16_bf16 v[48:63], v[164:167], v[148:151], v[48:63]
    v_cvt_pk_bf16_f32 v146, v132, v133
    v_cvt_pk_bf16_f32 v147, v134, v135
    v_exp_f32 v136, v136
    v_exp_f32 v137, v137
    v_exp_f32 v138, v138
    v_exp_f32 v139, v139
    v_mfma_f32_32x32x16_bf16 v[64:79], v[160:163], v[144:147], v[64:79]
    v_cvt_pk_bf16_f32 v148, v136, v137
    v_cvt_pk_bf16_f32 v149, v138, v139
    v_exp_f32 v140, v140
    v_exp_f32 v141, v141
    v_exp_f32 v142, v142
    v_exp_f32 v143, v143
    v_cvt_pk_bf16_f32 v150, v140, v141
    v_cvt_pk_bf16_f32 v151, v142, v143
    v_mfma_f32_32x32x16_bf16 v[128:143], v[152:155], v[40:43], 0
    v_exp_f32 v112, v112
    v_exp_f32 v113, v113
    v_exp_f32 v114, v114
    v_exp_f32 v115, v115
    v_mfma_f32_32x32x16_bf16 v[128:143], v[156:159], v[44:47], v[128:143]
    v_cvt_pk_bf16_f32 v144, v112, v113
    v_cvt_pk_bf16_f32 v145, v114, v115
    v_exp_f32 v116, v116
    v_exp_f32 v117, v117
    v_exp_f32 v118, v118
    v_exp_f32 v119, v119
    v_mfma_f32_32x32x16_bf16 v[64:79], v[164:167], v[148:151], v[64:79]
    v_cvt_pk_bf16_f32 v146, v116, v117
    v_cvt_pk_bf16_f32 v147, v118, v119
    v_exp_f32 v120, v120
    v_exp_f32 v121, v121
    v_exp_f32 v122, v122
    v_exp_f32 v123, v123
    v_mfma_f32_32x32x16_bf16 v[80:95], v[160:163], v[144:147], v[80:95]
    v_cvt_pk_bf16_f32 v148, v120, v121
    v_cvt_pk_bf16_f32 v149, v122, v123
    v_exp_f32 v124, v124
    v_exp_f32 v125, v125
    v_exp_f32 v126, v126
    v_exp_f32 v127, v127
    v_cvt_pk_bf16_f32 v150, v124, v125
    v_cvt_pk_bf16_f32 v151, v126, v127
    s_waitcnt vmcnt(12)
    v_mfma_f32_32x32x16_bf16 v[112:127], v[196:199], v[16:19], 0
    v_exp_f32 v128, v128
    v_exp_f32 v129, v129
    v_exp_f32 v130, v130
    v_exp_f32 v131, v131
    v_mfma_f32_32x32x16_bf16 v[112:127], v[200:203], v[20:23], v[112:127]
    s_waitcnt vmcnt(10)
    v_cmp_ne_u32 vcc, v8, v173
    s_nop 0
    s_and_b32 s7, vcc_lo, 254
    s_cbranch_scc1 KSLOW1_9
KBACK1_9:
    v_cvt_pk_bf16_f32 v144, v128, v129
    v_cvt_pk_bf16_f32 v145, v130, v131
    v_exp_f32 v132, v132
    v_exp_f32 v133, v133
    v_exp_f32 v134, v134
    v_exp_f32 v135, v135
    v_mfma_f32_32x32x16_bf16 v[80:95], v[164:167], v[148:151], v[80:95]
    v_cvt_pk_bf16_f32 v146, v132, v133
    v_cvt_pk_bf16_f32 v147, v134, v135
    v_exp_f32 v136, v136
    v_exp_f32 v137, v137
    v_exp_f32 v138, v138
    v_exp_f32 v139, v139
    v_mfma_f32_32x32x16_bf16 v[96:111], v[160:163], v[144:147], v[96:111]
    v_cvt_pk_bf16_f32 v148, v136, v137
    v_cvt_pk_bf16_f32 v149, v138, v139
    v_exp_f32 v140, v140
    v_exp_f32 v141, v141
    v_exp_f32 v142, v142
    v_exp_f32 v143, v143
    v_cvt_pk_bf16_f32 v150, v140, v141
    v_cvt_pk_bf16_f32 v151, v142, v143
    v_mfma_f32_32x32x16_bf16 v[128:143], v[196:199], v[24:27], 0
    v_exp_f32 v112, v112
    v_exp_f32 v113, v113
    v_exp_f32 v114, v114
    v_exp_f32 v115, v115
    v_mfma_f32_32x32x16_bf16 v[128:143], v[200:203], v[28:31], v[128:143]
    s_xor_b32 s23, s41, 114688
    v_cvt_pk_bf16_f32 v144, v112, v113
    v_cvt_pk_bf16_f32 v145, v114, v115
    v_exp_f32 v116, v116
    v_exp_f32 v117, v117
    v_exp_f32 v118, v118
    v_exp_f32 v119, v119
    v_mfma_f32_32x32x16_bf16 v[96:111], v[164:167], v[148:151], v[96:111]
    buffer_load_dwordx4 v[152:155], v1, s[8:11], s23 offen sc1
    buffer_load_dwordx4 v[156:159], v1, s[8:11], s23 offen offset:1024 sc1
    buffer_load_dwordx4 v[160:163], v1, s[8:11], s23 offen offset:2048 sc1
    buffer_load_dwordx4 v[164:167], v1, s[8:11], s23 offen offset:3072 sc1
    buffer_load_dwordx4 v1, s[8:11], s52 offen offset:1024 sc1 lds
    v_cvt_pk_bf16_f32 v146, v116, v117
    v_cvt_pk_bf16_f32 v147, v118, v119
    v_exp_f32 v120, v120
    v_exp_f32 v121, v121
    v_exp_f32 v122, v122
    v_exp_f32 v123, v123
    v_mfma_f32_32x32x16_bf16 v[48:63], v[204:207], v[144:147], v[48:63]
    v_cvt_pk_bf16_f32 v148, v120, v121
    v_cvt_pk_bf16_f32 v149, v122, v123
    v_exp_f32 v124, v124
    v_exp_f32 v125, v125
    v_exp_f32 v126, v126
    v_exp_f32 v127, v127
    v_cvt_pk_bf16_f32 v150, v124, v125
    v_cvt_pk_bf16_f32 v151, v126, v127
    v_mfma_f32_32x32x16_bf16 v[112:127], v[196:199], v[32:35], 0
    v_exp_f32 v128, v128
    v_exp_f32 v129, v129
    v_exp_f32 v130, v130
    v_exp_f32 v131, v131
    v_mfma_f32_32x32x16_bf16 v[112:127], v[200:203], v[36:39], v[112:127]
    v_cvt_pk_bf16_f32 v144, v128, v129
    v_cvt_pk_bf16_f32 v145, v130, v131
    v_exp_f32 v132, v132
    v_exp_f32 v133, v133
    v_exp_f32 v134, v134
    v_exp_f32 v135, v135
    v_mfma_f32_32x32x16_bf16 v[48:63], v[208:211], v[148:151], v[48:63]
    v_cvt_pk_bf16_f32 v146, v132, v133
    v_cvt_pk_bf16_f32 v147, v134, v135
    v_exp_f32 v136, v136
    v_exp_f32 v137, v137
    v_exp_f32 v138, v138
    v_exp_f32 v139, v139
    v_mfma_f32_32x32x16_bf16 v[64:79], v[204:207], v[144:147], v[64:79]
    v_cvt_pk_bf16_f32 v148, v136, v137
    v_cvt_pk_bf16_f32 v149, v138, v139
    v_exp_f32 v140, v140
    v_exp_f32 v141, v141
    v_exp_f32 v142, v142
    v_exp_f32 v143, v143
    v_cvt_pk_bf16_f32 v150, v140, v141
    v_cvt_pk_bf16_f32 v151, v142, v143
    v_mfma_f32_32x32x16_bf16 v[128:143], v[196:199], v[40:43], 0
    v_exp_f32 v112, v112
    v_exp_f32 v113, v113
    v_exp_f32 v114, v114
    v_exp_f32 v115, v115
    v_mfma_f32_32x32x16_bf16 v[128:143], v[200:203], v[44:47], v[128:143]
    v_cvt_pk_bf16_f32 v144, v112, v113
    v_cvt_pk_bf16_f32 v145, v114, v115
    v_exp_f32 v116, v116
    v_exp_f32 v117, v117
    v_exp_f32 v118, v118
    v_exp_f32 v119, v119
    v_mfma_f32_32x32x16_bf16 v[64:79], v[208:211], v[148:151], v[64:79]
    v_cvt_pk_bf16_f32 v146, v116, v117
    v_cvt_pk_bf16_f32 v147, v118, v119
    v_exp_f32 v120, v120
    v_exp_f32 v121, v121
    v_exp_f32 v122, v122
    v_exp_f32 v123, v123
    v_mfma_f32_32x32x16_bf16 v[80:95], v[204:207], v[144:147], v[80:95]
    v_cvt_pk_bf16_f32 v148, v120, v121
    v_cvt_pk_bf16_f32 v149, v122, v123
    v_exp_f32 v124, v124
    v_exp_f32 v125, v125
    v_exp_f32 v126, v126
    v_exp_f32 v127, v127
    v_cvt_pk_bf16_f32 v150, v124, v125
    v_cvt_pk_bf16_f32 v151, v126, v127
    s_waitcnt vmcnt(11)
    v_mfma_f32_32x32x16_bf16 v[112:127], v[212:215], v[16:19], 0
    v_exp_f32 v128, v128
    v_exp_f32 v129, v129
    v_exp_f32 v130, v130
    v_exp_f32 v131, v131
    v_mfma_f32_32x32x16_bf16 v[112:127], v[216:219], v[20:23], v[112:127]
    v_cvt_pk_bf16_f32 v144, v128, v129
    v_cvt_pk_bf16_f32 v145, v130, v131
    v_exp_f32 v132, v132
    v_exp_f32 v133, v133
    v_exp_f32 v134, v134
    v_exp_f32 v135, v135
    v_mfma_f32_32x32x16_bf16 v[80:95], v[208:211], v[148:151], v[80:95]
    v_cvt_pk_bf16_f32 v146, v132, v133
    v_cvt_pk_bf16_f32 v147, v134, v135
    v_exp_f32 v136, v136
    v_exp_f32 v137, v137
    v_exp_f32 v138, v138
    v_exp_f32 v139, v139
    v_mfma_f32_32x32x16_bf16 v[96:111], v[204:207], v[144:147], v[96:111]
    v_cvt_pk_bf16_f32 v148, v136, v137
    v_cvt_pk_bf16_f32 v149, v138, v139
    v_exp_f32 v140, v140
    v_exp_f32 v141, v141
    v_exp_f32 v142, v142
    v_exp_f32 v143, v143
    v_cvt_pk_bf16_f32 v150, v140, v141
    v_cvt_pk_bf16_f32 v151, v142, v143
    v_mfma_f32_32x32x16_bf16 v[128:143], v[212:215], v[24:27], 0
    v_exp_f32 v112, v112
    v_exp_f32 v113, v113
    v_exp_f32 v114, v114
    v_exp_f32 v115, v115
    v_mfma_f32_32x32x16_bf16 v[128:143], v[216:219], v[28:31], v[128:143]
    s_xor_b32 s23, s41, 98304
    v_cvt_pk_bf16_f32 v144, v112, v113
    v_cvt_pk_bf16_f32 v145, v114, v115
    v_exp_f32 v116, v116
    v_exp_f32 v117, v117
    v_exp_f32 v118, v118
    v_exp_f32 v119, v119
    v_mfma_f32_32x32x16_bf16 v[96:111], v[208:211], v[148:151], v[96:111]
    buffer_load_dwordx4 v[196:199], v1, s[8:11], s23 offen sc1
    buffer_load_dwordx4 v[200:203], v1, s[8:11], s23 offen offset:1024 sc1
    buffer_load_dwordx4 v[204:207], v1, s[8:11], s23 offen offset:2048 sc1
    buffer_load_dwordx4 v[208:211], v1, s[8:11], s23 offen offset:3072 sc1
    buffer_load_dwordx4 v1, s[8:11], s52 offen offset:2048 sc1 lds
    v_cvt_pk_bf16_f32 v146, v116, v117
    v_cvt_pk_bf16_f32 v147, v118, v119
    v_exp_f32 v120, v120
    v_exp_f32 v121, v121
    v_exp_f32 v122, v122
    v_exp_f32 v123, v123
    v_mfma_f32_32x32x16_bf16 v[48:63], v[220:223], v[144:147], v[48:63]
    v_cvt_pk_bf16_f32 v148, v120, v121
    v_cvt_pk_bf16_f32 v149, v122, v123
    v_exp_f32 v124, v124
    v_exp_f32 v125, v125
    v_exp_f32 v126, v126
    v_exp_f32 v127, v127
    v_cvt_pk_bf16_f32 v150, v124, v125
    v_cvt_pk_bf16_f32 v151, v126, v127
    v_mfma_f32_32x32x16_bf16 v[112:127], v[212:215], v[32:35], 0
    v_exp_f32 v128, v128
    v_exp_f32 v129, v129
    v_exp_f32 v130, v130
    v_exp_f32 v131, v131
    v_mfma_f32_32x32x16_bf16 v[112:127], v[216:219], v[36:39], v[112:127]
    v_cvt_pk_bf16_f32 v144, v128, v129
    v_cvt_pk_bf16_f32 v145, v130, v131
    v_exp_f32 v132, v132
    v_exp_f32 v133, v133
    v_exp_f32 v134, v134
    v_exp_f32 v135, v135
    v_mfma_f32_32x32x16_bf16 v[48:63], v[224:227], v[148:151], v[48:63]
    v_cvt_pk_bf16_f32 v146, v132, v133
    v_cvt_pk_bf16_f32 v147, v134, v135
    v_exp_f32 v136, v136
    v_exp_f32 v137, v137
    v_exp_f32 v138, v138
    v_exp_f32 v139, v139
    v_mfma_f32_32x32x16_bf16 v[64:79], v[220:223], v[144:147], v[64:79]
    v_cvt_pk_bf16_f32 v148, v136, v137
    v_cvt_pk_bf16_f32 v149, v138, v139
    v_exp_f32 v140, v140
    v_exp_f32 v141, v141
    v_exp_f32 v142, v142
    v_exp_f32 v143, v143
    v_cvt_pk_bf16_f32 v150, v140, v141
    v_cvt_pk_bf16_f32 v151, v142, v143
    v_mfma_f32_32x32x16_bf16 v[128:143], v[212:215], v[40:43], 0
    v_exp_f32 v112, v112
    v_exp_f32 v113, v113
    v_exp_f32 v114, v114
    v_exp_f32 v115, v115
    v_mfma_f32_32x32x16_bf16 v[128:143], v[216:219], v[44:47], v[128:143]
    v_cvt_pk_bf16_f32 v144, v112, v113
    v_cvt_pk_bf16_f32 v145, v114, v115
    v_exp_f32 v116, v116
    v_exp_f32 v117, v117
    v_exp_f32 v118, v118
    v_exp_f32 v119, v119
    v_mfma_f32_32x32x16_bf16 v[64:79], v[224:227], v[148:151], v[64:79]
    v_cvt_pk_bf16_f32 v146, v116, v117
    v_cvt_pk_bf16_f32 v147, v118, v119
    v_exp_f32 v120, v120
    v_exp_f32 v121, v121
    v_exp_f32 v122, v122
    v_exp_f32 v123, v123
    v_mfma_f32_32x32x16_bf16 v[80:95], v[220:223], v[144:147], v[80:95]
    v_cvt_pk_bf16_f32 v148, v120, v121
    v_cvt_pk_bf16_f32 v149, v122, v123
    v_exp_f32 v124, v124
    v_exp_f32 v125, v125
    v_exp_f32 v126, v126
    v_exp_f32 v127, v127
    v_cvt_pk_bf16_f32 v150, v124, v125
    v_cvt_pk_bf16_f32 v151, v126, v127
    s_waitcnt vmcnt(11)
    v_mfma_f32_32x32x16_bf16 v[112:127], v[180:183], v[16:19], 0
    v_exp_f32 v128, v128
    v_exp_f32 v129, v129
    v_exp_f32 v130, v130
    v_exp_f32 v131, v131
    v_mfma_f32_32x32x16_bf16 v[112:127], v[184:187], v[20:23], v[112:127]
    v_cvt_pk_bf16_f32 v144, v128, v129
    v_cvt_pk_bf16_f32 v145, v130, v131
    v_exp_f32 v132, v132
    v_exp_f32 v133, v133
    v_exp_f32 v134, v134
    v_exp_f32 v135, v135
    v_mfma_f32_32x32x16_bf16 v[80:95], v[224:227], v[148:151], v[80:95]
    v_cvt_pk_bf16_f32 v146, v132, v133
    v_cvt_pk_bf16_f32 v147, v134, v135
    v_exp_f32 v136, v136
    v_exp_f32 v137, v137
    v_exp_f32 v138, v138
    v_exp_f32 v139, v139
    v_mfma_f32_32x32x16_bf16 v[96:111], v[220:223], v[144:147], v[96:111]
    v_cvt_pk_bf16_f32 v148, v136, v137
    v_cvt_pk_bf16_f32 v149, v138, v139
    v_exp_f32 v140, v140
    v_exp_f32 v141, v141
    v_exp_f32 v142, v142
    v_exp_f32 v143, v143
    v_cvt_pk_bf16_f32 v150, v140, v141
    v_cvt_pk_bf16_f32 v151, v142, v143
    v_mfma_f32_32x32x16_bf16 v[128:143], v[180:183], v[24:27], 0
    v_exp_f32 v112, v112
    v_exp_f32 v113, v113
    v_exp_f32 v114, v114
    v_exp_f32 v115, v115
    v_mfma_f32_32x32x16_bf16 v[128:143], v[184:187], v[28:31], v[128:143]
    s_xor_b32 s23, s41, 81920
    v_cvt_pk_bf16_f32 v144, v112, v113
    v_cvt_pk_bf16_f32 v145, v114, v115
    v_exp_f32 v116, v116
    v_exp_f32 v117, v117
    v_exp_f32 v118, v118
    v_exp_f32 v119, v119
    v_mfma_f32_32x32x16_bf16 v[96:111], v[224:227], v[148:151], v[96:111]
    buffer_load_dwordx4 v[212:215], v1, s[8:11], s23 offen sc1
    buffer_load_dwordx4 v[216:219], v1, s[8:11], s23 offen offset:1024 sc1
    buffer_load_dwordx4 v[220:223], v1, s[8:11], s23 offen offset:2048 sc1
    buffer_load_dwordx4 v[224:227], v1, s[8:11], s23 offen offset:3072 sc1
    buffer_load_dwordx4 v1, s[8:11], s52 offen offset:3072 sc1 lds
    v_cvt_pk_bf16_f32 v146, v116, v117
    v_cvt_pk_bf16_f32 v147, v118, v119
    v_exp_f32 v120, v120
    v_exp_f32 v121, v121
    v_exp_f32 v122, v122
    v_exp_f32 v123, v123
    v_mfma_f32_32x32x16_bf16 v[48:63], v[188:191], v[144:147], v[48:63]
    v_cvt_pk_bf16_f32 v148, v120, v121
    v_cvt_pk_bf16_f32 v149, v122, v123
    v_exp_f32 v124, v124
    v_exp_f32 v125, v125
    v_exp_f32 v126, v126
    v_exp_f32 v127, v127
    v_cvt_pk_bf16_f32 v150, v124, v125
    v_cvt_pk_bf16_f32 v151, v126, v127
    v_mfma_f32_32x32x16_bf16 v[112:127], v[180:183], v[32:35], 0
    v_exp_f32 v128, v128
    v_exp_f32 v129, v129
    v_exp_f32 v130, v130
    v_exp_f32 v131, v131
    v_mfma_f32_32x32x16_bf16 v[112:127], v[184:187], v[36:39], v[112:127]
    v_cvt_pk_bf16_f32 v144, v128, v129
    v_cvt_pk_bf16_f32 v145, v130, v131
    v_exp_f32 v132, v132
    v_exp_f32 v133, v133
    v_exp_f32 v134, v134
    v_exp_f32 v135, v135
    v_mfma_f32_32x32x16_bf16 v[48:63], v[192:195], v[148:151], v[48:63]
    v_cvt_pk_bf16_f32 v146, v132, v133
    v_cvt_pk_bf16_f32 v147, v134, v135
    v_exp_f32 v136, v136
    v_exp_f32 v137, v137
    v_exp_f32 v138, v138
    v_exp_f32 v139, v139
    v_mfma_f32_32x32x16_bf16 v[64:79], v[188:191], v[144:147], v[64:79]
    v_cvt_pk_bf16_f32 v148, v136, v137
    v_cvt_pk_bf16_f32 v149, v138, v139
    v_exp_f32 v140, v140
    v_exp_f32 v141, v141
    v_exp_f32 v142, v142
    v_exp_f32 v143, v143
    v_cvt_pk_bf16_f32 v150, v140, v141
    v_cvt_pk_bf16_f32 v151, v142, v143
    v_mfma_f32_32x32x16_bf16 v[128:143], v[180:183], v[40:43], 0
    v_exp_f32 v112, v112
    v_exp_f32 v113, v113
    v_exp_f32 v114, v114
    v_exp_f32 v115, v115
    v_mfma_f32_32x32x16_bf16 v[128:143], v[184:187], v[44:47], v[128:143]
    v_cvt_pk_bf16_f32 v144, v112, v113
    v_cvt_pk_bf16_f32 v145, v114, v115
    v_exp_f32 v116, v116
    v_exp_f32 v117, v117
    v_exp_f32 v118, v118
    v_exp_f32 v119, v119
    v_mfma_f32_32x32x16_bf16 v[64:79], v[192:195], v[148:151], v[64:79]
    v_cvt_pk_bf16_f32 v146, v116, v117
    v_cvt_pk_bf16_f32 v147, v118, v119
    v_exp_f32 v120, v120
    v_exp_f32 v121, v121
    v_exp_f32 v122, v122
    v_exp_f32 v123, v123
    v_mfma_f32_32x32x16_bf16 v[80:95], v[188:191], v[144:147], v[80:95]
    v_cvt_pk_bf16_f32 v148, v120, v121
    v_cvt_pk_bf16_f32 v149, v122, v123
    v_exp_f32 v124, v124
    v_exp_f32 v125, v125
    v_exp_f32 v126, v126
    v_exp_f32 v127, v127
    v_cvt_pk_bf16_f32 v150, v124, v125
    v_cvt_pk_bf16_f32 v151, v126, v127
    s_waitcnt vmcnt(11)
    v_mfma_f32_32x32x16_bf16 v[112:127], v[152:155], v[16:19], 0
    v_exp_f32 v128, v128
    v_exp_f32 v129, v129
    v_exp_f32 v130, v130
    v_exp_f32 v131, v131
    v_mfma_f32_32x32x16_bf16 v[112:127], v[156:159], v[20:23], v[112:127]
    v_cvt_pk_bf16_f32 v144, v128, v129
    v_cvt_pk_bf16_f32 v145, v130, v131
    v_exp_f32 v132, v132
    v_exp_f32 v133, v133
    v_exp_f32 v134, v134
    v_exp_f32 v135, v135
    v_mfma_f32_32x32x16_bf16 v[80:95], v[192:195], v[148:151], v[80:95]
    v_cvt_pk_bf16_f32 v146, v132, v133
    v_cvt_pk_bf16_f32 v147, v134, v135
    v_exp_f32 v136, v136
    v_exp_f32 v137, v137
    v_exp_f32 v138, v138
    v_exp_f32 v139, v139
    v_mfma_f32_32x32x16_bf16 v[96:111], v[188:191], v[144:147], v[96:111]
    v_cvt_pk_bf16_f32 v148, v136, v137
    v_cvt_pk_bf16_f32 v149, v138, v139
    v_exp_f32 v140, v140
    v_exp_f32 v141, v141
    v_exp_f32 v142, v142
    v_exp_f32 v143, v143
    v_cvt_pk_bf16_f32 v150, v140, v141
    v_cvt_pk_bf16_f32 v151, v142, v143
    v_mfma_f32_32x32x16_bf16 v[128:143], v[152:155], v[24:27], 0
    v_exp_f32 v112, v112
    v_exp_f32 v113, v113
    v_exp_f32 v114, v114
    v_exp_f32 v115, v115
    v_mfma_f32_32x32x16_bf16 v[128:143], v[156:159], v[28:31], v[128:143]
    s_xor_b32 s23, s41, 65536
    v_cvt_pk_bf16_f32 v144, v112, v113
    v_cvt_pk_bf16_f32 v145, v114, v115
    v_exp_f32 v116, v116
    v_exp_f32 v117, v117
    v_exp_f32 v118, v118
    v_exp_f32 v119, v119
    v_mfma_f32_32x32x16_bf16 v[96:111], v[192:195], v[148:151], v[96:111]
    buffer_load_dwordx4 v[180:183], v1, s[8:11], s23 offen sc1
    buffer_load_dwordx4 v[184:187], v1, s[8:11], s23 offen offset:1024 sc1
    buffer_load_dwordx4 v[188:191], v1, s[8:11], s23 offen offset:2048 sc1
    buffer_load_dwordx4 v[192:195], v1, s[8:11], s23 offen offset:3072 sc1
    s_add_u32 s52, s50, 8192
    s_add_u32 m0, s51, 8192
    s_nop 0
    buffer_load_dwordx4 v1, s[8:11], s52 offen sc1 lds
    v_cvt_pk_bf16_f32 v146, v116, v117
    v_cvt_pk_bf16_f32 v147, v118, v119
    v_exp_f32 v120, v120
    v_exp_f32 v121, v121
    v_exp_f32 v122, v122
    v_exp_f32 v123, v123
    v_mfma_f32_32x32x16_bf16 v[48:63], v[160:163], v[144:147], v[48:63]
    v_cvt_pk_bf16_f32 v148, v120, v121
    v_cvt_pk_bf16_f32 v149, v122, v123
    v_exp_f32 v124, v124
    v_exp_f32 v125, v125
    v_exp_f32 v126, v126
    v_exp_f32 v127, v127
    v_cvt_pk_bf16_f32 v150, v124, v125
    v_cvt_pk_bf16_f32 v151, v126, v127
    v_mfma_f32_32x32x16_bf16 v[112:127], v[152:155], v[32:35], 0
    v_exp_f32 v128, v128
    v_exp_f32 v129, v129
    v_exp_f32 v130, v130
    v_exp_f32 v131, v131
    v_mfma_f32_32x32x16_bf16 v[112:127], v[156:159], v[36:39], v[112:127]
    s_add_u32 s53, s46, 12288
    buffer_load_dwordx4 v[228:231], v1, s[8:11], s53 offen offset:2048 sc1
    buffer_load_dwordx4 v[232:235], v1, s[8:11], s53 offen offset:3072 sc1
    v_cvt_pk_bf16_f32 v144, v128, v129
    v_cvt_pk_bf16_f32 v145, v130, v131
    v_exp_f32 v132, v132
    v_exp_f32 v133, v133
    v_exp_f32 v134, v134
    v_exp_f32 v135, v135
    v_mfma_f32_32x32x16_bf16 v[48:63], v[164:167], v[148:151], v[48:63]
    v_cvt_pk_bf16_f32 v146, v132, v133
    v_cvt_pk_bf16_f32 v147, v134, v135
    v_exp_f32 v136, v136
    v_exp_f32 v137, v137
    v_exp_f32 v138, v138
    v_exp_f32 v139, v139
    v_mfma_f32_32x32x16_bf16 v[64:79], v[160:163], v[144:147], v[64:79]
    v_cvt_pk_bf16_f32 v148, v136, v137
    v_cvt_pk_bf16_f32 v149, v138, v139
    v_exp_f32 v140, v140
    v_exp_f32 v141, v141
    v_exp_f32 v142, v142
    v_exp_f32 v143, v143
    v_cvt_pk_bf16_f32 v150, v140, v141
    v_cvt_pk_bf16_f32 v151, v142, v143
    v_mfma_f32_32x32x16_bf16 v[128:143], v[152:155], v[40:43], 0
    v_exp_f32 v112, v112
    v_exp_f32 v113, v113
    v_exp_f32 v114, v114
    v_exp_f32 v115, v115
    v_mfma_f32_32x32x16_bf16 v[128:143], v[156:159], v[44:47], v[128:143]
    v_cvt_pk_bf16_f32 v144, v112, v113
    v_cvt_pk_bf16_f32 v145, v114, v115
    v_exp_f32 v116, v116
    v_exp_f32 v117, v117
    v_exp_f32 v118, v118
    v_exp_f32 v119, v119
    v_mfma_f32_32x32x16_bf16 v[64:79], v[164:167], v[148:151], v[64:79]
    v_cvt_pk_bf16_f32 v146, v116, v117
    v_cvt_pk_bf16_f32 v147, v118, v119
    v_exp_f32 v120, v120
    v_exp_f32 v121, v121
    v_exp_f32 v122, v122
    v_exp_f32 v123, v123
    v_mfma_f32_32x32x16_bf16 v[80:95], v[160:163], v[144:147], v[80:95]
    v_cvt_pk_bf16_f32 v148, v120, v121
    v_cvt_pk_bf16_f32 v149, v122, v123
    v_exp_f32 v124, v124
    v_exp_f32 v125, v125
    v_exp_f32 v126, v126
    v_exp_f32 v127, v127
    v_cvt_pk_bf16_f32 v150, v124, v125
    v_cvt_pk_bf16_f32 v151, v126, v127
    s_waitcnt vmcnt(13)
    v_mfma_f32_32x32x16_bf16 v[112:127], v[196:199], v[16:19], 0
    v_exp_f32 v128, v128
    v_exp_f32 v129, v129
    v_exp_f32 v130, v130
    v_exp_f32 v131, v131
    v_mfma_f32_32x32x16_bf16 v[112:127], v[200:203], v[20:23], v[112:127]
    v_cvt_pk_bf16_f32 v144, v128, v129
    v_cvt_pk_bf16_f32 v145, v130, v131
    v_exp_f32 v132, v132
    v_exp_f32 v133, v133
    v_exp_f32 v134, v134
    v_exp_f32 v135, v135
    v_mfma_f32_32x32x16_bf16 v[80:95], v[164:167], v[148:151], v[80:95]
    v_cvt_pk_bf16_f32 v146, v132, v133
    v_cvt_pk_bf16_f32 v147, v134, v135
    v_exp_f32 v136, v136
    v_exp_f32 v137, v137
    v_exp_f32 v138, v138
    v_exp_f32 v139, v139
    v_mfma_f32_32x32x16_bf16 v[96:111], v[160:163], v[144:147], v[96:111]
    v_cvt_pk_bf16_f32 v148, v136, v137
    v_cvt_pk_bf16_f32 v149, v138, v139
    v_exp_f32 v140, v140
    v_exp_f32 v141, v141
    v_exp_f32 v142, v142
    v_exp_f32 v143, v143
    v_cvt_pk_bf16_f32 v150, v140, v141
    v_cvt_pk_bf16_f32 v151, v142, v143
    v_mfma_f32_32x32x16_bf16 v[128:143], v[196:199], v[24:27], 0
    v_exp_f32 v112, v112
    v_exp_f32 v113, v113
    v_exp_f32 v114, v114
    v_exp_f32 v115, v115
    v_mfma_f32_32x32x16_bf16 v[128:143], v[200:203], v[28:31], v[128:143]
    s_xor_b32 s23, s41, 49152
    v_cvt_pk_bf16_f32 v144, v112, v113
    v_cvt_pk_bf16_f32 v145, v114, v115
    v_exp_f32 v116, v116
    v_exp_f32 v117, v117
    v_exp_f32 v118, v118
    v_exp_f32 v119, v119
    v_mfma_f32_32x32x16_bf16 v[96:111], v[164:167], v[148:151], v[96:111]
    buffer_load_dwordx4 v[152:155], v1, s[8:11], s23 offen sc1
    buffer_load_dwordx4 v[156:159], v1, s[8:11], s23 offen offset:1024 sc1
    buffer_load_dwordx4 v[160:163], v1, s[8:11], s23 offen offset:2048 sc1
    buffer_load_dwordx4 v[164:167], v1, s[8:11], s23 offen offset:3072 sc1
    buffer_load_dwordx4 v1, s[8:11], s52 offen offset:1024 sc1 lds
    v_cvt_pk_bf16_f32 v146, v116, v117
    v_cvt_pk_bf16_f32 v147, v118, v119
    v_exp_f32 v120, v120
    v_exp_f32 v121, v121
    v_exp_f32 v122, v122
    v_exp_f32 v123, v123
    v_mfma_f32_32x32x16_bf16 v[48:63], v[204:207], v[144:147], v[48:63]
    v_cvt_pk_bf16_f32 v148, v120, v121
    v_cvt_pk_bf16_f32 v149, v122, v123
    v_exp_f32 v124, v124
    v_exp_f32 v125, v125
    v_exp_f32 v126, v126
    v_exp_f32 v127, v127
    v_cvt_pk_bf16_f32 v150, v124, v125
    v_cvt_pk_bf16_f32 v151, v126, v127
    v_mfma_f32_32x32x16_bf16 v[112:127], v[196:199], v[32:35], 0
    v_exp_f32 v128, v128
    v_exp_f32 v129, v129
    v_exp_f32 v130, v130
    v_exp_f32 v131, v131
    v_mfma_f32_32x32x16_bf16 v[112:127], v[200:203], v[36:39], v[112:127]
    v_cvt_pk_bf16_f32 v144, v128, v129
    v_cvt_pk_bf16_f32 v145, v130, v131
    v_exp_f32 v132, v132
    v_exp_f32 v133, v133
    v_exp_f32 v134, v134
    v_exp_f32 v135, v135
    v_mfma_f32_32x32x16_bf16 v[48:63], v[208:211], v[148:151], v[48:63]
    v_cvt_pk_bf16_f32 v146, v132, v133
    v_cvt_pk_bf16_f32 v147, v134, v135
    v_exp_f32 v136, v136
    v_exp_f32 v137, v137
    v_exp_f32 v138, v138
    v_exp_f32 v139, v139
    v_mfma_f32_32x32x16_bf16 v[64:79], v[204:207], v[144:147], v[64:79]
    v_cvt_pk_bf16_f32 v148, v136, v137
    v_cvt_pk_bf16_f32 v149, v138, v139
    v_exp_f32 v140, v140
    v_exp_f32 v141, v141
    v_exp_f32 v142, v142
    v_exp_f32 v143, v143
    v_cvt_pk_bf16_f32 v150, v140, v141
    v_cvt_pk_bf16_f32 v151, v142, v143
    v_mfma_f32_32x32x16_bf16 v[128:143], v[196:199], v[40:43], 0
    v_exp_f32 v112, v112
    v_exp_f32 v113, v113
    v_exp_f32 v114, v114
    v_exp_f32 v115, v115
    v_mfma_f32_32x32x16_bf16 v[128:143], v[200:203], v[44:47], v[128:143]
    v_cvt_pk_bf16_f32 v144, v112, v113
    v_cvt_pk_bf16_f32 v145, v114, v115
    v_exp_f32 v116, v116
    v_exp_f32 v117, v117
    v_exp_f32 v118, v118
    v_exp_f32 v119, v119
    v_mfma_f32_32x32x16_bf16 v[64:79], v[208:211], v[148:151], v[64:79]
    v_cvt_pk_bf16_f32 v146, v116, v117
    v_cvt_pk_bf16_f32 v147, v118, v119
    v_exp_f32 v120, v120
    v_exp_f32 v121, v121
    v_exp_f32 v122, v122
    v_exp_f32 v123, v123
    v_mfma_f32_32x32x16_bf16 v[80:95], v[204:207], v[144:147], v[80:95]
    v_cvt_pk_bf16_f32 v148, v120, v121
    v_cvt_pk_bf16_f32 v149, v122, v123
    v_exp_f32 v124, v124
    v_exp_f32 v125, v125
    v_exp_f32 v126, v126
    v_exp_f32 v127, v127
    v_cvt_pk_bf16_f32 v150, v124, v125
    v_cvt_pk_bf16_f32 v151, v126, v127
    s_waitcnt vmcnt(13)
    v_mfma_f32_32x32x16_bf16 v[112:127], v[212:215], v[16:19], 0
    v_exp_f32 v128, v128
    v_exp_f32 v129, v129
    v_exp_f32 v130, v130
    v_exp_f32 v131, v131
    v_mfma_f32_32x32x16_bf16 v[112:127], v[216:219], v[20:23], v[112:127]
    v_cvt_pk_bf16_f32 v144, v128, v129
    v_cvt_pk_bf16_f32 v145, v130, v131
    v_exp_f32 v132, v132
    v_exp_f32 v133, v133
    v_exp_f32 v134, v134
    v_exp_f32 v135, v135
    v_mfma_f32_32x32x16_bf16 v[80:95], v[208:211], v[148:151], v[80:95]
    v_cvt_pk_bf16_f32 v146, v132, v133
    v_cvt_pk_bf16_f32 v147, v134, v135
    v_exp_f32 v136, v136
    v_exp_f32 v137, v137
    v_exp_f32 v138, v138
    v_exp_f32 v139, v139
    v_mfma_f32_32x32x16_bf16 v[96:111], v[204:207], v[144:147], v[96:111]
    v_cvt_pk_bf16_f32 v148, v136, v137
    v_cvt_pk_bf16_f32 v149, v138, v139
    v_exp_f32 v140, v140
    v_exp_f32 v141, v141
    v_exp_f32 v142, v142
    v_exp_f32 v143, v143
    v_cvt_pk_bf16_f32 v150, v140, v141
    v_cvt_pk_bf16_f32 v151, v142, v143
    v_mfma_f32_32x32x16_bf16 v[128:143], v[212:215], v[24:27], 0
    v_exp_f32 v112, v112
    v_exp_f32 v113, v113
    v_exp_f32 v114, v114
    v_exp_f32 v115, v115
    v_mfma_f32_32x32x16_bf16 v[128:143], v[216:219], v[28:31], v[128:143]
    s_xor_b32 s23, s41, 32768
    v_cvt_pk_bf16_f32 v144, v112, v113
    v_cvt_pk_bf16_f32 v145, v114, v115
    v_exp_f32 v116, v116
    v_exp_f32 v117, v117
    v_exp_f32 v118, v118
    v_exp_f32 v119, v119
    v_mfma_f32_32x32x16_bf16 v[96:111], v[208:211], v[148:151], v[96:111]
    buffer_load_dwordx4 v[196:199], v1, s[8:11], s23 offen sc1
    buffer_load_dwordx4 v[200:203], v1, s[8:11], s23 offen offset:1024 sc1
    buffer_load_dwordx4 v[204:207], v1, s[8:11], s23 offen offset:2048 sc1
    buffer_load_dwordx4 v[208:211], v1, s[8:11], s23 offen offset:3072 sc1
    buffer_load_dwordx4 v1, s[8:11], s52 offen offset:2048 sc1 lds
    v_cvt_pk_bf16_f32 v146, v116, v117
    v_cvt_pk_bf16_f32 v147, v118, v119
    v_exp_f32 v120, v120
    v_exp_f32 v121, v121
    v_exp_f32 v122, v122
    v_exp_f32 v123, v123
    v_mfma_f32_32x32x16_bf16 v[48:63], v[220:223], v[144:147], v[48:63]
    v_cvt_pk_bf16_f32 v148, v120, v121
    v_cvt_pk_bf16_f32 v149, v122, v123
    v_exp_f32 v124, v124
    v_exp_f32 v125, v125
    v_exp_f32 v126, v126
    v_exp_f32 v127, v127
    v_cvt_pk_bf16_f32 v150, v124, v125
    v_cvt_pk_bf16_f32 v151, v126, v127
    v_mfma_f32_32x32x16_bf16 v[112:127], v[212:215], v[32:35], 0
    v_exp_f32 v128, v128
    v_exp_f32 v129, v129
    v_exp_f32 v130, v130
    v_exp_f32 v131, v131
    v_mfma_f32_32x32x16_bf16 v[112:127], v[216:219], v[36:39], v[112:127]
    v_cvt_pk_bf16_f32 v144, v128, v129
    v_cvt_pk_bf16_f32 v145, v130, v131
    v_exp_f32 v132, v132
    v_exp_f32 v133, v133
    v_exp_f32 v134, v134
    v_exp_f32 v135, v135
    v_mfma_f32_32x32x16_bf16 v[48:63], v[224:227], v[148:151], v[48:63]
    v_cvt_pk_bf16_f32 v146, v132, v133
    v_cvt_pk_bf16_f32 v147, v134, v135
    v_exp_f32 v136, v136
    v_exp_f32 v137, v137
    v_exp_f32 v138, v138
    v_exp_f32 v139, v139
    v_mfma_f32_32x32x16_bf16 v[64:79], v[220:223], v[144:147], v[64:79]
    v_cvt_pk_bf16_f32 v148, v136, v137
    v_cvt_pk_bf16_f32 v149, v138, v139
    v_exp_f32 v140, v140
    v_exp_f32 v141, v141
    v_exp_f32 v142, v142
    v_exp_f32 v143, v143
    v_cvt_pk_bf16_f32 v150, v140, v141
    v_cvt_pk_bf16_f32 v151, v142, v143
    v_mfma_f32_32x32x16_bf16 v[128:143], v[212:215], v[40:43], 0
    v_exp_f32 v112, v112
    v_exp_f32 v113, v113
    v_exp_f32 v114, v114
    v_exp_f32 v115, v115
    v_mfma_f32_32x32x16_bf16 v[128:143], v[216:219], v[44:47], v[128:143]
    v_cvt_pk_bf16_f32 v144, v112, v113
    v_cvt_pk_bf16_f32 v145, v114, v115
    v_exp_f32 v116, v116
    v_exp_f32 v117, v117
    v_exp_f32 v118, v118
    v_exp_f32 v119, v119
    v_mfma_f32_32x32x16_bf16 v[64:79], v[224:227], v[148:151], v[64:79]
    v_cvt_pk_bf16_f32 v146, v116, v117
    v_cvt_pk_bf16_f32 v147, v118, v119
    v_exp_f32 v120, v120
    v_exp_f32 v121, v121
    v_exp_f32 v122, v122
    v_exp_f32 v123, v123
    v_mfma_f32_32x32x16_bf16 v[80:95], v[220:223], v[144:147], v[80:95]
    v_cvt_pk_bf16_f32 v148, v120, v121
    v_cvt_pk_bf16_f32 v149, v122, v123
    v_exp_f32 v124, v124
    v_exp_f32 v125, v125
    v_exp_f32 v126, v126
    v_exp_f32 v127, v127
    v_cvt_pk_bf16_f32 v150, v124, v125
    v_cvt_pk_bf16_f32 v151, v126, v127
    s_waitcnt vmcnt(13)
    v_mfma_f32_32x32x16_bf16 v[112:127], v[180:183], v[16:19], 0
    v_exp_f32 v128, v128
    v_exp_f32 v129, v129
    v_exp_f32 v130, v130
    v_exp_f32 v131, v131
    v_mfma_f32_32x32x16_bf16 v[112:127], v[184:187], v[20:23], v[112:127]
    v_cvt_pk_bf16_f32 v144, v128, v129
    v_cvt_pk_bf16_f32 v145, v130, v131
    v_exp_f32 v132, v132
    v_exp_f32 v133, v133
    v_exp_f32 v134, v134
    v_exp_f32 v135, v135
    v_mfma_f32_32x32x16_bf16 v[80:95], v[224:227], v[148:151], v[80:95]
    v_cvt_pk_bf16_f32 v146, v132, v133
    v_cvt_pk_bf16_f32 v147, v134, v135
    v_exp_f32 v136, v136
    v_exp_f32 v137, v137
    v_exp_f32 v138, v138
    v_exp_f32 v139, v139
    v_mfma_f32_32x32x16_bf16 v[96:111], v[220:223], v[144:147], v[96:111]
    v_cvt_pk_bf16_f32 v148, v136, v137
    v_cvt_pk_bf16_f32 v149, v138, v139
    v_exp_f32 v140, v140
    v_exp_f32 v141, v141
    v_exp_f32 v142, v142
    v_exp_f32 v143, v143
    v_cvt_pk_bf16_f32 v150, v140, v141
    v_cvt_pk_bf16_f32 v151, v142, v143
    v_mfma_f32_32x32x16_bf16 v[128:143], v[180:183], v[24:27], 0
    v_exp_f32 v112, v112
    v_exp_f32 v113, v113
    v_exp_f32 v114, v114
    v_exp_f32 v115, v115
    v_mfma_f32_32x32x16_bf16 v[128:143], v[184:187], v[28:31], v[128:143]
    s_xor_b32 s23, s41, 16384
    v_cvt_pk_bf16_f32 v144, v112, v113
    v_cvt_pk_bf16_f32 v145, v114, v115
    v_exp_f32 v116, v116
    v_exp_f32 v117, v117
    v_exp_f32 v118, v118
    v_exp_f32 v119, v119
    v_mfma_f32_32x32x16_bf16 v[96:111], v[224:227], v[148:151], v[96:111]
    buffer_load_dwordx4 v[212:215], v1, s[8:11], s23 offen sc1
    buffer_load_dwordx4 v[216:219], v1, s[8:11], s23 offen offset:1024 sc1
    buffer_load_dwordx4 v[220:223], v1, s[8:11], s23 offen offset:2048 sc1
    buffer_load_dwordx4 v[224:227], v1, s[8:11], s23 offen offset:3072 sc1
    buffer_load_dwordx4 v1, s[8:11], s52 offen offset:3072 sc1 lds
    v_cvt_pk_bf16_f32 v146, v116, v117
    v_cvt_pk_bf16_f32 v147, v118, v119
    v_exp_f32 v120, v120
    v_exp_f32 v121, v121
    v_exp_f32 v122, v122
    v_exp_f32 v123, v123
    v_mfma_f32_32x32x16_bf16 v[48:63], v[188:191], v[144:147], v[48:63]
    v_cvt_pk_bf16_f32 v148, v120, v121
    v_cvt_pk_bf16_f32 v149, v122, v123
    v_exp_f32 v124, v124
    v_exp_f32 v125, v125
    v_exp_f32 v126, v126
    v_exp_f32 v127, v127
    v_cvt_pk_bf16_f32 v150, v124, v125
    v_cvt_pk_bf16_f32 v151, v126, v127
    v_mfma_f32_32x32x16_bf16 v[112:127], v[180:183], v[32:35], 0
    s_add_u32 s56, s20, 0
    v_lshlrev_b32 v14, 5, v0
    buffer_load_dword v9, v14, s[8:11], s56 offen sc1
    v_exp_f32 v128, v128
    v_exp_f32 v129, v129
    v_exp_f32 v130, v130
    v_exp_f32 v131, v131
    v_mfma_f32_32x32x16_bf16 v[112:127], v[184:187], v[36:39], v[112:127]
    v_cvt_pk_bf16_f32 v144, v128, v129
    v_cvt_pk_bf16_f32 v145, v130, v131
    v_exp_f32 v132, v132
    v_exp_f32 v133, v133
    v_exp_f32 v134, v134
    v_exp_f32 v135, v135
    v_mfma_f32_32x32x16_bf16 v[48:63], v[192:195], v[148:151], v[48:63]
    v_cvt_pk_bf16_f32 v146, v132, v133
    v_cvt_pk_bf16_f32 v147, v134, v135
    v_exp_f32 v136, v136
    v_exp_f32 v137, v137
    v_exp_f32 v138, v138
    v_exp_f32 v139, v139
    v_mfma_f32_32x32x16_bf16 v[64:79], v[188:191], v[144:147], v[64:79]
    v_cvt_pk_bf16_f32 v148, v136, v137
    v_cvt_pk_bf16_f32 v149, v138, v139
    v_exp_f32 v140, v140
    v_exp_f32 v141, v141
    v_exp_f32 v142, v142
    v_exp_f32 v143, v143
    v_cvt_pk_bf16_f32 v150, v140, v141
    v_cvt_pk_bf16_f32 v151, v142, v143
    v_mfma_f32_32x32x16_bf16 v[128:143], v[180:183], v[40:43], 0
    s_lshl_b32 s56, s31, 7
    s_add_u32 s56, s56, 1900544
    buffer_load_dword v9, v5, s[8:11], s56 offen sc1
    s_add_u32 s56, s56, 8192
    buffer_load_dword v9, v5, s[8:11], s56 offen sc1
    v_exp_f32 v112, v112
    v_exp_f32 v113, v113
    v_exp_f32 v114, v114
    v_exp_f32 v115, v115
    v_mfma_f32_32x32x16_bf16 v[128:143], v[184:187], v[44:47], v[128:143]
    v_cvt_pk_bf16_f32 v144, v112, v113
    v_cvt_pk_bf16_f32 v145, v114, v115
    v_exp_f32 v116, v116
    v_exp_f32 v117, v117
    v_exp_f32 v118, v118
    v_exp_f32 v119, v119
    v_mfma_f32_32x32x16_bf16 v[64:79], v[192:195], v[148:151], v[64:79]
    v_cvt_pk_bf16_f32 v146, v116, v117
    v_cvt_pk_bf16_f32 v147, v118, v119
    v_exp_f32 v120, v120
    v_exp_f32 v121, v121
    v_exp_f32 v122, v122
    v_exp_f32 v123, v123
    v_mfma_f32_32x32x16_bf16 v[80:95], v[188:191], v[144:147], v[80:95]
    v_cvt_pk_bf16_f32 v148, v120, v121
    v_cvt_pk_bf16_f32 v149, v122, v123
    v_exp_f32 v124, v124
    v_exp_f32 v125, v125
    v_exp_f32 v126, v126
    v_exp_f32 v127, v127
    v_cvt_pk_bf16_f32 v150, v124, v125
    v_cvt_pk_bf16_f32 v151, v126, v127
    s_waitcnt vmcnt(14)
    v_mfma_f32_32x32x16_bf16 v[112:127], v[152:155], v[16:19], 0
    s_add_u32 s56, s12, 4194304
    v_lshlrev_b32 v14, 5, v0
    buffer_load_dword v9, v14, s[8:11], s56 offen sc1
    v_exp_f32 v128, v128
    v_exp_f32 v129, v129
    v_exp_f32 v130, v130
    v_exp_f32 v131, v131
    v_mfma_f32_32x32x16_bf16 v[112:127], v[156:159], v[20:23], v[112:127]
    v_cvt_pk_bf16_f32 v144, v128, v129
    v_cvt_pk_bf16_f32 v145, v130, v131
    v_exp_f32 v132, v132
    v_exp_f32 v133, v133
    v_exp_f32 v134, v134
    v_exp_f32 v135, v135
    v_mfma_f32_32x32x16_bf16 v[80:95], v[192:195], v[148:151], v[80:95]
    s_add_u32 s56, s13, 4194304
    v_lshlrev_b32 v14, 2, v0
    buffer_load_dword v9, v14, s[8:11], s56 offen sc1
    v_cvt_pk_bf16_f32 v146, v132, v133
    v_cvt_pk_bf16_f32 v147, v134, v135
    v_exp_f32 v136, v136
    v_exp_f32 v137, v137
    v_exp_f32 v138, v138
    v_exp_f32 v139, v139
    v_mfma_f32_32x32x16_bf16 v[96:111], v[188:191], v[144:147], v[96:111]
    v_cvt_pk_bf16_f32 v148, v136, v137
    v_cvt_pk_bf16_f32 v149, v138, v139
    v_exp_f32 v140, v140
    v_exp_f32 v141, v141
    v_exp_f32 v142, v142
    v_exp_f32 v143, v143
    v_cvt_pk_bf16_f32 v150, v140, v141
    v_cvt_pk_bf16_f32 v151, v142, v143
    v_mfma_f32_32x32x16_bf16 v[128:143], v[152:155], v[24:27], 0
    v_exp_f32 v112, v112
    v_exp_f32 v113, v113
    v_exp_f32 v114, v114
    v_exp_f32 v115, v115
    v_mfma_f32_32x32x16_bf16 v[128:143], v[156:159], v[28:31], v[128:143]
    v_cvt_pk_bf16_f32 v144, v112, v113
    v_cvt_pk_bf16_f32 v145, v114, v115
    v_exp_f32 v116, v116
    v_exp_f32 v117, v117
    v_exp_f32 v118, v118
    v_exp_f32 v119, v119
    v_mfma_f32_32x32x16_bf16 v[96:111], v[192:195], v[148:151], v[96:111]
    s_mov_b32 s53, s46
    buffer_load_dwordx4 v[180:183], v1, s[8:11], s53 offen sc1
    buffer_load_dwordx4 v[184:187], v1, s[8:11], s53 offen offset:1024 sc1
    buffer_load_dwordx4 v[188:191], v1, s[8:11], s53 offen offset:2048 sc1
    buffer_load_dwordx4 v[192:195], v1, s[8:11], s53 offen offset:3072 sc1
    v_cvt_pk_bf16_f32 v146, v116, v117
    v_cvt_pk_bf16_f32 v147, v118, v119
    v_exp_f32 v120, v120
    v_exp_f32 v121, v121
    v_exp_f32 v122, v122
    v_exp_f32 v123, v123
    v_mfma_f32_32x32x16_bf16 v[48:63], v[160:163], v[144:147], v[48:63]
    s_add_u32 s52, s50, 12288
    s_add_u32 m0, s51, 12288
    s_nop 0
    buffer_load_dwordx4 v1, s[8:11], s52 offen sc1 lds
    v_cvt_pk_bf16_f32 v148, v120, v121
    v_cvt_pk_bf16_f32 v149, v122, v123
    v_exp_f32 v124, v124
    v_exp_f32 v125, v125
    v_exp_f32 v126, v126
    v_exp_f32 v127, v127
    v_cvt_pk_bf16_f32 v150, v124, v125
    v_cvt_pk_bf16_f32 v151, v126, v127
    v_mfma_f32_32x32x16_bf16 v[112:127], v[152:155], v[32:35], 0
    s_lshl_b32 s56, s29, 6
    s_add_u32 s56, s56, 1904640
    buffer_load_dword v9, v6, s[8:11], s56 offen sc1
    v_exp_f32 v128, v128
    v_exp_f32 v129, v129
    v_exp_f32 v130, v130
    v_exp_f32 v131, v131
    v_mfma_f32_32x32x16_bf16 v[112:127], v[156:159], v[36:39], v[112:127]
    v_cvt_pk_bf16_f32 v144, v128, v129
    v_cvt_pk_bf16_f32 v145, v130, v131
    v_exp_f32 v132, v132
    v_exp_f32 v133, v133
    v_exp_f32 v134, v134
    v_exp_f32 v135, v135
    v_mfma_f32_32x32x16_bf16 v[48:63], v[164:167], v[148:151], v[48:63]
    v_cvt_pk_bf16_f32 v146, v132, v133
    v_cvt_pk_bf16_f32 v147, v134, v135
    v_exp_f32 v136, v136
    v_exp_f32 v137, v137
    v_exp_f32 v138, v138
    v_exp_f32 v139, v139
    v_mfma_f32_32x32x16_bf16 v[64:79], v[160:163], v[144:147], v[64:79]
    v_cvt_pk_bf16_f32 v148, v136, v137
    v_cvt_pk_bf16_f32 v149, v138, v139
    v_exp_f32 v140, v140
    v_exp_f32 v141, v141
    v_exp_f32 v142, v142
    v_exp_f32 v143, v143
    v_cvt_pk_bf16_f32 v150, v140, v141
    v_cvt_pk_bf16_f32 v151, v142, v143
    v_mfma_f32_32x32x16_bf16 v[128:143], v[152:155], v[40:43], 0
    v_exp_f32 v112, v112
    v_exp_f32 v113, v113
    v_exp_f32 v114, v114
    v_exp_f32 v115, v115
    v_mfma_f32_32x32x16_bf16 v[128:143], v[156:159], v[44:47], v[128:143]
    v_cvt_pk_bf16_f32 v144, v112, v113
    v_cvt_pk_bf16_f32 v145, v114, v115
    v_exp_f32 v116, v116
    v_exp_f32 v117, v117
    v_exp_f32 v118, v118
    v_exp_f32 v119, v119
    v_mfma_f32_32x32x16_bf16 v[64:79], v[164:167], v[148:151], v[64:79]
    v_cvt_pk_bf16_f32 v146, v116, v117
    v_cvt_pk_bf16_f32 v147, v118, v119
    v_exp_f32 v120, v120
    v_exp_f32 v121, v121
    v_exp_f32 v122, v122
    v_exp_f32 v123, v123
    v_mfma_f32_32x32x16_bf16 v[80:95], v[160:163], v[144:147], v[80:95]
    v_cvt_pk_bf16_f32 v148, v120, v121
    v_cvt_pk_bf16_f32 v149, v122, v123
    v_exp_f32 v124, v124
    v_exp_f32 v125, v125
    v_exp_f32 v126, v126
    v_exp_f32 v127, v127
    v_cvt_pk_bf16_f32 v150, v124, v125
    v_cvt_pk_bf16_f32 v151, v126, v127
    s_waitcnt vmcnt(17)
    v_mfma_f32_32x32x16_bf16 v[112:127], v[196:199], v[24:27], 0
    v_exp_f32 v128, v128
    v_exp_f32 v129, v129
    v_exp_f32 v130, v130
    v_exp_f32 v131, v131
    v_mfma_f32_32x32x16_bf16 v[112:127], v[200:203], v[28:31], v[112:127]
    v_cvt_pk_bf16_f32 v144, v128, v129
    v_cvt_pk_bf16_f32 v145, v130, v131
    v_exp_f32 v132, v132
    v_exp_f32 v133, v133
    v_exp_f32 v134, v134
    v_exp_f32 v135, v135
    v_mfma_f32_32x32x16_bf16 v[80:95], v[164:167], v[148:151], v[80:95]
    v_cvt_pk_bf16_f32 v146, v132, v133
    v_cvt_pk_bf16_f32 v147, v134, v135
    v_exp_f32 v136, v136
    v_exp_f32 v137, v137
    v_exp_f32 v138, v138
    v_exp_f32 v139, v139
    v_mfma_f32_32x32x16_bf16 v[96:111], v[160:163], v[144:147], v[96:111]
    v_cvt_pk_bf16_f32 v148, v136, v137
    v_cvt_pk_bf16_f32 v149, v138, v139
    v_exp_f32 v140, v140
    v_exp_f32 v141, v141
    v_exp_f32 v142, v142
    v_exp_f32 v143, v143
    v_cvt_pk_bf16_f32 v150, v140, v141
    v_cvt_pk_bf16_f32 v151, v142, v143
    s_waitcnt vmcnt(12)
    v_mfma_f32_32x32x16_bf16 v[128:143], v[212:215], v[24:27], 0
    v_exp_f32 v112, v112
    v_exp_f32 v113, v113
    v_exp_f32 v114, v114
    v_exp_f32 v115, v115
    v_mfma_f32_32x32x16_bf16 v[128:143], v[216:219], v[28:31], v[128:143]
    v_cvt_pk_bf16_f32 v144, v112, v113
    v_cvt_pk_bf16_f32 v145, v114, v115
    v_exp_f32 v116, v116
    v_exp_f32 v117, v117
    v_exp_f32 v118, v118
    v_exp_f32 v119, v119
    v_mfma_f32_32x32x16_bf16 v[96:111], v[164:167], v[148:151], v[96:111]
    s_add_u32 s53, s46, 4096
    buffer_load_dwordx4 v[152:155], v1, s[8:11], s53 offen sc1
    buffer_load_dwordx4 v[156:159], v1, s[8:11], s53 offen offset:1024 sc1
    buffer_load_dwordx4 v[160:163], v1, s[8:11], s53 offen offset:2048 sc1
    buffer_load_dwordx4 v[164:167], v1, s[8:11], s53 offen offset:3072 sc1
    s_add_u32 s53, s46, 8192
    buffer_load_dwordx4 v[24:27], v1, s[8:11], s53 offen sc1
    buffer_load_dwordx4 v[28:31], v1, s[8:11], s53 offen offset:1024 sc1
    v_cvt_pk_bf16_f32 v146, v116, v117
    v_cvt_pk_bf16_f32 v147, v118, v119
    v_exp_f32 v120, v120
    v_exp_f32 v121, v121
    v_exp_f32 v122, v122
    v_exp_f32 v123, v123
    v_mfma_f32_32x32x16_bf16 v[64:79], v[204:207], v[144:147], v[64:79]
    v_cvt_pk_bf16_f32 v148, v120, v121
    v_cvt_pk_bf16_f32 v149, v122, v123
    v_exp_f32 v124, v124
    v_exp_f32 v125, v125
    v_exp_f32 v126, v126
    v_exp_f32 v127, v127
    v_cvt_pk_bf16_f32 v150, v124, v125
    v_cvt_pk_bf16_f32 v151, v126, v127
    v_mfma_f32_32x32x16_bf16 v[112:127], v[196:199], v[32:35], 0
    v_exp_f32 v128, v128
    v_exp_f32 v129, v129
    v_exp_f32 v130, v130
    v_exp_f32 v131, v131
    v_mfma_f32_32x32x16_bf16 v[112:127], v[200:203], v[36:39], v[112:127]
    v_cvt_pk_bf16_f32 v144, v128, v129
    v_cvt_pk_bf16_f32 v145, v130, v131
    v_exp_f32 v132, v132
    v_exp_f32 v133, v133
    v_exp_f32 v134, v134
    v_exp_f32 v135, v135
    v_mfma_f32_32x32x16_bf16 v[64:79], v[208:211], v[148:151], v[64:79]
    v_cvt_pk_bf16_f32 v146, v132, v133
    v_cvt_pk_bf16_f32 v147, v134, v135
    v_exp_f32 v136, v136
    v_exp_f32 v137, v137
    v_exp_f32 v138, v138
    v_exp_f32 v139, v139
    v_mfma_f32_32x32x16_bf16 v[64:79], v[220:223], v[144:147], v[64:79]
    v_cvt_pk_bf16_f32 v148, v136, v137
    v_cvt_pk_bf16_f32 v149, v138, v139
    v_exp_f32 v140, v140
    v_exp_f32 v141, v141
    v_exp_f32 v142, v142
    v_exp_f32 v143, v143
    v_cvt_pk_bf16_f32 v150, v140, v141
    v_cvt_pk_bf16_f32 v151, v142, v143
    v_mfma_f32_32x32x16_bf16 v[128:143], v[212:215], v[32:35], 0
    v_exp_f32 v112, v112
    v_exp_f32 v113, v113
    v_exp_f32 v114, v114
    v_exp_f32 v115, v115
    v_mfma_f32_32x32x16_bf16 v[128:143], v[216:219], v[36:39], v[128:143]
    v_cvt_pk_bf16_f32 v144, v112, v113
    v_cvt_pk_bf16_f32 v145, v114, v115
    v_exp_f32 v116, v116
    v_exp_f32 v117, v117
    v_exp_f32 v118, v118
    v_exp_f32 v119, v119
    v_mfma_f32_32x32x16_bf16 v[64:79], v[224:227], v[148:151], v[64:79]
    s_add_u32 s53, s46, 8192
    buffer_load_dwordx4 v[32:35], v1, s[8:11], s53 offen offset:2048 sc1
    buffer_load_dwordx4 v[36:39], v1, s[8:11], s53 offen offset:3072 sc1
    v_cvt_pk_bf16_f32 v146, v116, v117
    v_cvt_pk_bf16_f32 v147, v118, v119
    v_exp_f32 v120, v120
    v_exp_f32 v121, v121
    v_exp_f32 v122, v122
    v_exp_f32 v123, v123
    v_mfma_f32_32x32x16_bf16 v[80:95], v[204:207], v[144:147], v[80:95]
    v_cvt_pk_bf16_f32 v148, v120, v121
    v_cvt_pk_bf16_f32 v149, v122, v123
    v_exp_f32 v124, v124
    v_exp_f32 v125, v125
    v_exp_f32 v126, v126
    v_exp_f32 v127, v127
    v_cvt_pk_bf16_f32 v150, v124, v125
    v_cvt_pk_bf16_f32 v151, v126, v127
    v_mfma_f32_32x32x16_bf16 v[112:127], v[196:199], v[40:43], 0
    ds_write_b128 v10, v[64:67]
    v_exp_f32 v128, v128
    v_exp_f32 v129, v129
    v_exp_f32 v130, v130
    v_exp_f32 v131, v131
    v_mfma_f32_32x32x16_bf16 v[112:127], v[200:203], v[44:47], v[112:127]
    ds_write_b128 v10, v[68:71] offset:1024
    v_cvt_pk_bf16_f32 v144, v128, v129
    v_cvt_pk_bf16_f32 v145, v130, v131
    v_exp_f32 v132, v132
    v_exp_f32 v133, v133
    v_exp_f32 v134, v134
    v_exp_f32 v135, v135
    v_mfma_f32_32x32x16_bf16 v[80:95], v[208:211], v[148:151], v[80:95]
    ds_write_b128 v10, v[72:75] offset:2048
    v_cvt_pk_bf16_f32 v146, v132, v133
    v_cvt_pk_bf16_f32 v147, v134, v135
    v_exp_f32 v136, v136
    v_exp_f32 v137, v137
    v_exp_f32 v138, v138
    v_exp_f32 v139, v139
    v_mfma_f32_32x32x16_bf16 v[80:95], v[220:223], v[144:147], v[80:95]
    ds_write_b128 v10, v[76:79] offset:3072
    v_cvt_pk_bf16_f32 v148, v136, v137
    v_cvt_pk_bf16_f32 v149, v138, v139
    v_exp_f32 v140, v140
    v_exp_f32 v141, v141
    v_exp_f32 v142, v142
    v_exp_f32 v143, v143
    v_cvt_pk_bf16_f32 v150, v140, v141
    v_cvt_pk_bf16_f32 v151, v142, v143
    v_mfma_f32_32x32x16_bf16 v[128:143], v[212:215], v[40:43], 0
    v_exp_f32 v112, v112
    v_exp_f32 v113, v113
    v_exp_f32 v114, v114
    v_exp_f32 v115, v115
    v_mfma_f32_32x32x16_bf16 v[128:143], v[216:219], v[44:47], v[128:143]
    v_cvt_pk_bf16_f32 v144, v112, v113
    v_cvt_pk_bf16_f32 v145, v114, v115
    v_exp_f32 v116, v116
    v_exp_f32 v117, v117
    v_exp_f32 v118, v118
    v_exp_f32 v119, v119
    v_mfma_f32_32x32x16_bf16 v[80:95], v[224:227], v[148:151], v[80:95]
    s_add_u32 s53, s46, 12288
    buffer_load_dwordx4 v[40:43], v1, s[8:11], s53 offen sc1
    buffer_load_dwordx4 v[44:47], v1, s[8:11], s53 offen offset:1024 sc1
    v_cvt_pk_bf16_f32 v146, v116, v117
    v_cvt_pk_bf16_f32 v147, v118, v119
    v_exp_f32 v120, v120
    v_exp_f32 v121, v121
    v_exp_f32 v122, v122
    v_exp_f32 v123, v123
    v_mfma_f32_32x32x16_bf16 v[96:111], v[204:207], v[144:147], v[96:111]
    v_cvt_pk_bf16_f32 v148, v120, v121
    v_cvt_pk_bf16_f32 v149, v122, v123
    v_exp_f32 v124, v124
    v_exp_f32 v125, v125
    v_exp_f32 v126, v126
    v_exp_f32 v127, v127
    v_cvt_pk_bf16_f32 v150, v124, v125
    v_cvt_pk_bf16_f32 v151, v126, v127
    v_mfma_f32_32x32x16_bf16 v[112:127], v[196:199], v[16:19], 0
    ds_write_b128 v11, v[80:83] offset:16384
    v_exp_f32 v128, v128
    v_exp_f32 v129, v129
    v_exp_f32 v130, v130
    v_exp_f32 v131, v131
    v_mfma_f32_32x32x16_bf16 v[112:127], v[200:203], v[20:23], v[112:127]
    ds_write_b128 v11, v[84:87] offset:17408
    v_cvt_pk_bf16_f32 v144, v128, v129
    v_cvt_pk_bf16_f32 v145, v130, v131
    v_exp_f32 v132, v132
    v_exp_f32 v133, v133
    v_exp_f32 v134, v134
    v_exp_f32 v135, v135
    v_mfma_f32_32x32x16_bf16 v[96:111], v[208:211], v[148:151], v[96:111]
    ds_write_b128 v11, v[88:91] offset:18432
    v_cvt_pk_bf16_f32 v146, v132, v133
    v_cvt_pk_bf16_f32 v147, v134, v135
    v_exp_f32 v136, v136
    v_exp_f32 v137, v137
    v_exp_f32 v138, v138
    v_exp_f32 v139, v139
    v_mfma_f32_32x32x16_bf16 v[96:111], v[220:223], v[144:147], v[96:111]
    ds_write_b128 v11, v[92:95] offset:19456
    v_cvt_pk_bf16_f32 v148, v136, v137
    v_cvt_pk_bf16_f32 v149, v138, v139
    v_exp_f32 v140, v140
    v_exp_f32 v141, v141
    v_exp_f32 v142, v142
    v_exp_f32 v143, v143
    v_cvt_pk_bf16_f32 v150, v140, v141
    v_cvt_pk_bf16_f32 v151, v142, v143
    v_mfma_f32_32x32x16_bf16 v[128:143], v[212:215], v[16:19], 0
    v_exp_f32 v112, v112
    v_exp_f32 v113, v113
    v_exp_f32 v114, v114
    v_exp_f32 v115, v115
    v_mfma_f32_32x32x16_bf16 v[128:143], v[216:219], v[20:23], v[128:143]
    v_cvt_pk_bf16_f32 v144, v112, v113
    v_cvt_pk_bf16_f32 v145, v114, v115
    v_exp_f32 v116, v116
    v_exp_f32 v117, v117
    v_exp_f32 v118, v118
    v_exp_f32 v119, v119
    v_mfma_f32_32x32x16_bf16 v[96:111], v[224:227], v[148:151], v[96:111]
    v_cvt_pk_bf16_f32 v146, v116, v117
    v_cvt_pk_bf16_f32 v147, v118, v119
    v_exp_f32 v120, v120
    v_exp_f32 v121, v121
    v_exp_f32 v122, v122
    v_exp_f32 v123, v123
    v_mfma_f32_32x32x16_bf16 v[48:63], v[204:207], v[144:147], v[48:63]
    v_cvt_pk_bf16_f32 v148, v120, v121
    v_cvt_pk_bf16_f32 v149, v122, v123
    v_exp_f32 v124, v124
    v_exp_f32 v125, v125
    v_exp_f32 v126, v126
    v_exp_f32 v127, v127
    v_cvt_pk_bf16_f32 v150, v124, v125
    v_cvt_pk_bf16_f32 v151, v126, v127
    ds_write_b128 v12, v[96:99] offset:32768
    ds_write_b128 v12, v[100:103] offset:33792
    ds_write_b128 v12, v[104:107] offset:34816
    ds_write_b128 v12, v[108:111] offset:35840
    v_exp_f32 v128, v128
    v_exp_f32 v129, v129
    v_exp_f32 v130, v130
    v_exp_f32 v131, v131
    s_waitcnt lgkmcnt(0)
    s_barrier
    ds_read_b128 v[64:67], v13
    ds_read_b128 v[68:71], v13 offset:1024
    ds_read_b128 v[72:75], v13 offset:2048
    ds_read_b128 v[76:79], v13 offset:3072
    ds_read_b128 v[80:83], v13 offset:16384
    ds_read_b128 v[84:87], v13 offset:17408
    ds_read_b128 v[88:91], v13 offset:18432
    ds_read_b128 v[92:95], v13 offset:19456
    ds_read_b128 v[96:99], v13 offset:32768
    ds_read_b128 v[100:103], v13 offset:33792
    ds_read_b128 v[104:107], v13 offset:34816
    ds_read_b128 v[108:111], v13 offset:35840
    v_cvt_pk_bf16_f32 v144, v128, v129
    v_cvt_pk_bf16_f32 v145, v130, v131
    v_exp_f32 v132, v132
    v_exp_f32 v133, v133
    v_exp_f32 v134, v134
    v_exp_f32 v135, v135
    v_mfma_f32_32x32x16_bf16 v[48:63], v[208:211], v[148:151], v[48:63]
    v_cvt_pk_bf16_f32 v146, v132, v133
    v_cvt_pk_bf16_f32 v147, v134, v135
    v_exp_f32 v136, v136
    v_exp_f32 v137, v137
    v_exp_f32 v138, v138
    v_exp_f32 v139, v139
    v_mfma_f32_32x32x16_bf16 v[48:63], v[220:223], v[144:147], v[48:63]
    v_cvt_pk_bf16_f32 v148, v136, v137
    v_cvt_pk_bf16_f32 v149, v138, v139
    v_exp_f32 v140, v140
    v_exp_f32 v141, v141
    v_exp_f32 v142, v142
    v_exp_f32 v143, v143
    v_cvt_pk_bf16_f32 v150, v140, v141
    v_cvt_pk_bf16_f32 v151, v142, v143
    s_waitcnt lgkmcnt(0)
    v_pk_add_f32 v[76:77], v[76:77], v[92:93]
    v_mfma_f32_32x32x16_bf16 v[48:63], v[224:227], v[148:151], v[48:63]
    s_mov_b32 s7, 0x4e800000
    v_pk_add_f32 v[64:65], v[64:65], v[80:81]
    v_pk_add_f32 v[66:67], v[66:67], v[82:83]
    v_pk_add_f32 v[68:69], v[68:69], v[84:85]
    v_pk_add_f32 v[70:71], v[70:71], v[86:87]
    v_pk_add_f32 v[72:73], v[72:73], v[88:89]
    v_pk_add_f32 v[74:75], v[74:75], v[90:91]
    v_pk_add_f32 v[78:79], v[78:79], v[94:95]
    v_pk_add_f32 v[76:77], v[76:77], v[108:109]
    v_pk_add_f32 v[64:65], v[64:65], v[96:97]
    v_pk_add_f32 v[66:67], v[66:67], v[98:99]
    v_pk_add_f32 v[68:69], v[68:69], v[100:101]
    v_pk_add_f32 v[70:71], v[70:71], v[102:103]
    v_pk_add_f32 v[72:73], v[72:73], v[104:105]
    v_pk_add_f32 v[74:75], v[74:75], v[106:107]
    v_pk_add_f32 v[78:79], v[78:79], v[110:111]
    v_pk_add_f32 v[60:61], v[60:61], v[76:77]
    v_pk_add_f32 v[48:49], v[48:49], v[64:65]
    v_cmp_nlt_f32 vcc, v60, s7
    v_mov_b32 v112, v60
    v_mov_b32 v113, v60
    v_pk_add_f32 v[50:51], v[50:51], v[66:67]
    s_and_b64 vcc, vcc, s[24:25]
    v_permlane32_swap_b32 v112, v113
    s_cbranch_scc1 AEXACT1
    v_rcp_f32 v114, v113
    v_pk_add_f32 v[52:53], v[52:53], v[68:69]
    v_pk_add_f32 v[54:55], v[54:55], v[70:71]
    v_pk_add_f32 v[56:57], v[56:57], v[72:73]
    v_pk_add_f32 v[58:59], v[58:59], v[74:75]
    v_pk_add_f32 v[62:63], v[62:63], v[78:79]
    v_pk_mul_f32 v[48:49], v[48:49], v[114:115] op_sel_hi:[1,0]
    v_pk_mul_f32 v[50:51], v[50:51], v[114:115] op_sel_hi:[1,0]
    v_pk_mul_f32 v[52:53], v[52:53], v[114:115] op_sel_hi:[1,0]
    v_pk_mul_f32 v[54:55], v[54:55], v[114:115] op_sel_hi:[1,0]
    v_pk_mul_f32 v[56:57], v[56:57], v[114:115] op_sel_hi:[1,0]
    v_pk_mul_f32 v[58:59], v[58:59], v[114:115] op_sel_hi:[1,0]
    v_pk_mul_f32 v[60:61], v[60:61], v[114:115] op_sel_hi:[1,0]
    v_pk_mul_f32 v[62:63], v[62:63], v[114:115] op_sel_hi:[1,0]
ASTORE1:
    v_cvt_pk_bf16_f32 v144, v48, v49
    v_cvt_pk_bf16_f32 v145, v50, v51
    v_cvt_pk_bf16_f32 v146, v52, v53
    v_cvt_pk_bf16_f32 v147, v54, v55
    buffer_store_dwordx4 v[144:147], v1, s[88:91], s20 offen
    v_cvt_pk_bf16_f32 v148, v56, v57
    v_cvt_pk_bf16_f32 v149, v58, v59
    v_cvt_pk_bf16_f32 v150, v60, v61
    v_cvt_pk_bf16_f32 v151, v62, v63
    v_cndmask_b32 v150, v150, 0, s[24:25]
    v_cndmask_b32 v151, v151, 0, s[24:25]
    buffer_store_dwordx4 v[148:151], v1, s[88:91], s20 offen offset:1024
    s_cmp_eq_u32 s90, 0
    s_cbranch_scc1 REM_13
    s_mov_b64 exec, 1
    s_waitcnt vmcnt(0)
    buffer_store_dword v8, off, s[8:11], s22
REM_13B:
    s_mov_b64 exec, -1
    s_barrier
    s_cmp_ge_u32 s5, 28
    s_cbranch_scc1 NEXT1
    s_lshl_b32 s39, s31, 7
    s_add_u32 s39, s39, 1900544
    s_lshl_b32 s40, s48, 15
    s_lshl_b32 s7, s3, 13
    s_add_u32 s40, s40, s7
    s_add_u32 s40, s40, 6291456
    s_xor_b32 s41, s40, 0x8000
    s_lshl_b32 s23, s49, 6
    v_lshrrev_b32 v15, 5, v0
    v_lshlrev_b32 v15, 3, v15
    s_mov_b32 s7, 0
POLL_14:
    buffer_load_dword v14, v5, s[8:11], s39 offen sc1
    s_waitcnt vmcnt(0)
    v_cmp_eq_u32 vcc, v8, v14
    s_nop 0
    s_cmp_eq_u64 vcc, -1
    s_cbranch_scc1 POLLD_15
    s_sleep 1
    s_add_u32 s7, s7, 1
    s_cmp_lt_u32 s7, 0x8000
    s_cbranch_scc1 POLL_14
POLLD_15:
    s_mov_b32 s20, s41
    buffer_load_dwordx4 v[48:51], v1, s[8:11], s20 offen sc1
    buffer_load_dwordx4 v[52:55], v1, s[8:11], s20 offen offset:1024 sc1
    buffer_load_dwordx4 v[56:59], v1, s[8:11], s20 offen offset:2048 sc1
    buffer_load_dwordx4 v[60:63], v1, s[8:11], s20 offen offset:3072 sc1
    s_add_u32 s20, s41, 4096
    buffer_load_dwordx4 v[64:67], v1, s[8:11], s20 offen sc1
    buffer_load_dwordx4 v[68:71], v1, s[8:11], s20 offen offset:1024 sc1
    buffer_load_dwordx4 v[72:75], v1, s[8:11], s20 offen offset:2048 sc1
    buffer_load_dwordx4 v[76:79], v1, s[8:11], s20 offen offset:3072 sc1
    s_mov_b32 s20, s40
    buffer_load_dwordx4 v[80:83], v1, s[8:11], s20 offen sc1
    buffer_load_dwordx4 v[84:87], v1, s[8:11], s20 offen offset:1024 sc1
    s_waitcnt vmcnt(9)
    v_mfma_f32_32x32x16_bf16 v[128:143], v[180:183], v[48:51], 0
    v_mfma_f32_32x32x16_bf16 v[212:227], v[184:187], v[48:51], 0
    buffer_load_dwordx4 v[88:91], v1, s[8:11], s20 offen offset:2048 sc1
    s_waitcnt vmcnt(9)
    v_mfma_f32_32x32x16_bf16 v[128:143], v[188:191], v[52:55], v[128:143]
    v_mfma_f32_32x32x16_bf16 v[212:227], v[192:195], v[52:55], v[212:227]
    buffer_load_dwordx4 v[92:95], v1, s[8:11], s20 offen offset:3072 sc1
    s_waitcnt vmcnt(9)
    v_mfma_f32_32x32x16_bf16 v[128:143], v[152:155], v[56:59], v[128:143]
    s_add_u32 s20, s40, 4096
    buffer_load_dwordx4 v[96:99], v1, s[8:11], s20 offen sc1
    v_mfma_f32_32x32x16_bf16 v[212:227], v[156:159], v[56:59], v[212:227]
    buffer_load_dwordx4 v[100:103], v1, s[8:11], s20 offen offset:1024 sc1
    s_waitcnt vmcnt(10)
    v_mfma_f32_32x32x16_bf16 v[128:143], v[160:163], v[60:63], v[128:143]
    v_mfma_f32_32x32x16_bf16 v[212:227], v[164:167], v[60:63], v[212:227]
    buffer_load_dwordx4 v[104:107], v1, s[8:11], s20 offen offset:2048 sc1
    s_waitcnt vmcnt(10)
    v_mfma_f32_32x32x16_bf16 v[128:143], v[24:27], v[64:67], v[128:143]
    buffer_load_dwordx4 v[108:111], v1, s[8:11], s20 offen offset:3072 sc1
    v_mfma_f32_32x32x16_bf16 v[212:227], v[28:31], v[64:67], v[212:227]
    buffer_load_dwordx2 v[196:197], v15, s[96:99], s23 offen
    s_waitcnt vmcnt(11)
    v_mfma_f32_32x32x16_bf16 v[128:143], v[32:35], v[68:71], v[128:143]
    v_mfma_f32_32x32x16_bf16 v[212:227], v[36:39], v[68:71], v[212:227]
    buffer_load_dwordx2 v[198:199], v15, s[96:99], s23 offen offset:16
    s_waitcnt vmcnt(11)
    v_mfma_f32_32x32x16_bf16 v[128:143], v[40:43], v[72:75], v[128:143]
    v_mfma_f32_32x32x16_bf16 v[212:227], v[44:47], v[72:75], v[212:227]
    buffer_load_dwordx2 v[200:201], v15, s[96:99], s23 offen offset:32
    s_waitcnt vmcnt(11)
    v_mfma_f32_32x32x16_bf16 v[128:143], v[228:231], v[76:79], v[128:143]
    v_mfma_f32_32x32x16_bf16 v[212:227], v[232:235], v[76:79], v[212:227]
    buffer_load_dwordx2 v[202:203], v15, s[96:99], s23 offen offset:48
    s_waitcnt vmcnt(11)
    v_mfma_f32_32x32x16_bf16 v[240:255], v[180:183], v[80:83], v[240:255]
    v_mfma_f32_32x32x16_bf16 v[112:127], v[184:187], v[80:83], 0
    s_waitcnt vmcnt(10)
    v_mfma_f32_32x32x16_bf16 v[240:255], v[188:191], v[84:87], v[240:255]
    v_mfma_f32_32x32x16_bf16 v[112:127], v[192:195], v[84:87], v[112:127]
    s_waitcnt vmcnt(9)
    v_mfma_f32_32x32x16_bf16 v[240:255], v[152:155], v[88:91], v[240:255]
    v_mfma_f32_32x32x16_bf16 v[112:127], v[156:159], v[88:91], v[112:127]
    s_waitcnt vmcnt(8)
    v_mfma_f32_32x32x16_bf16 v[240:255], v[160:163], v[92:95], v[240:255]
    v_mfma_f32_32x32x16_bf16 v[112:127], v[164:167], v[92:95], v[112:127]
    ds_write_b128 v11, v[128:131] offset:16384
    ds_write_b128 v11, v[132:135] offset:17408
    s_waitcnt vmcnt(7)
    v_mfma_f32_32x32x16_bf16 v[112:127], v[28:31], v[96:99], v[112:127]
    ds_write_b128 v11, v[136:139] offset:18432
    ds_write_b128 v11, v[140:143] offset:19456
    s_waitcnt vmcnt(6)
    v_mfma_f32_32x32x16_bf16 v[112:127], v[36:39], v[100:103], v[112:127]
    ds_write_b128 v12, v[212:215] offset:32768
    ds_write_b128 v12, v[216:219] offset:33792
    s_waitcnt vmcnt(5)
    v_mfma_f32_32x32x16_bf16 v[112:127], v[44:47], v[104:107], v[112:127]
    ds_write_b128 v12, v[220:223] offset:34816
    ds_write_b128 v12, v[224:227] offset:35840
    s_waitcnt vmcnt(4)
    v_mfma_f32_32x32x16_bf16 v[112:127], v[232:235], v[108:111], v[112:127]
    v_mfma_f32_32x32x16_bf16 v[240:255], v[24:27], v[96:99], v[240:255]
    v_mfma_f32_32x32x16_bf16 v[240:255], v[32:35], v[100:103], v[240:255]
    s_nop 9
    ds_write_b128 v10, v[112:115]
    ds_write_b128 v10, v[116:119] offset:1024
    ds_write_b128 v10, v[120:123] offset:2048
    ds_write_b128 v10, v[124:127] offset:3072
    s_waitcnt lgkmcnt(0)
    s_barrier
    v_mfma_f32_32x32x16_bf16 v[240:255], v[40:43], v[104:107], v[240:255]
    ds_read_b128 v[48:51], v13
    ds_read_b128 v[52:55], v13 offset:1024
    ds_read_b128 v[56:59], v13 offset:2048
    ds_read_b128 v[60:63], v13 offset:3072
    ds_read_b128 v[64:67], v13 offset:16384
    ds_read_b128 v[68:71], v13 offset:17408
    v_mfma_f32_32x32x16_bf16 v[240:255], v[228:231], v[108:111], v[240:255]
    ds_read_b128 v[72:75], v13 offset:18432
    ds_read_b128 v[76:79], v13 offset:19456
    ds_read_b128 v[80:83], v13 offset:32768
    ds_read_b128 v[84:87], v13 offset:33792
    ds_read_b128 v[88:91], v13 offset:34816
    ds_read_b128 v[92:95], v13 offset:35840
    s_add_u32 s20, s12, 4194304
    s_add_u32 s21, s13, 4194304
    s_add_u32 s22, s14, 1904640
    s_waitcnt lgkmcnt(8)
    s_nop 1
    v_pk_add_f32 v[240:241], v[240:241], v[48:49]
    v_pk_add_f32 v[242:243], v[242:243], v[50:51]
    v_pk_add_f32 v[244:245], v[244:245], v[52:53]
    v_pk_add_f32 v[246:247], v[246:247], v[54:55]
    v_pk_add_f32 v[248:249], v[248:249], v[56:57]
    v_pk_add_f32 v[250:251], v[250:251], v[58:59]
    v_pk_add_f32 v[252:253], v[252:253], v[60:61]
    v_pk_add_f32 v[254:255], v[254:255], v[62:63]
    s_waitcnt lgkmcnt(4)
    v_pk_add_f32 v[240:241], v[240:241], v[64:65]
    v_pk_add_f32 v[242:243], v[242:243], v[66:67]
    v_pk_add_f32 v[244:245], v[244:245], v[68:69]
    v_pk_add_f32 v[246:247], v[246:247], v[70:71]
    v_pk_add_f32 v[248:249], v[248:249], v[72:73]
    v_pk_add_f32 v[250:251], v[250:251], v[74:75]
    v_pk_add_f32 v[252:253], v[252:253], v[76:77]
    v_pk_add_f32 v[254:255], v[254:255], v[78:79]
    s_waitcnt lgkmcnt(0)
    v_pk_add_f32 v[240:241], v[240:241], v[80:81]
    v_pk_add_f32 v[242:243], v[242:243], v[82:83]
    v_pk_add_f32 v[244:245], v[244:245], v[84:85]
    v_pk_add_f32 v[246:247], v[246:247], v[86:87]
    v_pk_add_f32 v[248:249], v[248:249], v[88:89]
    v_pk_add_f32 v[250:251], v[250:251], v[90:91]
    v_pk_add_f32 v[252:253], v[252:253], v[92:93]
    v_pk_add_f32 v[254:255], v[254:255], v[94:95]
    v_cvt_pk_bf16_f32 v96, v240, v241
    v_cvt_pk_bf16_f32 v97, v242, v243
    v_cvt_pk_bf16_f32 v98, v244, v245
    v_cvt_pk_bf16_f32 v99, v246, v247
    buffer_store_dwordx4 v[96:99], v1, s[88:91], s20 offen
    v_cvt_pk_bf16_f32 v100, v248, v249
    v_cvt_pk_bf16_f32 v101, v250, v251
    v_cvt_pk_bf16_f32 v102, v252, v253
    v_cvt_pk_bf16_f32 v103, v254, v255
    buffer_store_dwordx4 v[100:103], v1, s[88:91], s20 offen offset:1024
    v_pk_add_f32 v[104:105], v[240:241], v[242:243]
    v_pk_mul_f32 v[106:107], v[240:241], v[240:241]
    v_pk_fma_f32 v[106:107], v[242:243], v[242:243], v[106:107]
    v_pk_add_f32 v[104:105], v[104:105], v[244:245]
    v_pk_fma_f32 v[106:107], v[244:245], v[244:245], v[106:107]
    v_pk_add_f32 v[104:105], v[104:105], v[246:247]
    v_pk_fma_f32 v[106:107], v[246:247], v[246:247], v[106:107]
    v_pk_add_f32 v[104:105], v[104:105], v[248:249]
    v_pk_fma_f32 v[106:107], v[248:249], v[248:249], v[106:107]
    v_pk_add_f32 v[104:105], v[104:105], v[250:251]
    v_pk_fma_f32 v[106:107], v[250:251], v[250:251], v[106:107]
    v_pk_add_f32 v[104:105], v[104:105], v[252:253]
    v_pk_fma_f32 v[106:107], v[252:253], v[252:253], v[106:107]
    v_pk_add_f32 v[104:105], v[104:105], v[254:255]
    v_pk_fma_f32 v[106:107], v[254:255], v[254:255], v[106:107]
    v_add_f32 v104, v104, v105
    v_add_f32 v105, v106, v107
    v_mov_b32 v106, v104
    v_mov_b32 v107, v105
    s_nop 0
    v_permlane32_swap_b32 v104, v106
    v_permlane32_swap_b32 v105, v107
    v_pk_add_f32 v[104:105], v[104:105], v[106:107]
    s_mov_b32 exec_hi, 0
    buffer_store_dwordx2 v[104:105], v3, s[88:91], s21 offen
    s_cmp_eq_u32 s90, 0
    s_cbranch_scc1 REM_16
    s_mov_b64 exec, 1
    s_waitcnt vmcnt(0)
    buffer_store_dword v8, off, s[8:11], s22
REM_16B:
    s_mov_b64 exec, -1
    s_barrier
    v_lshlrev_b32 v14, 16, v196
    v_and_b32 v15, 0xffff0000, v196
    v_pk_add_f32 v[240:241], v[240:241], v[14:15]
    v_lshlrev_b32 v14, 16, v197
    v_and_b32 v15, 0xffff0000, v197
    v_pk_add_f32 v[242:243], v[242:243], v[14:15]
    v_lshlrev_b32 v14, 16, v198
    v_and_b32 v15, 0xffff0000, v198
    v_pk_add_f32 v[244:245], v[244:245], v[14:15]
    v_lshlrev_b32 v14, 16, v199
    v_and_b32 v15, 0xffff0000, v199
    v_pk_add_f32 v[246:247], v[246:247], v[14:15]
    v_lshlrev_b32 v14, 16, v200
    v_and_b32 v15, 0xffff0000, v200
    v_pk_add_f32 v[248:249], v[248:249], v[14:15]
    v_lshlrev_b32 v14, 16, v201
    v_and_b32 v15, 0xffff0000, v201
    v_pk_add_f32 v[250:251], v[250:251], v[14:15]
    v_lshlrev_b32 v14, 16, v202
    v_and_b32 v15, 0xffff0000, v202
    v_pk_add_f32 v[252:253], v[252:253], v[14:15]
    v_lshlrev_b32 v14, 16, v203
    v_and_b32 v15, 0xffff0000, v203
    v_pk_add_f32 v[254:255], v[254:255], v[14:15]
    s_lshl_b32 s37, s29, 15
    s_add_u32 s37, s37, 4194304
    s_lshl_b32 s39, s29, 6
    s_add_u32 s39, s39, 1904640
    s_add_u32 s41, s15, 4096
    s_lshl_b32 s22, s29, 4
    s_add_u32 s22, s22, s30
    s_lshl_b32 s22, s22, 2
    s_add_u32 s22, s22, 1908736
    ds_read_b128 v[128:131], v2
    ds_read_b128 v[132:135], v2 offset:1024
    ds_read_b128 v[136:139], v2 offset:4096
    ds_read_b128 v[140:143], v2 offset:5120
    ds_read_b128 v[144:147], v2 offset:2048
    ds_read_b128 v[148:151], v2 offset:8192
    s_mov_b32 s7, 0
POLL_17:
    buffer_load_dword v14, v6, s[8:11], s39 offen sc1
    s_waitcnt vmcnt(0)
    v_cmp_eq_u32 vcc, v8, v14
    s_nop 0
    s_cmp_eq_u64 vcc, -1
    s_cbranch_scc1 POLLD_18
    s_sleep 1
    s_add_u32 s7, s7, 1
    s_cmp_lt_u32 s7, 0x8000
    s_cbranch_scc1 POLL_17
POLLD_18:
    s_mov_b32 s20, s37
    buffer_load_dwordx4 v[16:19], v1, s[8:11], s20 offen sc1
    buffer_load_dwordx4 v[20:23], v1, s[8:11], s20 offen offset:1024 sc1
    buffer_load_dwordx4 v[24:27], v1, s[8:11], s20 offen offset:2048 sc1
    buffer_load_dwordx4 v[28:31], v1, s[8:11], s20 offen offset:3072 sc1
    s_add_u32 s20, s37, 4096
    buffer_load_dwordx4 v[32:35], v1, s[8:11], s20 offen sc1
    buffer_load_dwordx4 v[36:39], v1, s[8:11], s20 offen offset:1024 sc1
    buffer_load_dwordx4 v[40:43], v1, s[8:11], s20 offen offset:2048 sc1
    buffer_load_dwordx4 v[44:47], v1, s[8:11], s20 offen offset:3072 sc1
    s_add_u32 s20, s37, 8192
    buffer_load_dwordx4 v[48:51], v1, s[8:11], s20 offen sc1
    buffer_load_dwordx4 v[52:55], v1, s[8:11], s20 offen offset:1024 sc1
    s_waitcnt vmcnt(9) lgkmcnt(4)
    v_mfma_f32_32x32x16_bf16 v[164:179], v[128:131], v[16:19], 0
    ds_read_b128 v[152:155], v2 offset:9216
    v_mfma_f32_32x32x16_bf16 v[180:195], v[132:135], v[16:19], 0
    ds_read_b128 v[156:159], v2 offset:12288
    buffer_load_dwordx4 v[56:59], v1, s[8:11], s20 offen offset:2048 sc1
    s_waitcnt vmcnt(9) lgkmcnt(4)
    v_mfma_f32_32x32x16_bf16 v[164:179], v[136:139], v[20:23], v[164:179]
    ds_read_b128 v[160:163], v2 offset:13312
    v_mfma_f32_32x32x16_bf16 v[180:195], v[140:143], v[20:23], v[180:195]
    ds_read_b128 v[128:131], v2 offset:6144
    buffer_load_dwordx4 v[60:63], v1, s[8:11], s20 offen offset:3072 sc1
    s_waitcnt lgkmcnt(4)
    v_mfma_f32_32x32x16_bf16 v[196:211], v[144:147], v[16:19], 0
    ds_read_b128 v[132:135], v2 offset:16384
    s_waitcnt vmcnt(9)
    v_mfma_f32_32x32x16_bf16 v[164:179], v[148:151], v[24:27], v[164:179]
    ds_read_b128 v[136:139], v2 offset:17408
    s_add_u32 s20, s37, 12288
    buffer_load_dwordx4 v[64:67], v1, s[8:11], s20 offen sc1
    s_waitcnt lgkmcnt(4)
    v_mfma_f32_32x32x16_bf16 v[180:195], v[152:155], v[24:27], v[180:195]
    ds_read_b128 v[140:143], v2 offset:20480
    s_waitcnt vmcnt(9)
    v_mfma_f32_32x32x16_bf16 v[164:179], v[156:159], v[28:31], v[164:179]
    ds_read_b128 v[144:147], v2 offset:21504
    buffer_load_dwordx4 v[68:71], v1, s[8:11], s20 offen offset:1024 sc1
    s_waitcnt lgkmcnt(4)
    v_mfma_f32_32x32x16_bf16 v[180:195], v[160:163], v[28:31], v[180:195]
    ds_read_b128 v[148:151], v2 offset:10240
    v_mfma_f32_32x32x16_bf16 v[196:211], v[128:131], v[20:23], v[196:211]
    ds_read_b128 v[152:155], v2 offset:24576
    buffer_load_dwordx4 v[72:75], v1, s[8:11], s20 offen offset:2048 sc1
    s_waitcnt vmcnt(10) lgkmcnt(4)
    v_mfma_f32_32x32x16_bf16 v[164:179], v[132:135], v[32:35], v[164:179]
    ds_read_b128 v[156:159], v2 offset:25600
    v_mfma_f32_32x32x16_bf16 v[180:195], v[136:139], v[32:35], v[180:195]
    ds_read_b128 v[160:163], v2 offset:28672
    buffer_load_dwordx4 v[76:79], v1, s[8:11], s20 offen offset:3072 sc1
    s_waitcnt vmcnt(10) lgkmcnt(4)
    v_mfma_f32_32x32x16_bf16 v[164:179], v[140:143], v[36:39], v[164:179]
    ds_read_b128 v[128:131], v2 offset:29696
    v_mfma_f32_32x32x16_bf16 v[180:195], v[144:147], v[36:39], v[180:195]
    ds_read_b128 v[132:135], v2 offset:14336
    s_add_u32 s21, s37, 28672
    buffer_load_dwordx2 v[212:213], v3, s[8:11], s21 offen sc1
    s_waitcnt lgkmcnt(4)
    v_mfma_f32_32x32x16_bf16 v[196:211], v[148:151], v[24:27], v[196:211]
    ds_read_b128 v[136:139], v2 offset:32768
    s_waitcnt vmcnt(10)
    v_mfma_f32_32x32x16_bf16 v[164:179], v[152:155], v[40:43], v[164:179]
    ds_read_b128 v[140:143], v2 offset:33792
    buffer_load_dwordx2 v[214:215], v3, s[8:11], s21 offen offset:512 sc1
    s_waitcnt lgkmcnt(4)
    v_mfma_f32_32x32x16_bf16 v[180:195], v[156:159], v[40:43], v[180:195]
    ds_read_b128 v[144:147], v2 offset:36864
    s_waitcnt vmcnt(10)
    v_mfma_f32_32x32x16_bf16 v[164:179], v[160:163], v[44:47], v[164:179]
    ds_read_b128 v[148:151], v2 offset:37888
    buffer_load_dwordx2 v[216:217], v3, s[8:11], s21 offen offset:1024 sc1
    s_waitcnt lgkmcnt(4)
    v_mfma_f32_32x32x16_bf16 v[180:195], v[128:131], v[44:47], v[180:195]
    ds_read_b128 v[152:155], v2 offset:18432
    v_mfma_f32_32x32x16_bf16 v[196:211], v[132:135], v[28:31], v[196:211]
    ds_read_b128 v[156:159], v2 offset:40960
    buffer_load_dwordx2 v[218:219], v3, s[8:11], s21 offen offset:1536 sc1
    s_waitcnt vmcnt(11) lgkmcnt(4)
    v_mfma_f32_32x32x16_bf16 v[164:179], v[136:139], v[48:51], v[164:179]
    ds_read_b128 v[160:163], v2 offset:41984
    v_mfma_f32_32x32x16_bf16 v[180:195], v[140:143], v[48:51], v[180:195]
    ds_read_b128 v[128:131], v2 offset:45056
    buffer_load_dwordx2 v[220:221], v3, s[8:11], s21 offen offset:2048 sc1
    s_waitcnt vmcnt(11) lgkmcnt(4)
    v_mfma_f32_32x32x16_bf16 v[164:179], v[144:147], v[52:55], v[164:179]
    ds_read_b128 v[132:135], v2 offset:46080
    v_mfma_f32_32x32x16_bf16 v[180:195], v[148:151], v[52:55], v[180:195]
    ds_read_b128 v[136:139], v2 offset:22528
    buffer_load_dwordx2 v[222:223], v3, s[8:11], s21 offen offset:2560 sc1
    s_waitcnt lgkmcnt(4)
    v_mfma_f32_32x32x16_bf16 v[196:211], v[152:155], v[32:35], v[196:211]
    ds_read_b128 v[140:143], v2 offset:49152
    s_waitcnt vmcnt(11)
    v_mfma_f32_32x32x16_bf16 v[164:179], v[156:159], v[56:59], v[164:179]
    ds_read_b128 v[144:147], v2 offset:50176
    buffer_load_dwordx2 v[224:225], v3, s[8:11], s21 offen offset:3072 sc1
    s_waitcnt lgkmcnt(4)
    v_mfma_f32_32x32x16_bf16 v[180:195], v[160:163], v[56:59], v[180:195]
    ds_read_b128 v[148:151], v2 offset:53248
    s_waitcnt vmcnt(11)
    v_mfma_f32_32x32x16_bf16 v[164:179], v[128:131], v[60:63], v[164:179]
    ds_read_b128 v[152:155], v2 offset:54272
    s_add_u32 s20, s37, 16384
    buffer_load_dwordx4 v[80:83], v1, s[8:11], s20 offen sc1
    s_waitcnt lgkmcnt(4)
    v_mfma_f32_32x32x16_bf16 v[180:195], v[132:135], v[60:63], v[180:195]
    ds_read_b128 v[156:159], v2 offset:26624
    v_mfma_f32_32x32x16_bf16 v[196:211], v[136:139], v[36:39], v[196:211]
    ds_read_b128 v[160:163], v2 offset:57344
    buffer_load_dwordx4 v[84:87], v1, s[8:11], s20 offen offset:1024 sc1
    s_waitcnt vmcnt(12) lgkmcnt(4)
    v_mfma_f32_32x32x16_bf16 v[164:179], v[140:143], v[64:67], v[164:179]
    ds_read_b128 v[128:131], v2 offset:58368
    v_mfma_f32_32x32x16_bf16 v[180:195], v[144:147], v[64:67], v[180:195]
    ds_read_b128 v[132:135], v2 offset:61440
    buffer_load_dwordx4 v[88:91], v1, s[8:11], s20 offen offset:2048 sc1
    s_waitcnt vmcnt(12) lgkmcnt(4)
    v_mfma_f32_32x32x16_bf16 v[164:179], v[148:151], v[68:71], v[164:179]
    ds_read_b128 v[136:139], v2 offset:62464
    v_mfma_f32_32x32x16_bf16 v[180:195], v[152:155], v[68:71], v[180:195]
    ds_read_b128 v[140:143], v2 offset:30720
    buffer_load_dwordx4 v[92:95], v1, s[8:11], s20 offen offset:3072 sc1
    s_waitcnt lgkmcnt(4)
    v_mfma_f32_32x32x16_bf16 v[196:211], v[156:159], v[40:43], v[196:211]
    ds_read_b128 v[144:147], v7
    s_waitcnt vmcnt(12)
    v_mfma_f32_32x32x16_bf16 v[164:179], v[160:163], v[72:75], v[164:179]
    ds_read_b128 v[148:151], v7 offset:1024
    s_add_u32 s20, s37, 20480
    buffer_load_dwordx4 v[96:99], v1, s[8:11], s20 offen sc1
    s_waitcnt lgkmcnt(4)
    v_mfma_f32_32x32x16_bf16 v[180:195], v[128:131], v[72:75], v[180:195]
    ds_read_b128 v[152:155], v7 offset:4096
    s_waitcnt vmcnt(12)
    v_mfma_f32_32x32x16_bf16 v[164:179], v[132:135], v[76:79], v[164:179]
    ds_read_b128 v[156:159], v7 offset:5120
    buffer_load_dwordx4 v[100:103], v1, s[8:11], s20 offen offset:1024 sc1
    s_waitcnt lgkmcnt(4)
    v_mfma_f32_32x32x16_bf16 v[180:195], v[136:139], v[76:79], v[180:195]
    ds_read_b128 v[160:163], v2 offset:34816
    v_mfma_f32_32x32x16_bf16 v[196:211], v[140:143], v[44:47], v[196:211]
    ds_read_b128 v[128:131], v7 offset:8192
    buffer_load_dwordx4 v[104:107], v1, s[8:11], s20 offen offset:2048 sc1
    s_waitcnt vmcnt(6) lgkmcnt(4)
    v_mfma_f32_32x32x16_bf16 v[164:179], v[144:147], v[80:83], v[164:179]
    ds_read_b128 v[132:135], v7 offset:9216
    v_add_f32 v212, v212, v214
    v_add_f32 v213, v213, v215
    v_add_f32 v212, v212, v216
    v_mfma_f32_32x32x16_bf16 v[180:195], v[148:151], v[80:83], v[180:195]
    ds_read_b128 v[136:139], v7 offset:12288
    buffer_load_dwordx4 v[108:111], v1, s[8:11], s20 offen offset:3072 sc1
    v_add_f32 v213, v213, v217
    v_add_f32 v212, v212, v218
    v_add_f32 v213, v213, v219
    s_waitcnt vmcnt(6) lgkmcnt(4)
    v_mfma_f32_32x32x16_bf16 v[164:179], v[152:155], v[84:87], v[164:179]
    ds_read_b128 v[140:143], v7 offset:13312
    v_add_f32 v212, v212, v220
    v_add_f32 v213, v213, v221
    v_add_f32 v212, v212, v222
    v_mfma_f32_32x32x16_bf16 v[180:195], v[156:159], v[84:87], v[180:195]
    ds_read_b128 v[144:147], v2 offset:38912
    s_add_u32 s20, s37, 24576
    buffer_load_dwordx4 v[112:115], v1, s[8:11], s20 offen sc1
    v_add_f32 v213, v213, v223
    v_add_f32 v212, v212, v224
    v_add_f32 v213, v213, v225
    s_waitcnt lgkmcnt(4)
    v_mfma_f32_32x32x16_bf16 v[196:211], v[160:163], v[48:51], v[196:211]
    ds_read_b128 v[148:151], v7 offset:16384
    v_mov_b32 v214, v212
    v_mov_b32 v215, v213
    s_nop 0
    s_waitcnt vmcnt(6)
    v_mfma_f32_32x32x16_bf16 v[164:179], v[128:131], v[88:91], v[164:179]
    ds_read_b128 v[152:155], v7 offset:17408
    buffer_load_dwordx4 v[116:119], v1, s[8:11], s20 offen offset:1024 sc1
    v_permlane32_swap_b32 v212, v214
    v_permlane32_swap_b32 v213, v215
    v_add_f32 v212, v212, v214
    s_waitcnt lgkmcnt(4)
    v_mfma_f32_32x32x16_bf16 v[180:195], v[132:135], v[88:91], v[180:195]
    ds_read_b128 v[156:159], v7 offset:20480
    v_add_f32 v213, v213, v215
    v_mul_f32 v214, 0xbb124925, v212
    v_mul_f32 v215, 0x3b124925, v213
    s_waitcnt vmcnt(6)
    v_mfma_f32_32x32x16_bf16 v[164:179], v[136:139], v[92:95], v[164:179]
    ds_read_b128 v[160:163], v7 offset:21504
    buffer_load_dwordx4 v[120:123], v1, s[8:11], s20 offen offset:2048 sc1
    v_fma_f32 v215, -v214, v214, v215
    v_max_f32 v215, 0, v215
    v_add_f32 v215, 0x3727c5ac, v215
    s_waitcnt lgkmcnt(4)
    v_mfma_f32_32x32x16_bf16 v[180:195], v[140:143], v[92:95], v[180:195]
    ds_read_b128 v[128:131], v2 offset:43008
    v_rsq_f32 v232, v215
    v_cvt_pk_bf16_f32 v228, v214, v214
    v_mul_f32 v215, v215, v232
    v_mfma_f32_32x32x16_bf16 v[196:211], v[144:147], v[52:55], v[196:211]
    ds_read_b128 v[132:135], v7 offset:24576
    buffer_load_dwordx4 v[124:127], v1, s[8:11], s20 offen offset:3072 sc1
    v_and_b32 v216, 0xffff0000, v228
    v_sub_f32 v216, v214, v216
    v_cvt_pk_bf16_f32 v229, v216, v215
    s_waitcnt vmcnt(7) lgkmcnt(4)
    v_mfma_f32_32x32x16_bf16 v[164:179], v[148:151], v[96:99], v[164:179]
    ds_read_b128 v[136:139], v7 offset:25600
    v_and_b32 v217, 0xffff0000, v229
    v_sub_f32 v217, v215, v217
    v_mov_b32 v230, v228
    v_mfma_f32_32x32x16_bf16 v[180:195], v[152:155], v[96:99], v[180:195]
    ds_read_b128 v[140:143], v7 offset:28672
    v_cvt_pk_bf16_f32 v231, v216, v217
    v_mul_f32 v233, v232, v232
    s_waitcnt vmcnt(6) lgkmcnt(4)
    v_mfma_f32_32x32x16_bf16 v[164:179], v[156:159], v[100:103], v[164:179]
    ds_read_b128 v[144:147], v7 offset:29696
    v_mfma_f32_32x32x16_bf16 v[180:195], v[160:163], v[100:103], v[180:195]
    ds_read_b128 v[148:151], v2 offset:47104
    s_waitcnt lgkmcnt(4)
    v_mfma_f32_32x32x16_bf16 v[196:211], v[128:131], v[56:59], v[196:211]
    ds_read_b128 v[152:155], v7 offset:32768
    s_waitcnt vmcnt(5)
    v_mfma_f32_32x32x16_bf16 v[164:179], v[132:135], v[104:107], v[164:179]
    ds_read_b128 v[156:159], v7 offset:33792
    s_waitcnt lgkmcnt(4)
    v_mfma_f32_32x32x16_bf16 v[180:195], v[136:139], v[104:107], v[180:195]
    ds_read_b128 v[160:163], v7 offset:36864
    s_waitcnt vmcnt(4)
    v_mfma_f32_32x32x16_bf16 v[164:179], v[140:143], v[108:111], v[164:179]
    ds_read_b128 v[128:131], v7 offset:37888
    s_waitcnt lgkmcnt(4)
    v_mfma_f32_32x32x16_bf16 v[180:195], v[144:147], v[108:111], v[180:195]
    ds_read_b128 v[132:135], v2 offset:51200
    v_mfma_f32_32x32x16_bf16 v[196:211], v[148:151], v[60:63], v[196:211]
    ds_read_b128 v[136:139], v7 offset:40960
    s_waitcnt vmcnt(3) lgkmcnt(4)
    v_mfma_f32_32x32x16_bf16 v[164:179], v[152:155], v[112:115], v[164:179]
    ds_read_b128 v[140:143], v7 offset:41984
    v_mfma_f32_32x32x16_bf16 v[180:195], v[156:159], v[112:115], v[180:195]
    ds_read_b128 v[144:147], v7 offset:45056
    s_waitcnt vmcnt(2) lgkmcnt(4)
    v_mfma_f32_32x32x16_bf16 v[164:179], v[160:163], v[116:119], v[164:179]
    ds_read_b128 v[148:151], v7 offset:46080
    v_mfma_f32_32x32x16_bf16 v[180:195], v[128:131], v[116:119], v[180:195]
    ds_read_b128 v[152:155], v2 offset:55296
    s_waitcnt lgkmcnt(4)
    v_mfma_f32_32x32x16_bf16 v[196:211], v[132:135], v[64:67], v[196:211]
    ds_read_b128 v[156:159], v2 offset:59392
    s_waitcnt vmcnt(1)
    v_mfma_f32_32x32x16_bf16 v[164:179], v[136:139], v[120:123], v[164:179]
    ds_read_b128 v[160:163], v2 offset:63488
    s_waitcnt lgkmcnt(4)
    v_mfma_f32_32x32x16_bf16 v[180:195], v[140:143], v[120:123], v[180:195]
    ds_read_b128 v[128:131], v7 offset:2048
    s_waitcnt vmcnt(0)
    v_mfma_f32_32x32x16_bf16 v[164:179], v[144:147], v[124:127], v[164:179]
    ds_read_b128 v[132:135], v7 offset:6144
    s_waitcnt lgkmcnt(4)
    v_mfma_f32_32x32x16_bf16 v[180:195], v[148:151], v[124:127], v[180:195]
    ds_read_b128 v[136:139], v7 offset:10240
    v_mfma_f32_32x32x16_bf16 v[196:211], v[152:155], v[68:71], v[196:211]
    ds_read_b128 v[140:143], v7 offset:14336
    v_mfma_f32_32x32x16_bf16 v[164:179], a[224:227], v[228:231], v[164:179]
    v_mfma_f32_32x32x16_bf16 v[180:195], a[228:231], v[228:231], v[180:195]
    v_mfma_f32_32x32x16_bf16 v[196:211], a[232:235], v[228:231], v[196:211]
    s_waitcnt lgkmcnt(4)
    v_mfma_f32_32x32x16_bf16 v[196:211], v[156:159], v[72:75], v[196:211]
    ds_read_b128 v[144:147], v7 offset:18432
    s_nop 6
    v_mul_f32 v164, v164, |v164|
    v_mul_f32 v165, v165, |v165|
    v_mul_f32 v166, v166, |v166|
    v_mul_f32 v167, v167, |v167|
    v_mfma_f32_32x32x16_bf16 v[196:211], v[160:163], v[76:79], v[196:211]
    ds_read_b128 v[148:151], v7 offset:22528
    v_mul_f32 v168, v168, |v168|
    v_mul_f32 v169, v169, |v169|
    v_mul_f32 v170, v170, |v170|
    v_mul_f32 v171, v171, |v171|
    s_waitcnt lgkmcnt(4)
    v_mfma_f32_32x32x16_bf16 v[196:211], v[128:131], v[80:83], v[196:211]
    ds_read_b128 v[152:155], v7 offset:26624
    v_mul_f32 v164, v164, v233
    v_mul_f32 v165, v165, v233
    v_mul_f32 v166, v166, v233
    v_mul_f32 v167, v167, v233
    v_mfma_f32_32x32x16_bf16 v[196:211], v[132:135], v[84:87], v[196:211]
    ds_read_b128 v[156:159], v7 offset:30720
    v_mul_f32 v168, v168, v233
    v_mul_f32 v169, v169, v233
    v_mul_f32 v170, v170, v233
    v_mul_f32 v171, v171, v233
    s_waitcnt lgkmcnt(4)
    v_mfma_f32_32x32x16_bf16 v[196:211], v[136:139], v[88:91], v[196:211]
    ds_read_b128 v[160:163], v7 offset:34816
    v_cvt_pk_bf16_f32 v164, v164, v165
    v_cvt_pk_bf16_f32 v165, v166, v167
    v_cvt_pk_bf16_f32 v166, v168, v169
    v_cvt_pk_bf16_f32 v167, v170, v171
    v_mfma_f32_32x32x16_bf16 v[196:211], v[140:143], v[92:95], v[196:211]
    ds_read_b128 v[128:131], v7 offset:38912
    v_pk_max_i16 v164, v164, 0
    v_pk_max_i16 v165, v165, 0
    v_pk_max_i16 v166, v166, 0
    v_pk_max_i16 v167, v167, 0
    s_waitcnt lgkmcnt(4)
    v_mfma_f32_32x32x16_bf16 v[196:211], v[144:147], v[96:99], v[196:211]
    ds_read_b128 v[132:135], v7 offset:43008
    buffer_store_dwordx4 v[164:167], v1, s[8:11], s15 offen sc1
    v_mul_f32 v172, v172, |v172|
    v_mul_f32 v173, v173, |v173|
    v_mul_f32 v174, v174, |v174|
    v_mfma_f32_32x32x16_bf16 v[196:211], v[148:151], v[100:103], v[196:211]
    ds_read_b128 v[136:139], v7 offset:47104
    v_mul_f32 v175, v175, |v175|
    v_mul_f32 v176, v176, |v176|
    v_mul_f32 v177, v177, |v177|
    v_mul_f32 v178, v178, |v178|
    s_waitcnt lgkmcnt(4)
    v_mfma_f32_32x32x16_bf16 v[196:211], v[152:155], v[104:107], v[196:211]
    ds_read_b128 v[140:143], v2 offset:3072
    v_mul_f32 v179, v179, |v179|
    v_mul_f32 v172, v172, v233
    v_mul_f32 v173, v173, v233
    v_mul_f32 v174, v174, v233
    v_mfma_f32_32x32x16_bf16 v[196:211], v[156:159], v[108:111], v[196:211]
    ds_read_b128 v[144:147], v2 offset:7168
    v_mul_f32 v175, v175, v233
    v_mul_f32 v176, v176, v233
    v_mul_f32 v177, v177, v233
    v_mul_f32 v178, v178, v233
    s_waitcnt lgkmcnt(4)
    v_mfma_f32_32x32x16_bf16 v[196:211], v[160:163], v[112:115], v[196:211]
    ds_read_b128 v[148:151], v2 offset:11264
    v_mul_f32 v179, v179, v233
    v_cvt_pk_bf16_f32 v172, v172, v173
    v_cvt_pk_bf16_f32 v173, v174, v175
    v_cvt_pk_bf16_f32 v174, v176, v177
    v_mfma_f32_32x32x16_bf16 v[196:211], v[128:131], v[116:119], v[196:211]
    ds_read_b128 v[152:155], v2 offset:15360
    v_cvt_pk_bf16_f32 v175, v178, v179
    v_pk_max_i16 v172, v172, 0
    v_pk_max_i16 v173, v173, 0
    v_pk_max_i16 v174, v174, 0
    s_waitcnt lgkmcnt(4)
    v_mfma_f32_32x32x16_bf16 v[196:211], v[132:135], v[120:123], v[196:211]
    ds_read_b128 v[156:159], v2 offset:19456
    v_pk_max_i16 v175, v175, 0
    buffer_store_dwordx4 v[172:175], v1, s[8:11], s15 offen offset:1024 sc1
    v_mul_f32 v180, v180, |v180|
    v_mul_f32 v181, v181, |v181|
    v_mfma_f32_32x32x16_bf16 v[196:211], v[136:139], v[124:127], v[196:211]
    ds_read_b128 v[160:163], v2 offset:23552
    v_mul_f32 v182, v182, |v182|
    v_mul_f32 v183, v183, |v183|
    v_mul_f32 v184, v184, |v184|
    v_mul_f32 v185, v185, |v185|
    v_mfma_f32_32x32x16_bf16 v[212:227], a[236:239], v[228:231], 0
    v_mul_f32 v186, v186, |v186|
    v_mul_f32 v187, v187, |v187|
    v_mul_f32 v180, v180, v233
    v_mul_f32 v181, v181, v233
    s_waitcnt lgkmcnt(4)
    v_mfma_f32_32x32x16_bf16 v[212:227], v[140:143], v[16:19], v[212:227]
    ds_read_b128 v[128:131], v2 offset:27648
    v_mul_f32 v182, v182, v233
    v_mul_f32 v183, v183, v233
    v_mul_f32 v184, v184, v233
    v_mul_f32 v185, v185, v233
    v_mfma_f32_32x32x16_bf16 v[212:227], v[144:147], v[20:23], v[212:227]
    ds_read_b128 v[132:135], v2 offset:31744
    v_mul_f32 v186, v186, v233
    v_mul_f32 v187, v187, v233
    v_cvt_pk_bf16_f32 v180, v180, v181
    v_cvt_pk_bf16_f32 v181, v182, v183
    s_waitcnt lgkmcnt(4)
    v_mfma_f32_32x32x16_bf16 v[212:227], v[148:151], v[24:27], v[212:227]
    ds_read_b128 v[136:139], v2 offset:35840
    v_cvt_pk_bf16_f32 v182, v184, v185
    v_cvt_pk_bf16_f32 v183, v186, v187
    v_pk_max_i16 v180, v180, 0
    v_pk_max_i16 v181, v181, 0
    v_mfma_f32_32x32x16_bf16 v[212:227], v[152:155], v[28:31], v[212:227]
    ds_read_b128 v[140:143], v2 offset:39936
    v_pk_max_i16 v182, v182, 0
    v_pk_max_i16 v183, v183, 0
    buffer_store_dwordx4 v[180:183], v1, s[8:11], s15 offen offset:2048 sc1
    v_mul_f32 v188, v188, |v188|
    s_waitcnt lgkmcnt(4)
    v_mfma_f32_32x32x16_bf16 v[212:227], v[156:159], v[32:35], v[212:227]
    ds_read_b128 v[144:147], v2 offset:44032
    v_mul_f32 v189, v189, |v189|
    v_mul_f32 v190, v190, |v190|
    v_mul_f32 v191, v191, |v191|
    v_mul_f32 v192, v192, |v192|
    v_mfma_f32_32x32x16_bf16 v[212:227], v[160:163], v[36:39], v[212:227]
    ds_read_b128 v[148:151], v2 offset:48128
    v_mul_f32 v193, v193, |v193|
    v_mul_f32 v194, v194, |v194|
    v_mul_f32 v195, v195, |v195|
    v_mul_f32 v188, v188, v233
    s_waitcnt lgkmcnt(4)
    v_mfma_f32_32x32x16_bf16 v[212:227], v[128:131], v[40:43], v[212:227]
    ds_read_b128 v[152:155], v2 offset:52224
    v_mul_f32 v189, v189, v233
    v_mul_f32 v190, v190, v233
    v_mul_f32 v191, v191, v233
    v_mul_f32 v192, v192, v233
    v_mfma_f32_32x32x16_bf16 v[212:227], v[132:135], v[44:47], v[212:227]
    ds_read_b128 v[156:159], v2 offset:56320
    v_mul_f32 v193, v193, v233
    v_mul_f32 v194, v194, v233
    v_mul_f32 v195, v195, v233
    v_cvt_pk_bf16_f32 v188, v188, v189
    s_waitcnt lgkmcnt(4)
    v_mfma_f32_32x32x16_bf16 v[212:227], v[136:139], v[48:51], v[212:227]
    ds_read_b128 v[160:163], v2 offset:60416
    v_cvt_pk_bf16_f32 v189, v190, v191
    v_cvt_pk_bf16_f32 v190, v192, v193
    v_cvt_pk_bf16_f32 v191, v194, v195
    v_pk_max_i16 v188, v188, 0
    v_mfma_f32_32x32x16_bf16 v[212:227], v[140:143], v[52:55], v[212:227]
    ds_read_b128 v[128:131], v2 offset:64512
    v_pk_max_i16 v189, v189, 0
    v_pk_max_i16 v190, v190, 0
    v_pk_max_i16 v191, v191, 0
    buffer_store_dwordx4 v[188:191], v1, s[8:11], s15 offen offset:3072 sc1
    s_waitcnt lgkmcnt(4)
    v_mfma_f32_32x32x16_bf16 v[212:227], v[144:147], v[56:59], v[212:227]
    ds_read_b128 v[132:135], v7 offset:3072
    v_mul_f32 v196, v196, |v196|
    v_mul_f32 v197, v197, |v197|
    v_mul_f32 v198, v198, |v198|
    v_mul_f32 v199, v199, |v199|
    v_mfma_f32_32x32x16_bf16 v[212:227], v[148:151], v[60:63], v[212:227]
    ds_read_b128 v[136:139], v7 offset:7168
    v_mul_f32 v200, v200, |v200|
    v_mul_f32 v201, v201, |v201|
    v_mul_f32 v202, v202, |v202|
    v_mul_f32 v203, v203, |v203|
    s_waitcnt lgkmcnt(4)
    v_mfma_f32_32x32x16_bf16 v[212:227], v[152:155], v[64:67], v[212:227]
    ds_read_b128 v[140:143], v7 offset:11264
    v_mul_f32 v196, v196, v233
    v_mul_f32 v197, v197, v233
    v_mul_f32 v198, v198, v233
    v_mul_f32 v199, v199, v233
    v_mfma_f32_32x32x16_bf16 v[212:227], v[156:159], v[68:71], v[212:227]
    ds_read_b128 v[144:147], v7 offset:15360
    v_mul_f32 v200, v200, v233
    v_mul_f32 v201, v201, v233
    v_mul_f32 v202, v202, v233
    v_mul_f32 v203, v203, v233
    s_waitcnt lgkmcnt(4)
    v_mfma_f32_32x32x16_bf16 v[212:227], v[160:163], v[72:75], v[212:227]
    ds_read_b128 v[148:151], v7 offset:19456
    v_cvt_pk_bf16_f32 v196, v196, v197
    v_cvt_pk_bf16_f32 v197, v198, v199
    v_cvt_pk_bf16_f32 v198, v200, v201
    v_cvt_pk_bf16_f32 v199, v202, v203
    v_mfma_f32_32x32x16_bf16 v[212:227], v[128:131], v[76:79], v[212:227]
    ds_read_b128 v[152:155], v7 offset:23552
    v_pk_max_i16 v196, v196, 0
    v_pk_max_i16 v197, v197, 0
    v_pk_max_i16 v198, v198, 0
    v_pk_max_i16 v199, v199, 0
    s_waitcnt lgkmcnt(4)
    v_mfma_f32_32x32x16_bf16 v[212:227], v[132:135], v[80:83], v[212:227]
    ds_read_b128 v[156:159], v7 offset:27648
    buffer_store_dwordx4 v[196:199], v1, s[8:11], s41 offen sc1
    v_mul_f32 v204, v204, |v204|
    v_mul_f32 v205, v205, |v205|
    v_mul_f32 v206, v206, |v206|
    v_mfma_f32_32x32x16_bf16 v[212:227], v[136:139], v[84:87], v[212:227]
    ds_read_b128 v[160:163], v7 offset:31744
    v_mul_f32 v207, v207, |v207|
    v_mul_f32 v208, v208, |v208|
    v_mul_f32 v209, v209, |v209|
    v_mul_f32 v210, v210, |v210|
    s_waitcnt lgkmcnt(4)
    v_mfma_f32_32x32x16_bf16 v[212:227], v[140:143], v[88:91], v[212:227]
    ds_read_b128 v[128:131], v7 offset:35840
    v_mul_f32 v211, v211, |v211|
    v_mul_f32 v204, v204, v233
    v_mul_f32 v205, v205, v233
    v_mul_f32 v206, v206, v233
    v_mfma_f32_32x32x16_bf16 v[212:227], v[144:147], v[92:95], v[212:227]
    ds_read_b128 v[132:135], v7 offset:39936
    v_mul_f32 v207, v207, v233
    v_mul_f32 v208, v208, v233
    v_mul_f32 v209, v209, v233
    v_mul_f32 v210, v210, v233
    s_waitcnt lgkmcnt(4)
    v_mfma_f32_32x32x16_bf16 v[212:227], v[148:151], v[96:99], v[212:227]
    ds_read_b128 v[136:139], v7 offset:44032
    v_mul_f32 v211, v211, v233
    v_cvt_pk_bf16_f32 v204, v204, v205
    v_cvt_pk_bf16_f32 v205, v206, v207
    v_cvt_pk_bf16_f32 v206, v208, v209
    v_mfma_f32_32x32x16_bf16 v[212:227], v[152:155], v[100:103], v[212:227]
    ds_read_b128 v[140:143], v7 offset:48128
    v_cvt_pk_bf16_f32 v207, v210, v211
    v_pk_max_i16 v204, v204, 0
    v_pk_max_i16 v205, v205, 0
    v_pk_max_i16 v206, v206, 0
    s_waitcnt lgkmcnt(4)
    v_mfma_f32_32x32x16_bf16 v[212:227], v[156:159], v[104:107], v[212:227]
    v_pk_max_i16 v207, v207, 0
    buffer_store_dwordx4 v[204:207], v1, s[8:11], s41 offen offset:1024 sc1
    v_mfma_f32_32x32x16_bf16 v[212:227], v[160:163], v[108:111], v[212:227]
    s_waitcnt lgkmcnt(2)
    v_mfma_f32_32x32x16_bf16 v[212:227], v[128:131], v[112:115], v[212:227]
    v_mfma_f32_32x32x16_bf16 v[212:227], v[132:135], v[116:119], v[212:227]
    s_waitcnt lgkmcnt(0)
    v_mfma_f32_32x32x16_bf16 v[212:227], v[136:139], v[120:123], v[212:227]
    v_mfma_f32_32x32x16_bf16 v[212:227], v[140:143], v[124:127], v[212:227]
    s_nop 11
    v_pk_mul_f32 v[212:213], v[212:213], v[232:233] op_sel_hi:[1,0]
    v_pk_mul_f32 v[214:215], v[214:215], v[232:233] op_sel_hi:[1,0]
    v_pk_mul_f32 v[216:217], v[216:217], v[232:233] op_sel_hi:[1,0]
    v_pk_mul_f32 v[218:219], v[218:219], v[232:233] op_sel_hi:[1,0]
    v_mul_f32 v212, v212, |v212|
    v_mul_f32 v213, v213, |v213|
    v_mul_f32 v214, v214, |v214|
    v_mul_f32 v215, v215, |v215|
    v_mul_f32 v216, v216, |v216|
    v_mul_f32 v217, v217, |v217|
    v_mul_f32 v218, v218, |v218|
    v_mul_f32 v219, v219, |v219|
    v_cvt_pk_bf16_f32 v212, v212, v213
    v_cvt_pk_bf16_f32 v213, v214, v215
    v_cvt_pk_bf16_f32 v214, v216, v217
    v_cvt_pk_bf16_f32 v215, v218, v219
    v_pk_max_i16 v212, v212, 0
    v_pk_max_i16 v213, v213, 0
    v_pk_max_i16 v214, v214, 0
    v_pk_max_i16 v215, v215, 0
    buffer_store_dwordx4 v[212:215], v1, s[8:11], s41 offen offset:2048 sc1
    v_pk_mul_f32 v[220:221], v[220:221], v[232:233] op_sel_hi:[1,0]
    v_pk_mul_f32 v[222:223], v[222:223], v[232:233] op_sel_hi:[1,0]
    v_pk_mul_f32 v[224:225], v[224:225], v[232:233] op_sel_hi:[1,0]
    v_pk_mul_f32 v[226:227], v[226:227], v[232:233] op_sel_hi:[1,0]
    v_mul_f32 v220, v220, |v220|
    v_mul_f32 v221, v221, |v221|
    v_mul_f32 v222, v222, |v222|
    v_mul_f32 v223, v223, |v223|
    v_mul_f32 v224, v224, |v224|
    v_mul_f32 v225, v225, |v225|
    v_mul_f32 v226, v226, |v226|
    v_mul_f32 v227, v227, |v227|
    v_cvt_pk_bf16_f32 v220, v220, v221
    v_cvt_pk_bf16_f32 v221, v222, v223
    v_cvt_pk_bf16_f32 v222, v224, v225
    v_cvt_pk_bf16_f32 v223, v226, v227
    v_pk_max_i16 v220, v220, 0
    v_pk_max_i16 v221, v221, 0
    v_pk_max_i16 v222, v222, 0
    v_pk_max_i16 v223, v223, 0
    buffer_store_dwordx4 v[220:223], v1, s[8:11], s41 offen offset:3072 sc1
    s_cmp_eq_u32 s90, 0
    s_cbranch_scc1 REM_19
    s_mov_b64 exec, 1
    s_waitcnt vmcnt(0)
    buffer_store_dword v8, off, s[8:11], s22
REM_19B:
    s_mov_b64 exec, -1
    s_barrier
    s_lshl_b32 s39, s31, 7
    s_add_u32 s39, s39, 1908736
    s_mul_i32 s7, s3, 28672
    s_add_u32 s7, s7, 20971520
    s_mul_i32 s40, s48, 114688
    s_add_u32 s40, s40, s7
    s_xor_b32 s41, s48, 1
    s_mul_i32 s41, s41, 114688
    s_add_u32 s41, s41, s7
    v_lshlrev_b32 v9, 2, v0
    v_and_b32 v9, 64, v9
    v_add_u32 v9, v9, v6
    v_and_b32 v15, 31, v0
    s_movk_i32 s7, 896
    v_mul_lo_u32 v15, v15, s7
    v_lshrrev_b32 v14, 5, v0
    v_lshl_add_u32 v15, v14, 4, v15
    s_mul_i32 s23, s48, 28672
    s_lshl_b32 s7, s49, 6
    s_add_u32 s23, s23, s7
    s_mov_b32 s7, 0
POLL_20:
    buffer_load_dword v14, v9, s[8:11], s39 offen sc1
    s_waitcnt vmcnt(0)
    v_cmp_eq_u32 vcc, v8, v14
    s_nop 0
    s_cmp_eq_u64 vcc, -1
    s_cbranch_scc1 POLLD_21
    s_sleep 1
    s_add_u32 s7, s7, 1
    s_cmp_lt_u32 s7, 0x8000
    s_cbranch_scc1 POLL_20
POLLD_21:
    s_mov_b32 s20, s41
    buffer_load_dwordx4 v[16:19], v1, s[8:11], s20 offen sc1
    buffer_load_dwordx4 v[20:23], v1, s[8:11], s20 offen offset:1024 sc1
    buffer_load_dwordx4 v[24:27], v1, s[8:11], s20 offen offset:2048 sc1
    buffer_load_dwordx4 v[28:31], v1, s[8:11], s20 offen offset:3072 sc1
    s_add_u32 s20, s41, 4096
    buffer_load_dwordx4 v[32:35], v1, s[8:11], s20 offen sc1
    buffer_load_dwordx4 v[36:39], v1, s[8:11], s20 offen offset:1024 sc1
    buffer_load_dwordx4 v[40:43], v1, s[8:11], s20 offen offset:2048 sc1
    buffer_load_dwordx4 v[44:47], v1, s[8:11], s20 offen offset:3072 sc1
    s_add_u32 s20, s41, 8192
    buffer_load_dwordx4 v[48:51], v1, s[8:11], s20 offen sc1
    buffer_load_dwordx4 v[52:55], v1, s[8:11], s20 offen offset:1024 sc1
    buffer_load_dwordx4 v[56:59], v1, s[8:11], s20 offen offset:2048 sc1
    s_waitcnt vmcnt(10)
    v_mfma_f32_32x32x16_bf16 v[192:207], a[0:3], v[16:19], 0
    v_mfma_f32_32x32x16_bf16 v[208:223], a[4:7], v[16:19], 0
    buffer_load_dwordx4 v[60:63], v1, s[8:11], s20 offen offset:3072 sc1
    s_waitcnt vmcnt(10)
    v_mfma_f32_32x32x16_bf16 v[192:207], a[8:11], v[20:23], v[192:207]
    v_mfma_f32_32x32x16_bf16 v[208:223], a[12:15], v[20:23], v[208:223]
    s_add_u32 s20, s41, 12288
    buffer_load_dwordx4 v[16:19], v1, s[8:11], s20 offen sc1
    s_waitcnt vmcnt(10)
    v_mfma_f32_32x32x16_bf16 v[192:207], a[16:19], v[24:27], v[192:207]
    buffer_load_dwordx4 v[20:23], v1, s[8:11], s20 offen offset:1024 sc1
    v_mfma_f32_32x32x16_bf16 v[208:223], a[20:23], v[24:27], v[208:223]
    buffer_load_dwordx4 v[24:27], v1, s[8:11], s20 offen offset:2048 sc1
    s_waitcnt vmcnt(11)
    v_mfma_f32_32x32x16_bf16 v[192:207], a[24:27], v[28:31], v[192:207]
    v_mfma_f32_32x32x16_bf16 v[208:223], a[28:31], v[28:31], v[208:223]
    buffer_load_dwordx4 v[28:31], v1, s[8:11], s20 offen offset:3072 sc1
    s_waitcnt vmcnt(11)
    v_mfma_f32_32x32x16_bf16 v[192:207], a[32:35], v[32:35], v[192:207]
    v_mfma_f32_32x32x16_bf16 v[208:223], a[36:39], v[32:35], v[208:223]
    s_add_u32 s20, s41, 16384
    buffer_load_dwordx4 v[32:35], v1, s[8:11], s20 offen sc1
    s_waitcnt vmcnt(11)
    v_mfma_f32_32x32x16_bf16 v[192:207], a[40:43], v[36:39], v[192:207]
    v_mfma_f32_32x32x16_bf16 v[208:223], a[44:47], v[36:39], v[208:223]
    buffer_load_dwordx4 v[36:39], v1, s[8:11], s20 offen offset:1024 sc1
    s_waitcnt vmcnt(11)
    v_mfma_f32_32x32x16_bf16 v[192:207], a[48:51], v[40:43], v[192:207]
    v_mfma_f32_32x32x16_bf16 v[208:223], a[52:55], v[40:43], v[208:223]
    buffer_load_dwordx4 v[40:43], v1, s[8:11], s20 offen offset:2048 sc1
    s_waitcnt vmcnt(11)
    v_mfma_f32_32x32x16_bf16 v[192:207], a[56:59], v[44:47], v[192:207]
    v_mfma_f32_32x32x16_bf16 v[208:223], a[60:63], v[44:47], v[208:223]
    buffer_load_dwordx4 v[44:47], v1, s[8:11], s20 offen offset:3072 sc1
    s_waitcnt vmcnt(11)
    v_mfma_f32_32x32x16_bf16 v[192:207], a[64:67], v[48:51], v[192:207]
    v_mfma_f32_32x32x16_bf16 v[208:223], a[68:71], v[48:51], v[208:223]
    s_add_u32 s20, s41, 20480
    buffer_load_dwordx4 v[48:51], v1, s[8:11], s20 offen sc1
    s_waitcnt vmcnt(11)
    v_mfma_f32_32x32x16_bf16 v[192:207], a[72:75], v[52:55], v[192:207]
    v_mfma_f32_32x32x16_bf16 v[208:223], a[76:79], v[52:55], v[208:223]
    buffer_load_dwordx4 v[52:55], v1, s[8:11], s20 offen offset:1024 sc1
    s_waitcnt vmcnt(11)
    v_mfma_f32_32x32x16_bf16 v[192:207], a[80:83], v[56:59], v[192:207]
    v_mfma_f32_32x32x16_bf16 v[208:223], a[84:87], v[56:59], v[208:223]
    buffer_load_dwordx4 v[56:59], v1, s[8:11], s20 offen offset:2048 sc1
    s_waitcnt vmcnt(11)
    v_mfma_f32_32x32x16_bf16 v[192:207], a[88:91], v[60:63], v[192:207]
    v_mfma_f32_32x32x16_bf16 v[208:223], a[92:95], v[60:63], v[208:223]
    buffer_load_dwordx4 v[60:63], v1, s[8:11], s20 offen offset:3072 sc1
    s_waitcnt vmcnt(11)
    v_mfma_f32_32x32x16_bf16 v[192:207], a[96:99], v[16:19], v[192:207]
    v_mfma_f32_32x32x16_bf16 v[208:223], a[100:103], v[16:19], v[208:223]
    s_add_u32 s20, s41, 24576
    buffer_load_dwordx4 v[16:19], v1, s[8:11], s20 offen sc1
    s_waitcnt vmcnt(11)
    v_mfma_f32_32x32x16_bf16 v[192:207], a[104:107], v[20:23], v[192:207]
    v_mfma_f32_32x32x16_bf16 v[208:223], a[108:111], v[20:23], v[208:223]
    buffer_load_dwordx4 v[20:23], v1, s[8:11], s20 offen offset:1024 sc1
    s_waitcnt vmcnt(11)
    v_mfma_f32_32x32x16_bf16 v[192:207], a[112:115], v[24:27], v[192:207]
    v_mfma_f32_32x32x16_bf16 v[208:223], a[116:119], v[24:27], v[208:223]
    buffer_load_dwordx4 v[24:27], v1, s[8:11], s20 offen offset:2048 sc1
    s_waitcnt vmcnt(11)
    v_mfma_f32_32x32x16_bf16 v[192:207], a[120:123], v[28:31], v[192:207]
    v_mfma_f32_32x32x16_bf16 v[208:223], a[124:127], v[28:31], v[208:223]
    buffer_load_dwordx4 v[28:31], v1, s[8:11], s20 offen offset:3072 sc1
    s_waitcnt vmcnt(11)
    v_mfma_f32_32x32x16_bf16 v[192:207], a[128:131], v[32:35], v[192:207]
    v_mfma_f32_32x32x16_bf16 v[208:223], a[132:135], v[32:35], v[208:223]
    s_mov_b32 s20, s40
    buffer_load_dwordx4 v[32:35], v1, s[8:11], s20 offen sc1
    s_waitcnt vmcnt(11)
    v_mfma_f32_32x32x16_bf16 v[192:207], a[136:139], v[36:39], v[192:207]
    v_mfma_f32_32x32x16_bf16 v[208:223], a[140:143], v[36:39], v[208:223]
    buffer_load_dwordx4 v[36:39], v1, s[8:11], s20 offen offset:1024 sc1
    s_waitcnt vmcnt(11)
    v_mfma_f32_32x32x16_bf16 v[192:207], a[144:147], v[40:43], v[192:207]
    v_mfma_f32_32x32x16_bf16 v[208:223], a[148:151], v[40:43], v[208:223]
    buffer_load_dwordx4 v[40:43], v1, s[8:11], s20 offen offset:2048 sc1
    s_waitcnt vmcnt(11)
    v_mfma_f32_32x32x16_bf16 v[192:207], a[152:155], v[44:47], v[192:207]
    v_mfma_f32_32x32x16_bf16 v[208:223], a[156:159], v[44:47], v[208:223]
    buffer_load_dwordx4 v[44:47], v1, s[8:11], s20 offen offset:3072 sc1
    s_waitcnt vmcnt(11)
    v_mfma_f32_32x32x16_bf16 v[192:207], a[160:163], v[48:51], v[192:207]
    v_mfma_f32_32x32x16_bf16 v[208:223], a[164:167], v[48:51], v[208:223]
    s_add_u32 s20, s40, 4096
    buffer_load_dwordx4 v[48:51], v1, s[8:11], s20 offen sc1
    s_waitcnt vmcnt(11)
    v_mfma_f32_32x32x16_bf16 v[192:207], a[168:171], v[52:55], v[192:207]
    v_mfma_f32_32x32x16_bf16 v[208:223], a[172:175], v[52:55], v[208:223]
    buffer_load_dwordx4 v[52:55], v1, s[8:11], s20 offen offset:1024 sc1
    s_waitcnt vmcnt(11)
    v_mfma_f32_32x32x16_bf16 v[192:207], a[176:179], v[56:59], v[192:207]
    v_mfma_f32_32x32x16_bf16 v[208:223], a[180:183], v[56:59], v[208:223]
    buffer_load_dwordx4 v[56:59], v1, s[8:11], s20 offen offset:2048 sc1
    s_waitcnt vmcnt(11)
    v_mfma_f32_32x32x16_bf16 v[192:207], a[184:187], v[60:63], v[192:207]
    v_mfma_f32_32x32x16_bf16 v[208:223], a[188:191], v[60:63], v[208:223]
    buffer_load_dwordx4 v[60:63], v1, s[8:11], s20 offen offset:3072 sc1
    s_waitcnt vmcnt(11)
    v_mfma_f32_32x32x16_bf16 v[192:207], a[192:195], v[16:19], v[192:207]
    v_mfma_f32_32x32x16_bf16 v[208:223], a[196:199], v[16:19], v[208:223]
    s_add_u32 s20, s40, 8192
    buffer_load_dwordx4 v[16:19], v1, s[8:11], s20 offen sc1
    s_waitcnt vmcnt(11)
    v_mfma_f32_32x32x16_bf16 v[192:207], a[200:203], v[20:23], v[192:207]
    v_mfma_f32_32x32x16_bf16 v[208:223], a[204:207], v[20:23], v[208:223]
    buffer_load_dwordx4 v[20:23], v1, s[8:11], s20 offen offset:1024 sc1
    s_waitcnt vmcnt(11)
    v_mfma_f32_32x32x16_bf16 v[192:207], a[208:211], v[24:27], v[192:207]
    v_mfma_f32_32x32x16_bf16 v[208:223], a[212:215], v[24:27], v[208:223]
    buffer_load_dwordx4 v[24:27], v1, s[8:11], s20 offen offset:2048 sc1
    s_waitcnt vmcnt(11)
    v_mfma_f32_32x32x16_bf16 v[192:207], a[216:219], v[28:31], v[192:207]
    v_mfma_f32_32x32x16_bf16 v[208:223], a[220:223], v[28:31], v[208:223]
    buffer_load_dwordx4 v[28:31], v1, s[8:11], s20 offen offset:3072 sc1
    s_waitcnt vmcnt(11)
    v_mfma_f32_32x32x16_bf16 v[240:255], a[0:3], v[32:35], v[240:255]
    v_mfma_f32_32x32x16_bf16 v[176:191], a[4:7], v[32:35], 0
    s_add_u32 s20, s40, 12288
    buffer_load_dwordx4 v[32:35], v1, s[8:11], s20 offen sc1
    s_waitcnt vmcnt(11)
    v_mfma_f32_32x32x16_bf16 v[240:255], a[8:11], v[36:39], v[240:255]
    v_mfma_f32_32x32x16_bf16 v[176:191], a[12:15], v[36:39], v[176:191]
    buffer_load_dwordx4 v[36:39], v1, s[8:11], s20 offen offset:1024 sc1
    s_waitcnt vmcnt(11)
    v_mfma_f32_32x32x16_bf16 v[240:255], a[16:19], v[40:43], v[240:255]
    v_mfma_f32_32x32x16_bf16 v[176:191], a[20:23], v[40:43], v[176:191]
    buffer_load_dwordx4 v[40:43], v1, s[8:11], s20 offen offset:2048 sc1
    s_waitcnt vmcnt(11)
    v_mfma_f32_32x32x16_bf16 v[240:255], a[24:27], v[44:47], v[240:255]
    v_mfma_f32_32x32x16_bf16 v[176:191], a[28:31], v[44:47], v[176:191]
    buffer_load_dwordx4 v[44:47], v1, s[8:11], s20 offen offset:3072 sc1
    ds_write_b128 v11, v[192:195] offset:16384
    s_waitcnt vmcnt(11)
    v_mfma_f32_32x32x16_bf16 v[240:255], a[32:35], v[48:51], v[240:255]
    v_mfma_f32_32x32x16_bf16 v[176:191], a[36:39], v[48:51], v[176:191]
    s_add_u32 s20, s40, 16384
    buffer_load_dwordx4 v[48:51], v1, s[8:11], s20 offen sc1
    ds_write_b128 v11, v[196:199] offset:17408
    s_waitcnt vmcnt(11)
    v_mfma_f32_32x32x16_bf16 v[240:255], a[40:43], v[52:55], v[240:255]
    v_mfma_f32_32x32x16_bf16 v[176:191], a[44:47], v[52:55], v[176:191]
    buffer_load_dwordx4 v[52:55], v1, s[8:11], s20 offen offset:1024 sc1
    ds_write_b128 v11, v[200:203] offset:18432
    s_waitcnt vmcnt(11)
    v_mfma_f32_32x32x16_bf16 v[240:255], a[48:51], v[56:59], v[240:255]
    v_mfma_f32_32x32x16_bf16 v[176:191], a[52:55], v[56:59], v[176:191]
    buffer_load_dwordx4 v[56:59], v1, s[8:11], s20 offen offset:2048 sc1
    ds_write_b128 v11, v[204:207] offset:19456
    s_waitcnt vmcnt(11)
    v_mfma_f32_32x32x16_bf16 v[240:255], a[56:59], v[60:63], v[240:255]
    v_mfma_f32_32x32x16_bf16 v[176:191], a[60:63], v[60:63], v[176:191]
    buffer_load_dwordx4 v[60:63], v1, s[8:11], s20 offen offset:3072 sc1
    ds_write_b128 v12, v[208:211] offset:32768
    s_waitcnt vmcnt(11)
    v_mfma_f32_32x32x16_bf16 v[240:255], a[64:67], v[16:19], v[240:255]
    v_mfma_f32_32x32x16_bf16 v[176:191], a[68:71], v[16:19], v[176:191]
    s_add_u32 s20, s40, 20480
    buffer_load_dwordx4 v[16:19], v1, s[8:11], s20 offen sc1
    ds_write_b128 v12, v[212:215] offset:33792
    s_waitcnt vmcnt(11)
    v_mfma_f32_32x32x16_bf16 v[240:255], a[72:75], v[20:23], v[240:255]
    v_mfma_f32_32x32x16_bf16 v[176:191], a[76:79], v[20:23], v[176:191]
    buffer_load_dwordx4 v[20:23], v1, s[8:11], s20 offen offset:1024 sc1
    ds_write_b128 v12, v[216:219] offset:34816
    s_waitcnt vmcnt(11)
    v_mfma_f32_32x32x16_bf16 v[240:255], a[80:83], v[24:27], v[240:255]
    v_mfma_f32_32x32x16_bf16 v[176:191], a[84:87], v[24:27], v[176:191]
    buffer_load_dwordx4 v[24:27], v1, s[8:11], s20 offen offset:2048 sc1
    ds_write_b128 v12, v[220:223] offset:35840
    s_waitcnt vmcnt(11)
    v_mfma_f32_32x32x16_bf16 v[240:255], a[88:91], v[28:31], v[240:255]
    v_mfma_f32_32x32x16_bf16 v[176:191], a[92:95], v[28:31], v[176:191]
    buffer_load_dwordx4 v[28:31], v1, s[8:11], s20 offen offset:3072 sc1
    s_waitcnt vmcnt(11)
    v_mfma_f32_32x32x16_bf16 v[240:255], a[96:99], v[32:35], v[240:255]
    v_mfma_f32_32x32x16_bf16 v[176:191], a[100:103], v[32:35], v[176:191]
    s_add_u32 s20, s40, 24576
    buffer_load_dwordx4 v[32:35], v1, s[8:11], s20 offen sc1
    s_waitcnt lgkmcnt(0)
    s_barrier
    ds_read_b128 v[192:195], v13 offset:16384
    ds_read_b128 v[196:199], v13 offset:17408
    ds_read_b128 v[200:203], v13 offset:18432
    ds_read_b128 v[204:207], v13 offset:19456
    ds_read_b128 v[208:211], v13 offset:32768
    ds_read_b128 v[212:215], v13 offset:33792
    ds_read_b128 v[216:219], v13 offset:34816
    ds_read_b128 v[220:223], v13 offset:35840
    s_waitcnt vmcnt(11)
    v_mfma_f32_32x32x16_bf16 v[240:255], a[104:107], v[36:39], v[240:255]
    v_mfma_f32_32x32x16_bf16 v[176:191], a[108:111], v[36:39], v[176:191]
    buffer_load_dwordx4 v[36:39], v1, s[8:11], s20 offen offset:1024 sc1
    s_waitcnt vmcnt(11)
    v_mfma_f32_32x32x16_bf16 v[240:255], a[112:115], v[40:43], v[240:255]
    v_mfma_f32_32x32x16_bf16 v[176:191], a[116:119], v[40:43], v[176:191]
    buffer_load_dwordx4 v[40:43], v1, s[8:11], s20 offen offset:2048 sc1
    s_waitcnt vmcnt(11)
    v_mfma_f32_32x32x16_bf16 v[240:255], a[120:123], v[44:47], v[240:255]
    v_mfma_f32_32x32x16_bf16 v[176:191], a[124:127], v[44:47], v[176:191]
    buffer_load_dwordx4 v[44:47], v1, s[8:11], s20 offen offset:3072 sc1
    s_waitcnt lgkmcnt(0)
    s_waitcnt vmcnt(11)
    v_mfma_f32_32x32x16_bf16 v[240:255], a[128:131], v[48:51], v[240:255]
    v_mfma_f32_32x32x16_bf16 v[176:191], a[132:135], v[48:51], v[176:191]
    v_add_f32 v192, v192, v208
    v_add_f32 v193, v193, v209
    v_add_f32 v194, v194, v210
    v_add_f32 v195, v195, v211
    s_waitcnt vmcnt(10)
    v_mfma_f32_32x32x16_bf16 v[240:255], a[136:139], v[52:55], v[240:255]
    v_mfma_f32_32x32x16_bf16 v[176:191], a[140:143], v[52:55], v[176:191]
    v_add_f32 v196, v196, v212
    v_add_f32 v197, v197, v213
    v_add_f32 v198, v198, v214
    v_add_f32 v199, v199, v215
    s_waitcnt vmcnt(9)
    v_mfma_f32_32x32x16_bf16 v[240:255], a[144:147], v[56:59], v[240:255]
    v_mfma_f32_32x32x16_bf16 v[176:191], a[148:151], v[56:59], v[176:191]
    v_add_f32 v200, v200, v216
    v_add_f32 v201, v201, v217
    v_add_f32 v202, v202, v218
    v_add_f32 v203, v203, v219
    s_waitcnt vmcnt(8)
    v_mfma_f32_32x32x16_bf16 v[240:255], a[152:155], v[60:63], v[240:255]
    v_mfma_f32_32x32x16_bf16 v[176:191], a[156:159], v[60:63], v[176:191]
    v_add_f32 v204, v204, v220
    v_add_f32 v205, v205, v221
    v_add_f32 v206, v206, v222
    v_add_f32 v207, v207, v223
    s_waitcnt vmcnt(7)
    v_mfma_f32_32x32x16_bf16 v[176:191], a[164:167], v[16:19], v[176:191]
    s_waitcnt vmcnt(6)
    v_mfma_f32_32x32x16_bf16 v[176:191], a[172:175], v[20:23], v[176:191]
    s_waitcnt vmcnt(5)
    v_mfma_f32_32x32x16_bf16 v[176:191], a[180:183], v[24:27], v[176:191]
    s_nop 0
    v_add_f32 v240, v240, v192
    v_add_f32 v241, v241, v193
    v_add_f32 v242, v242, v194
    s_waitcnt vmcnt(4)
    v_mfma_f32_32x32x16_bf16 v[176:191], a[188:191], v[28:31], v[176:191]
    v_add_f32 v243, v243, v195
    v_add_f32 v244, v244, v196
    v_add_f32 v245, v245, v197
    s_waitcnt vmcnt(3)
    v_mfma_f32_32x32x16_bf16 v[176:191], a[196:199], v[32:35], v[176:191]
    v_add_f32 v246, v246, v198
    v_add_f32 v247, v247, v199
    v_add_f32 v248, v248, v200
    s_waitcnt vmcnt(2)
    v_mfma_f32_32x32x16_bf16 v[176:191], a[204:207], v[36:39], v[176:191]
    v_add_f32 v249, v249, v201
    v_add_f32 v250, v250, v202
    v_add_f32 v251, v251, v203
    s_waitcnt vmcnt(1)
    v_mfma_f32_32x32x16_bf16 v[176:191], a[212:215], v[40:43], v[176:191]
    v_add_f32 v252, v252, v204
    v_add_f32 v253, v253, v205
    v_add_f32 v254, v254, v206
    s_waitcnt vmcnt(0)
    v_mfma_f32_32x32x16_bf16 v[176:191], a[220:223], v[44:47], v[176:191]
    v_add_f32 v255, v255, v207
    s_nop 1
    v_mfma_f32_32x32x16_bf16 v[240:255], a[160:163], v[16:19], v[240:255]
    v_mfma_f32_32x32x16_bf16 v[240:255], a[168:171], v[20:23], v[240:255]
    s_nop 6
    ds_write_b128 v10, v[176:179]
    v_mfma_f32_32x32x16_bf16 v[240:255], a[176:179], v[24:27], v[240:255]
    ds_write_b128 v10, v[180:183] offset:1024
    v_mfma_f32_32x32x16_bf16 v[240:255], a[184:187], v[28:31], v[240:255]
    ds_write_b128 v10, v[184:187] offset:2048
    ds_write_b128 v10, v[188:191] offset:3072
    s_waitcnt lgkmcnt(0)
    s_barrier
    v_mfma_f32_32x32x16_bf16 v[240:255], a[192:195], v[32:35], v[240:255]
    ds_read_b128 v[112:115], v13
    ds_read_b128 v[116:119], v13 offset:1024
    ds_read_b128 v[120:123], v13 offset:2048
    ds_read_b128 v[124:127], v13 offset:3072
    v_mfma_f32_32x32x16_bf16 v[240:255], a[200:203], v[36:39], v[240:255]
    v_mfma_f32_32x32x16_bf16 v[240:255], a[208:211], v[40:43], v[240:255]
    v_mfma_f32_32x32x16_bf16 v[240:255], a[216:219], v[44:47], v[240:255]
    s_waitcnt lgkmcnt(0)
    s_nop 10
    v_pk_add_f32 v[240:241], v[240:241], v[112:113]
    v_pk_add_f32 v[242:243], v[242:243], v[114:115]
    v_pk_add_f32 v[244:245], v[244:245], v[116:117]
    v_pk_add_f32 v[246:247], v[246:247], v[118:119]
    v_pk_add_f32 v[248:249], v[248:249], v[120:121]
    v_pk_add_f32 v[250:251], v[250:251], v[122:123]
    v_pk_add_f32 v[252:253], v[252:253], v[124:125]
    v_pk_add_f32 v[254:255], v[254:255], v[126:127]
    v_cvt_pk_bf16_f32 v160, v240, v241
    v_cvt_pk_bf16_f32 v161, v242, v243
    v_cvt_pk_bf16_f32 v162, v244, v245
    v_cvt_pk_bf16_f32 v163, v246, v247
    s_nop 0
    v_permlane32_swap_b32 v160, v162
    v_permlane32_swap_b32 v161, v163
    buffer_store_dwordx4 v[160:163], v15, s[16:19], s23 offen
    v_cvt_pk_bf16_f32 v164, v248, v249
    v_cvt_pk_bf16_f32 v165, v250, v251
    v_cvt_pk_bf16_f32 v166, v252, v253
    v_cvt_pk_bf16_f32 v167, v254, v255
    s_nop 0
    v_permlane32_swap_b32 v164, v166
    v_permlane32_swap_b32 v165, v167
    buffer_store_dwordx4 v[164:167], v15, s[16:19], s23 offen offset:32
    s_or_b32 s7, s2, s3
    s_cmp_lg_u32 s7, 0
    s_cbranch_scc1 NEXT1
    s_mov_b32 s7, 2031616
    s_mov_b64 exec, 1
    buffer_store_dword v8, off, s[8:11], s7 sc1
    s_mov_b64 exec, -1
NEXT1:
M_END:
    s_endpgm
AEXACT0:
    v_lshlrev_b32 v15, 7, v0
    s_mov_b32 s7, 0
POLL_22:
    buffer_load_dword v14, v15, s[8:11], s39 offen sc1
    s_waitcnt vmcnt(0)
    v_cmp_eq_u32 vcc, v8, v14
    s_nop 0
    s_cmp_eq_u64 vcc, -1
    s_cbranch_scc1 POLLD_23
    s_sleep 1
    s_add_u32 s7, s7, 1
    s_cmp_lt_u32 s7, 0x8000
    s_cbranch_scc1 POLL_22
POLLD_23:
    v_cndmask_b32 v22, v22, 0, s[24:25]
    v_cndmask_b32 v23, v23, 0, s[24:25]
    v_mov_b32 v168, 0xff7fffff
    s_lshl_b32 s38, s27, 18
    s_add_u32 s38, s38, 12582912
    s_mov_b32 s43, 0
    s_mov_b32 s21, s38
AEXA0:
    buffer_load_dwordx4 v[196:199], v1, s[8:11], s21 offen sc1
    buffer_load_dwordx4 v[200:203], v1, s[8:11], s21 offen offset:1024 sc1
    s_waitcnt vmcnt(0)
    v_mfma_f32_32x32x16_bf16 v[112:127], v[196:199], v[16:19], 0
    v_mfma_f32_32x32x16_bf16 v[112:127], v[200:203], v[20:23], v[112:127]
    s_nop 11
    v_max3_f32 v168, v112, v113, v168
    v_max3_f32 v168, v114, v115, v168
    v_max3_f32 v168, v116, v117, v168
    v_max3_f32 v168, v118, v119, v168
    v_max3_f32 v168, v120, v121, v168
    v_max3_f32 v168, v122, v123, v168
    v_max3_f32 v168, v124, v125, v168
    v_max3_f32 v168, v126, v127, v168
    s_add_u32 s21, s21, 4096
    s_add_u32 s43, s43, 1
    s_cmp_lt_u32 s43, 64
    s_cbranch_scc1 AEXA0
    v_mov_b32 v128, v168
    s_nop 1
    v_permlane32_swap_b32 v168, v128
    v_max_f32 v168, v168, v128
    v_and_b32 v128, 0xffff0000, v168
    v_sub_f32 v132, v168, v128
    v_and_b32 v136, 0xffff0000, v132
    v_sub_f32 v132, v132, v136
    v_cvt_pk_bf16_f32 v128, -v128, -v136
    v_cvt_pk_bf16_f32 v132, -v132, 0
    v_cndmask_b32 v22, v22, v128, s[24:25]
    v_cndmask_b32 v23, v23, v132, s[24:25]
    v_mov_b64 v[48:49], 0
    v_mov_b64 v[50:51], 0
    v_mov_b64 v[52:53], 0
    v_mov_b64 v[54:55], 0
    v_mov_b64 v[56:57], 0
    v_mov_b64 v[58:59], 0
    v_mov_b64 v[60:61], 0
    v_mov_b64 v[62:63], 0
    s_mov_b32 s43, 0
    s_mov_b32 s21, s38
AEXB0:
    buffer_load_dwordx4 v[196:199], v1, s[8:11], s21 offen sc1
    buffer_load_dwordx4 v[200:203], v1, s[8:11], s21 offen offset:1024 sc1
    buffer_load_dwordx4 v[204:207], v1, s[8:11], s21 offen offset:2048 sc1
    buffer_load_dwordx4 v[208:211], v1, s[8:11], s21 offen offset:3072 sc1
    s_waitcnt vmcnt(0)
    v_mfma_f32_32x32x16_bf16 v[112:127], v[196:199], v[16:19], 0
    v_mfma_f32_32x32x16_bf16 v[112:127], v[200:203], v[20:23], v[112:127]
    s_nop 11
    v_exp_f32 v112, v112
    v_exp_f32 v113, v113
    v_exp_f32 v114, v114
    v_exp_f32 v115, v115
    v_exp_f32 v116, v116
    v_exp_f32 v117, v117
    v_exp_f32 v118, v118
    v_exp_f32 v119, v119
    v_exp_f32 v120, v120
    v_exp_f32 v121, v121
    v_exp_f32 v122, v122
    v_exp_f32 v123, v123
    v_exp_f32 v124, v124
    v_exp_f32 v125, v125
    v_exp_f32 v126, v126
    v_exp_f32 v127, v127
    v_cvt_pk_bf16_f32 v144, v112, v113
    v_cvt_pk_bf16_f32 v145, v114, v115
    v_cvt_pk_bf16_f32 v146, v116, v117
    v_cvt_pk_bf16_f32 v147, v118, v119
    v_cvt_pk_bf16_f32 v148, v120, v121
    v_cvt_pk_bf16_f32 v149, v122, v123
    v_cvt_pk_bf16_f32 v150, v124, v125
    v_cvt_pk_bf16_f32 v151, v126, v127
    v_mfma_f32_32x32x16_bf16 v[48:63], v[204:207], v[144:147], v[48:63]
    s_nop 0
    v_mfma_f32_32x32x16_bf16 v[48:63], v[208:211], v[148:151], v[48:63]
    s_add_u32 s21, s21, 4096
    s_add_u32 s43, s43, 1
    s_cmp_lt_u32 s43, 64
    s_cbranch_scc1 AEXB0
    s_nop 7
    v_mov_b32 v128, v60
    v_mov_b32 v129, v60
    s_nop 1
    v_permlane32_swap_b32 v128, v129
    v_rcp_f32 v130, v129
    s_nop 0
    v_pk_mul_f32 v[48:49], v[48:49], v[130:131] op_sel_hi:[1,0]
    v_pk_mul_f32 v[50:51], v[50:51], v[130:131] op_sel_hi:[1,0]
    v_pk_mul_f32 v[52:53], v[52:53], v[130:131] op_sel_hi:[1,0]
    v_pk_mul_f32 v[54:55], v[54:55], v[130:131] op_sel_hi:[1,0]
    v_pk_mul_f32 v[56:57], v[56:57], v[130:131] op_sel_hi:[1,0]
    v_pk_mul_f32 v[58:59], v[58:59], v[130:131] op_sel_hi:[1,0]
    v_pk_mul_f32 v[60:61], v[60:61], v[130:131] op_sel_hi:[1,0]
    v_pk_mul_f32 v[62:63], v[62:63], v[130:131] op_sel_hi:[1,0]
    s_branch ASTORE0
AEXACT1:
    v_lshlrev_b32 v15, 7, v0
    s_mov_b32 s7, 0
POLL_24:
    buffer_load_dword v14, v15, s[8:11], s39 offen sc1
    s_waitcnt vmcnt(0)
    v_cmp_eq_u32 vcc, v8, v14
    s_nop 0
    s_cmp_eq_u64 vcc, -1
    s_cbranch_scc1 POLLD_25
    s_sleep 1
    s_add_u32 s7, s7, 1
    s_cmp_lt_u32 s7, 0x8000
    s_cbranch_scc1 POLL_24
POLLD_25:
    v_cndmask_b32 v22, v22, 0, s[24:25]
    v_cndmask_b32 v23, v23, 0, s[24:25]
    v_mov_b32 v168, 0xff7fffff
    s_lshl_b32 s38, s27, 18
    s_add_u32 s38, s38, 16777216
    s_mov_b32 s43, 0
    s_mov_b32 s21, s38
AEXA1:
    buffer_load_dwordx4 v[196:199], v1, s[8:11], s21 offen sc1
    buffer_load_dwordx4 v[200:203], v1, s[8:11], s21 offen offset:1024 sc1
    s_waitcnt vmcnt(0)
    v_mfma_f32_32x32x16_bf16 v[112:127], v[196:199], v[16:19], 0
    v_mfma_f32_32x32x16_bf16 v[112:127], v[200:203], v[20:23], v[112:127]
    s_nop 11
    v_max3_f32 v168, v112, v113, v168
    v_max3_f32 v168, v114, v115, v168
    v_max3_f32 v168, v116, v117, v168
    v_max3_f32 v168, v118, v119, v168
    v_max3_f32 v168, v120, v121, v168
    v_max3_f32 v168, v122, v123, v168
    v_max3_f32 v168, v124, v125, v168
    v_max3_f32 v168, v126, v127, v168
    s_add_u32 s21, s21, 4096
    s_add_u32 s43, s43, 1
    s_cmp_lt_u32 s43, 64
    s_cbranch_scc1 AEXA1
    v_mov_b32 v128, v168
    s_nop 1
    v_permlane32_swap_b32 v168, v128
    v_max_f32 v168, v168, v128
    v_and_b32 v128, 0xffff0000, v168
    v_sub_f32 v132, v168, v128
    v_and_b32 v136, 0xffff0000, v132
    v_sub_f32 v132, v132, v136
    v_cvt_pk_bf16_f32 v128, -v128, -v136
    v_cvt_pk_bf16_f32 v132, -v132, 0
    v_cndmask_b32 v22, v22, v128, s[24:25]
    v_cndmask_b32 v23, v23, v132, s[24:25]
    v_mov_b64 v[48:49], 0
    v_mov_b64 v[50:51], 0
    v_mov_b64 v[52:53], 0
    v_mov_b64 v[54:55], 0
    v_mov_b64 v[56:57], 0
    v_mov_b64 v[58:59], 0
    v_mov_b64 v[60:61], 0
    v_mov_b64 v[62:63], 0
    s_mov_b32 s43, 0
    s_mov_b32 s21, s38
AEXB1:
    buffer_load_dwordx4 v[196:199], v1, s[8:11], s21 offen sc1
    buffer_load_dwordx4 v[200:203], v1, s[8:11], s21 offen offset:1024 sc1
    buffer_load_dwordx4 v[204:207], v1, s[8:11], s21 offen offset:2048 sc1
    buffer_load_dwordx4 v[208:211], v1, s[8:11], s21 offen offset:3072 sc1
    s_waitcnt vmcnt(0)
    v_mfma_f32_32x32x16_bf16 v[112:127], v[196:199], v[16:19], 0
    v_mfma_f32_32x32x16_bf16 v[112:127], v[200:203], v[20:23], v[112:127]
    s_nop 11
    v_exp_f32 v112, v112
    v_exp_f32 v113, v113
    v_exp_f32 v114, v114
    v_exp_f32 v115, v115
    v_exp_f32 v116, v116
    v_exp_f32 v117, v117
    v_exp_f32 v118, v118
    v_exp_f32 v119, v119
    v_exp_f32 v120, v120
    v_exp_f32 v121, v121
    v_exp_f32 v122, v122
    v_exp_f32 v123, v123
    v_exp_f32 v124, v124
    v_exp_f32 v125, v125
    v_exp_f32 v126, v126
    v_exp_f32 v127, v127
    v_cvt_pk_bf16_f32 v144, v112, v113
    v_cvt_pk_bf16_f32 v145, v114, v115
    v_cvt_pk_bf16_f32 v146, v116, v117
    v_cvt_pk_bf16_f32 v147, v118, v119
    v_cvt_pk_bf16_f32 v148, v120, v121
    v_cvt_pk_bf16_f32 v149, v122, v123
    v_cvt_pk_bf16_f32 v150, v124, v125
    v_cvt_pk_bf16_f32 v151, v126, v127
    v_mfma_f32_32x32x16_bf16 v[48:63], v[204:207], v[144:147], v[48:63]
    s_nop 0
    v_mfma_f32_32x32x16_bf16 v[48:63], v[208:211], v[148:151], v[48:63]
    s_add_u32 s21, s21, 4096
    s_add_u32 s43, s43, 1
    s_cmp_lt_u32 s43, 64
    s_cbranch_scc1 AEXB1
    s_nop 7
    v_mov_b32 v128, v60
    v_mov_b32 v129, v60
    s_nop 1
    v_permlane32_swap_b32 v128, v129
    v_rcp_f32 v130, v129
    s_nop 0
    v_pk_mul_f32 v[48:49], v[48:49], v[130:131] op_sel_hi:[1,0]
    v_pk_mul_f32 v[50:51], v[50:51], v[130:131] op_sel_hi:[1,0]
    v_pk_mul_f32 v[52:53], v[52:53], v[130:131] op_sel_hi:[1,0]
    v_pk_mul_f32 v[54:55], v[54:55], v[130:131] op_sel_hi:[1,0]
    v_pk_mul_f32 v[56:57], v[56:57], v[130:131] op_sel_hi:[1,0]
    v_pk_mul_f32 v[58:59], v[58:59], v[130:131] op_sel_hi:[1,0]
    v_pk_mul_f32 v[60:61], v[60:61], v[130:131] op_sel_hi:[1,0]
    v_pk_mul_f32 v[62:63], v[62:63], v[130:131] op_sel_hi:[1,0]
    s_branch ASTORE1
PSLOW:
    s_mov_b32 s7, 0
POLL_26:
    buffer_load_dword v14, v174, s[8:11], s45 offen sc1
    s_waitcnt vmcnt(0)
    v_cmp_eq_u32 vcc, v8, v14
    s_nop 0
    s_cmp_eq_u64 vcc, -1
    s_cbranch_scc1 POLLD_27
    s_sleep 1
    s_add_u32 s7, s7, 1
    s_cmp_lt_u32 s7, 0x8000
    s_cbranch_scc1 POLL_26
POLLD_27:
    s_branch PBACK
KSLOW0_1:
    s_mov_b32 s7, 0
    s_mov_b32 exec_lo, 61440
    s_mov_b32 exec_hi, 0
KSL0_1:
    buffer_load_dword v15, v4, s[8:11], s39 offen sc1
    s_waitcnt vmcnt(0)
    v_cmp_ne_u32 vcc, v8, v15
    s_nop 0
    s_cmp_eq_u32 vcc_lo, 0
    s_cbranch_scc1 KSD0_1
    s_sleep 1
    s_add_u32 s7, s7, 1
    s_cmp_lt_u32 s7, 0x8000
    s_cbranch_scc1 KSL0_1
KSD0_1:
    s_mov_b64 exec, -1
    s_branch KBACK0_1
KSLOW0_5:
    s_mov_b32 s7, 0
    s_mov_b32 exec_lo, 3840
    s_mov_b32 exec_hi, 0
KSL0_5:
    buffer_load_dword v15, v4, s[8:11], s39 offen sc1
    s_waitcnt vmcnt(0)
    v_cmp_ne_u32 vcc, v8, v15
    s_nop 0
    s_cmp_eq_u32 vcc_lo, 0
    s_cbranch_scc1 KSD0_5
    s_sleep 1
    s_add_u32 s7, s7, 1
    s_cmp_lt_u32 s7, 0x8000
    s_cbranch_scc1 KSL0_5
KSD0_5:
    s_mov_b64 exec, -1
    s_branch KBACK0_5
KSLOW0_9:
    s_mov_b32 s7, 0
    s_mov_b32 exec_lo, 254
    s_mov_b32 exec_hi, 0
KSL0_9:
    buffer_load_dword v15, v4, s[8:11], s39 offen sc1
    s_waitcnt vmcnt(0)
    v_cmp_ne_u32 vcc, v8, v15
    s_nop 0
    s_cmp_eq_u32 vcc_lo, 0
    s_cbranch_scc1 KSD0_9
    s_sleep 1
    s_add_u32 s7, s7, 1
    s_cmp_lt_u32 s7, 0x8000
    s_cbranch_scc1 KSL0_9
KSD0_9:
    s_mov_b64 exec, -1
    s_branch KBACK0_9
KSLOW1_1:
    s_mov_b32 s7, 0
    s_mov_b32 exec_lo, 61440
    s_mov_b32 exec_hi, 0
KSL1_1:
    buffer_load_dword v15, v4, s[8:11], s39 offen sc1
    s_waitcnt vmcnt(0)
    v_cmp_ne_u32 vcc, v8, v15
    s_nop 0
    s_cmp_eq_u32 vcc_lo, 0
    s_cbranch_scc1 KSD1_1
    s_sleep 1
    s_add_u32 s7, s7, 1
    s_cmp_lt_u32 s7, 0x8000
    s_cbranch_scc1 KSL1_1
KSD1_1:
    s_mov_b64 exec, -1
    s_branch KBACK1_1
KSLOW1_5:
    s_mov_b32 s7, 0
    s_mov_b32 exec_lo, 3840
    s_mov_b32 exec_hi, 0
KSL1_5:
    buffer_load_dword v15, v4, s[8:11], s39 offen sc1
    s_waitcnt vmcnt(0)
    v_cmp_ne_u32 vcc, v8, v15
    s_nop 0
    s_cmp_eq_u32 vcc_lo, 0
    s_cbranch_scc1 KSD1_5
    s_sleep 1
    s_add_u32 s7, s7, 1
    s_cmp_lt_u32 s7, 0x8000
    s_cbranch_scc1 KSL1_5
KSD1_5:
    s_mov_b64 exec, -1
    s_branch KBACK1_5
KSLOW1_9:
    s_mov_b32 s7, 0
    s_mov_b32 exec_lo, 254
    s_mov_b32 exec_hi, 0
KSL1_9:
    buffer_load_dword v15, v4, s[8:11], s39 offen sc1
    s_waitcnt vmcnt(0)
    v_cmp_ne_u32 vcc, v8, v15
    s_nop 0
    s_cmp_eq_u32 vcc_lo, 0
    s_cbranch_scc1 KSD1_9
    s_sleep 1
    s_add_u32 s7, s7, 1
    s_cmp_lt_u32 s7, 0x8000
    s_cbranch_scc1 KSL1_9
KSD1_9:
    s_mov_b64 exec, -1
    s_branch KBACK1_9
REM_1:
    s_mov_b32 exec_lo, -1
    s_mov_b32 exec_hi, -1
    buffer_store_dwordx4 v[144:147], v1, s[8:11], s20 offen sc1
    s_mov_b32 exec_lo, -1
    s_mov_b32 exec_hi, -1
    buffer_store_dwordx4 v[148:151], v1, s[8:11], s20 offen offset:1024 sc1
    s_mov_b64 exec, 1
    s_waitcnt vmcnt(0)
    buffer_store_dword v8, off, s[8:11], s22 sc1
    s_branch REM_1B
REM_4:
    s_mov_b32 exec_lo, -1
    s_mov_b32 exec_hi, -1
    buffer_store_dwordx4 v[96:99], v1, s[8:11], s20 offen sc1
    s_mov_b32 exec_lo, -1
    s_mov_b32 exec_hi, -1
    buffer_store_dwordx4 v[100:103], v1, s[8:11], s20 offen offset:1024 sc1
    s_mov_b32 exec_lo, -1
    s_mov_b32 exec_hi, 0
    buffer_store_dwordx2 v[104:105], v3, s[8:11], s21 offen sc1
    s_mov_b64 exec, 1
    s_waitcnt vmcnt(0)
    buffer_store_dword v8, off, s[8:11], s22 sc1
    s_branch REM_4B
REM_7:
    s_mov_b64 exec, 1
    s_waitcnt vmcnt(0)
    buffer_store_dword v8, off, s[8:11], s22 sc1
    s_branch REM_7B
REM_10:
    s_mov_b32 exec_lo, -1
    s_mov_b32 exec_hi, -1
    buffer_store_dwordx4 v[160:163], v1, s[8:11], s20 offen sc1
    s_mov_b32 exec_lo, -1
    s_mov_b32 exec_hi, -1
    buffer_store_dwordx4 v[164:167], v1, s[8:11], s20 offen offset:1024 sc1
    s_mov_b32 exec_lo, -1
    s_mov_b32 exec_hi, 0
    buffer_store_dwordx2 v[168:169], v3, s[8:11], s21 offen sc1
    s_mov_b64 exec, 1
    s_waitcnt vmcnt(0)
    buffer_store_dword v8, off, s[8:11], s22 sc1
    s_branch REM_10B
REM_13:
    s_mov_b32 exec_lo, -1
    s_mov_b32 exec_hi, -1
    buffer_store_dwordx4 v[144:147], v1, s[8:11], s20 offen sc1
    s_mov_b32 exec_lo, -1
    s_mov_b32 exec_hi, -1
    buffer_store_dwordx4 v[148:151], v1, s[8:11], s20 offen offset:1024 sc1
    s_mov_b64 exec, 1
    s_waitcnt vmcnt(0)
    buffer_store_dword v8, off, s[8:11], s22 sc1
    s_branch REM_13B
REM_16:
    s_mov_b32 exec_lo, -1
    s_mov_b32 exec_hi, -1
    buffer_store_dwordx4 v[96:99], v1, s[8:11], s20 offen sc1
    s_mov_b32 exec_lo, -1
    s_mov_b32 exec_hi, -1
    buffer_store_dwordx4 v[100:103], v1, s[8:11], s20 offen offset:1024 sc1
    s_mov_b32 exec_lo, -1
    s_mov_b32 exec_hi, 0
    buffer_store_dwordx2 v[104:105], v3, s[8:11], s21 offen sc1
    s_mov_b64 exec, 1
    s_waitcnt vmcnt(0)
    buffer_store_dword v8, off, s[8:11], s22 sc1
    s_branch REM_16B
REM_19:
    s_mov_b64 exec, 1
    s_waitcnt vmcnt(0)
    buffer_store_dword v8, off, s[8:11], s22 sc1
    s_branch REM_19B
IDLE0:
    s_mul_i32 s51, s3, 13312
    s_add_u32 s51, s51, 32768
    s_add_u32 s50, s51, s33
    s_add_u32 s51, s51, 16384
    s_lshl_b32 s43, s3, 13
    s_add_u32 s42, s43, s33
    s_add_u32 s43, s43, 16384
    s_mov_b32 s52, s50
    s_add_u32 m0, s51, 0
    s_nop 0
    buffer_load_dwordx4 v1, s[8:11], s52 offen sc1 lds
    buffer_load_dwordx4 v1, s[8:11], s52 offen offset:1024 sc1 lds
    buffer_load_dwordx4 v1, s[8:11], s52 offen offset:2048 sc1 lds
    buffer_load_dwordx4 v1, s[8:11], s52 offen offset:3072 sc1 lds
    s_add_u32 s52, s50, 4096
    s_add_u32 m0, s51, 4096
    s_nop 0
    buffer_load_dwordx4 v1, s[8:11], s52 offen sc1 lds
    buffer_load_dwordx4 v1, s[8:11], s52 offen offset:1024 sc1 lds
    buffer_load_dwordx4 v1, s[8:11], s52 offen offset:2048 sc1 lds
    buffer_load_dwordx4 v1, s[8:11], s52 offen offset:3072 sc1 lds
    s_add_u32 s52, s50, 8192
    s_add_u32 m0, s51, 8192
    s_nop 0
    buffer_load_dwordx4 v1, s[8:11], s52 offen sc1 lds
    buffer_load_dwordx4 v1, s[8:11], s52 offen offset:1024 sc1 lds
    buffer_load_dwordx4 v1, s[8:11], s52 offen offset:2048 sc1 lds
    buffer_load_dwordx4 v1, s[8:11], s52 offen offset:3072 sc1 lds
    s_add_u32 s52, s50, 12288
    s_add_u32 m0, s51, 12288
    s_nop 0
    buffer_load_dwordx4 v1, s[8:11], s52 offen sc1 lds
    s_mov_b32 s52, s42
    s_add_u32 m0, s43, 0
    s_nop 0
    buffer_load_dwordx4 v1, s[8:11], s52 offen sc1 lds
    buffer_load_dwordx4 v1, s[8:11], s52 offen offset:1024 sc1 lds
    buffer_load_dwordx4 v1, s[8:11], s52 offen offset:2048 sc1 lds
    buffer_load_dwordx4 v1, s[8:11], s52 offen offset:3072 sc1 lds
    s_add_u32 s52, s42, 4096
    s_add_u32 m0, s43, 4096
    s_nop 0
    buffer_load_dwordx4 v1, s[8:11], s52 offen sc1 lds
    buffer_load_dwordx4 v1, s[8:11], s52 offen offset:1024 sc1 lds
    buffer_load_dwordx4 v1, s[8:11], s52 offen offset:2048 sc1 lds
    buffer_load_dwordx4 v1, s[8:11], s52 offen offset:3072 sc1 lds
    s_branch NEXT0
.section .rodata,"a"
.p2align 6
.amdhsa_kernel interleave_layers__softmax_full_mha__dense_activation_squared_relu__prompt_kernel
  .amdhsa_next_free_vgpr 512
  .amdhsa_next_free_sgpr 102
  .amdhsa_accum_offset 256
  .amdhsa_group_segment_fixed_size 0
  .amdhsa_kernarg_size 88
  .amdhsa_user_sgpr_count 2
  .amdhsa_user_sgpr_kernarg_segment_ptr 1
  .amdhsa_system_sgpr_workgroup_id_x 1
.end_amdhsa_kernel
```
